```python
import torch

def _softmax(x, axis=-1):
    return torch.softmax(x, dim=axis)

def _gelu(x):
    return torch.nn.functional.gelu(x, approximate='tanh')

def _silu(x):
    return torch.nn.functional.silu(x)

def _sigmoid(x):
    return torch.sigmoid(x)

def _layernorm(x, axis=-1, eps=1e-05):
    m = x.mean(dim=axis, keepdim=True)
    v = x.var(dim=axis, keepdim=True, unbiased=False)
    return (x - m) / torch.sqrt(v + eps)

def _scatter_add(tgt, idx, src, axis=0):
    return tgt.clone().index_add_(axis, idx, src)

def _segment_sum(src, seg, n):
    out = torch.zeros((n,) + src.shape[1:], dtype=src.dtype)
    return out.index_add_(0, seg, src)

def _pad(x, pw):
    flat = tuple((v for pair in reversed(pw) for v in pair))
    return torch.nn.functional.pad(x, flat)
kernel_name = 'interleave_layers__sliding_block__memory_aug_recurrent_mem_tr__prompt'

def setup_inputs():

    _w = lambda a: (lambda t: t.to(torch.bfloat16) if t.is_floating_point() else t)(torch.as_tensor(a))

    def _A_setup():
        B, S, D = (1, 2048, 448)
        return {'x': _w((lambda *s: torch.randn(*s, dtype=torch.bfloat16) * 0.05)(B, S, D)), 'wqkv': _w((lambda *s: torch.randn(*s, dtype=torch.bfloat16) * 0.05)(D, 3 * D)), 'wo': _w((lambda *s: torch.randn(*s, dtype=torch.bfloat16) * 0.05)(D, D))}
    _A_in = _A_setup()

    def _B_setup():
        B, S, Dm = (1, 2048, 448)
        H, Dh = (16, 256)
        M, seg = (8, 32)
        seg = min(seg, S)
        S = S // seg * seg
        return {'x': _w((lambda *s: torch.randn(*s, dtype=torch.bfloat16) * 0.05)(B, S, Dm)), 'mem0': _w((lambda *s: torch.randn(*s, dtype=torch.bfloat16) * 0.8)(B, M, Dm)), 'Wq': _w((lambda *s: torch.randn(*s, dtype=torch.bfloat16) * 1.6)(Dm, H, Dh) * Dm ** (-0.5)), 'Wk': _w((lambda *s: torch.randn(*s, dtype=torch.bfloat16) * 1.6)(Dm, H, Dh) * Dm ** (-0.5)), 'Wv': _w((lambda *s: torch.randn(*s, dtype=torch.bfloat16) * 0.8)(Dm, H, Dh) * Dm ** (-0.5)), 'Wo': _w((lambda *s: torch.randn(*s, dtype=torch.bfloat16) * 0.8)(H, Dh, Dm) * (H * Dh) ** (-0.5)), 'seg_len': seg}
    _B_in = _B_setup()
    return {'A_x': _A_in['x'], 'A_wqkv': _A_in['wqkv'], 'A_wo': _A_in['wo'], 'B_x': _B_in['x'], 'B_mem0': _B_in['mem0'], 'B_Wq': _B_in['Wq'], 'B_Wk': _B_in['Wk'], 'B_Wv': _B_in['Wv'], 'B_Wo': _B_in['Wo'], 'B_seg_len': _B_in['seg_len']}

def reference(A_x, A_wqkv, A_wo, B_x, B_mem0, B_Wq, B_Wk, B_Wv, B_Wo, B_seg_len):

    def _A_ref(x, wqkv, wo):
        B, S, D = x.shape
        H = 16
        Dh = D // H
        W = 256
        qkv = (lambda x, *d: x.permute(*d))((x @ wqkv).reshape(B, S, 3, H, Dh), 2, 0, 3, 1, 4)
        q, k, v = (qkv[0], qkv[1], qkv[2])
        scores = torch.einsum('bhqd,bhkd->bhqk', q, k) * Dh ** (-0.5)
        idx = torch.arange(S)
        mask = (idx[:, None] - idx[None, :] >= 0) & (idx[:, None] - idx[None, :] < W)
        scores = torch.where(mask[None, None], scores, -1000000000.0)
        p = _softmax(scores, axis=-1)
        o = torch.einsum('bhqk,bhkd->bhqd', p, v)
        return (lambda x, *d: x.permute(*d))(o, 0, 2, 1, 3).reshape(B, S, D) @ wo

    def _B_ref(x, mem0, Wq, Wk, Wv, Wo, seg_len):
        B, S, Dm = x.shape
        H, Dh = (Wq.shape[1], Wq.shape[2])
        M = mem0.shape[1]
        scale = Dh ** (-0.5)
        n_seg = S // seg_len
        L = M + seg_len
        idx = torch.arange(L)
        mask = (idx[:, None] < M) | (idx[:, None] >= idx[None, :])
        mem = mem0
        outs = []
        for s in range(n_seg):
            xs = x[:, s * seg_len:(s + 1) * seg_len, :].clone()
            h = torch.concatenate([mem, xs], axis=1)
            q = torch.einsum('btd,dhe->bhte', h, Wq)
            k = torch.einsum('btd,dhe->bhte', h, Wk)
            v = torch.einsum('btd,dhe->bhte', h, Wv)
            scores = torch.einsum('bhqe,bhke->bhqk', q, k) * scale
            scores = torch.where(mask[None, None], scores, -1000000000.0)
            p = _softmax(scores, axis=-1)
            o = torch.einsum('bhqk,bhke->bhqe', p, v)
            o = torch.einsum('bhte,hed->btd', o, Wo)
            mem = o[:, :M, :].clone()
            outs.append(o[:, M:, :])
        return torch.concatenate(outs, axis=1)
    x = A_x
    x = x + _A_ref(_layernorm(x, axis=-1), A_wqkv, A_wo)
    x = x + _B_ref(_layernorm(x, axis=-1), B_mem0, B_Wq, B_Wk, B_Wv, B_Wo, B_seg_len)
    x = x + _A_ref(_layernorm(x, axis=-1), A_wqkv, A_wo)
    x = x + _B_ref(_layernorm(x, axis=-1), B_mem0, B_Wq, B_Wk, B_Wv, B_Wo, B_seg_len)
    return x
```

```asm
; @launch kernel=prep_kernel grid=(487,1,1) block=(256,1,1) lds=69632
; @launch kernel=mega_kernel grid=(256,1,1) block=(256,1,1) lds=159808
.amdgcn_target "amdgcn-amd-amdhsa--gfx950"
.text
.globl prep_kernel
.p2align 8
.type prep_kernel,@function
prep_kernel:
    s_cmp_ge_u32 s2, 487
    s_cbranch_scc1 prep_kernel_done
    s_load_dwordx16 s[16:31], s[0:1], 0
    s_load_dwordx8 s[32:39], s[0:1], 64
    s_load_dwordx2 s[40:41], s[0:1], 96
    v_lshrrev_b32 v1, 6, v0
    v_and_b32 v62, 63, v0
    s_nop 0
    v_readfirstlane_b32 s3, v1
    v_lshlrev_b32 v63, 2, v62
    v_and_b32 v2, 31, v62
    v_lshrrev_b32 v3, 5, v62
    s_lshl_b32 s4, s2, 2
    s_add_u32 s4, s4, s3
    v_lshlrev_b32 v5, 4, v62
    s_waitcnt lgkmcnt(0)
    s_mov_b32 s44, s40
    s_mov_b32 s45, s41
    s_mov_b32 s46, 268435456
    s_mov_b32 s47, 0x00020000
    s_cmp_ge_u32 s4, 1948
    s_cbranch_scc1 prep_kernel_done
    s_cmp_ge_u32 s4, 1788
    s_cbranch_scc1 prep_kernel_f5
    s_cmp_ge_u32 s4, 1532
    s_cbranch_scc1 prep_kernel_e4
    s_cmp_ge_u32 s4, 1504
    s_cbranch_scc1 prep_kernel_d3
    s_cmp_ge_u32 s4, 1408
    s_cbranch_scc1 prep_kernel_c2
    s_cmp_ge_u32 s4, 896
    s_cbranch_scc1 prep_kernel_a1
    s_and_b32 s7, s4, 3
    s_and_b32 s6, s2, 7
    s_lshr_b32 s13, s2, 3
    s_cmp_ge_u32 s13, 14
    s_cselect_b32 s5, 8, 0
    s_cselect_b32 s9, 14, 0
    s_add_u32 s6, s6, s5
    s_sub_u32 s13, s13, s9
    s_mul_i32 s5, s6, 14
    s_add_u32 s5, s5, s13
    s_lshl_b32 s8, s7, 2
    s_cmp_eq_u32 s7, 3
    s_cselect_b32 s8, 11, s8
    s_cmp_ge_u32 s7, 2
    s_cselect_b32 s19, 3, 4
    s_mov_b32 s48, s32
    s_mov_b32 s49, s33
    s_mov_b32 s50, 3670016
    s_mov_b32 s51, 0x00020000
    s_mov_b32 s56, s30
    s_mov_b32 s57, s31
    s_mov_b32 s58, 3670016
    s_mov_b32 s59, 0x00020000
    s_mul_i32 s9, s6, 229376
    s_lshl_b32 s10, s13, 6
    s_add_u32 s9, s9, s10
    s_mov_b32 s14, s9
    s_lshl_b32 s10, s8, 18
    s_lshl_b32 s9, s6, 9
    s_add_u32 s10, s10, s9
    s_add_u32 s11, s5, 256
    s_mul_i32 s11, s11, 28672
    s_lshl_b32 s9, s8, 11
    s_add_u32 s11, s11, s9
    s_add_u32 s11, s11, 8257536
    v_lshlrev_b32 v7, 4, v2
    v_lshl_add_u32 v7, v3, 3, v7
    v_lshlrev_b32 v6, 13, v3
    v_lshl_add_u32 v6, v2, 4, v6
    v_mul_u32_u24 v13, 528, v3
    v_lshl_add_u32 v13, v2, 4, v13
    v_mul_u32_u24 v14, 528, v2
    v_lshl_add_u32 v14, v3, 4, v14
    s_mul_i32 s62, s3, 17408
    v_add_u32 v13, s62, v13
    v_add_u32 v14, s62, v14
    s_add_u32 s12, s10, 0
    buffer_load_dwordx4 v[192:195], v6, s[56:59], s12 offen
    s_add_u32 s12, s12, 16384
    buffer_load_dwordx4 v[196:199], v6, s[56:59], s12 offen
    s_add_u32 s12, s12, 16384
    buffer_load_dwordx4 v[200:203], v6, s[56:59], s12 offen
    s_add_u32 s12, s12, 16384
    buffer_load_dwordx4 v[204:207], v6, s[56:59], s12 offen
    s_add_u32 s12, s12, 16384
    buffer_load_dwordx4 v[208:211], v6, s[56:59], s12 offen
    s_add_u32 s12, s12, 16384
    buffer_load_dwordx4 v[212:215], v6, s[56:59], s12 offen
    s_add_u32 s12, s12, 16384
    buffer_load_dwordx4 v[216:219], v6, s[56:59], s12 offen
    s_add_u32 s12, s12, 16384
    buffer_load_dwordx4 v[220:223], v6, s[56:59], s12 offen
    s_add_u32 s12, s12, 16384
    buffer_load_dwordx4 v[224:227], v6, s[56:59], s12 offen
    s_add_u32 s12, s12, 16384
    buffer_load_dwordx4 v[228:231], v6, s[56:59], s12 offen
    s_add_u32 s12, s12, 16384
    buffer_load_dwordx4 v[232:235], v6, s[56:59], s12 offen
    s_add_u32 s12, s12, 16384
    buffer_load_dwordx4 v[236:239], v6, s[56:59], s12 offen
    s_add_u32 s12, s12, 16384
    buffer_load_dwordx4 v[240:243], v6, s[56:59], s12 offen
    s_add_u32 s12, s12, 16384
    buffer_load_dwordx4 v[244:247], v6, s[56:59], s12 offen
    s_add_u32 s12, s12, 16384
    buffer_load_dwordx4 v[248:251], v6, s[56:59], s12 offen
    s_add_u32 s12, s12, 16384
    buffer_load_dwordx4 v[252:255], v6, s[56:59], s12 offen
    s_add_u32 s12, s12, 16384
    v_lshrrev_b32 v8, 2, v62
    s_mov_b32 s61, 896
    v_mul_lo_u32 v8, v8, s61
    v_and_b32 v9, 3, v62
    v_lshl_add_u32 v8, v9, 4, v8
    s_mul_i32 s62, s3, 17408
    v_add_u32 v10, s62, v5
    v_lshrrev_b32 v11, 5, v62
    v_lshlrev_b32 v11, 3, v11
    v_bfe_u32 v12, v62, 2, 2
    v_add_u32 v11, v11, v12
    v_lshlrev_b32 v11, 6, v11
    v_bfe_u32 v12, v62, 4, 1
    v_lshl_add_u32 v11, v12, 5, v11
    v_lshl_add_u32 v11, v9, 3, v11
    v_add_u32 v11, s62, v11
    s_mov_b32 s60, s14
    buffer_load_dwordx4 v[64:67], v8, s[48:51], s60 offen
    s_add_u32 s60, s60, 14336
    buffer_load_dwordx4 v[68:71], v8, s[48:51], s60 offen
    s_add_u32 s60, s60, 14336
    buffer_load_dwordx4 v[72:75], v8, s[48:51], s60 offen
    s_add_u32 s60, s60, 14336
    buffer_load_dwordx4 v[76:79], v8, s[48:51], s60 offen
    s_add_u32 s60, s60, 14336
    buffer_load_dwordx4 v[80:83], v8, s[48:51], s60 offen
    s_add_u32 s60, s60, 14336
    buffer_load_dwordx4 v[84:87], v8, s[48:51], s60 offen
    s_add_u32 s60, s60, 14336
    buffer_load_dwordx4 v[88:91], v8, s[48:51], s60 offen
    s_add_u32 s60, s60, 14336
    buffer_load_dwordx4 v[92:95], v8, s[48:51], s60 offen
    s_add_u32 s60, s60, 14336
    buffer_load_dwordx4 v[96:99], v8, s[48:51], s60 offen
    s_add_u32 s60, s60, 14336
    buffer_load_dwordx4 v[100:103], v8, s[48:51], s60 offen
    s_add_u32 s60, s60, 14336
    buffer_load_dwordx4 v[104:107], v8, s[48:51], s60 offen
    s_add_u32 s60, s60, 14336
    buffer_load_dwordx4 v[108:111], v8, s[48:51], s60 offen
    s_add_u32 s60, s60, 14336
    buffer_load_dwordx4 v[112:115], v8, s[48:51], s60 offen
    s_add_u32 s60, s60, 14336
    buffer_load_dwordx4 v[116:119], v8, s[48:51], s60 offen
    s_add_u32 s60, s60, 14336
    buffer_load_dwordx4 v[120:123], v8, s[48:51], s60 offen
    s_add_u32 s60, s60, 14336
    buffer_load_dwordx4 v[124:127], v8, s[48:51], s60 offen
    s_add_u32 s60, s60, 14336
    s_waitcnt vmcnt(15)
    ds_write_b128 v10, v[64:67] offset:0
    s_waitcnt vmcnt(14)
    ds_write_b128 v10, v[68:71] offset:1024
    s_waitcnt vmcnt(13)
    ds_write_b128 v10, v[72:75] offset:2048
    s_waitcnt vmcnt(12)
    ds_write_b128 v10, v[76:79] offset:3072
    s_waitcnt vmcnt(11)
    ds_write_b128 v10, v[80:83] offset:4096
    s_waitcnt vmcnt(10)
    ds_write_b128 v10, v[84:87] offset:5120
    s_waitcnt vmcnt(9)
    ds_write_b128 v10, v[88:91] offset:6144
    s_waitcnt vmcnt(8)
    ds_write_b128 v10, v[92:95] offset:7168
    s_waitcnt vmcnt(7)
    ds_write_b128 v10, v[96:99] offset:8192
    s_waitcnt vmcnt(6)
    ds_write_b128 v10, v[100:103] offset:9216
    s_waitcnt vmcnt(5)
    ds_write_b128 v10, v[104:107] offset:10240
    s_waitcnt vmcnt(4)
    ds_write_b128 v10, v[108:111] offset:11264
    s_waitcnt vmcnt(3)
    ds_write_b128 v10, v[112:115] offset:12288
    s_waitcnt vmcnt(2)
    ds_write_b128 v10, v[116:119] offset:13312
    s_waitcnt vmcnt(1)
    ds_write_b128 v10, v[120:123] offset:14336
    s_waitcnt vmcnt(0)
    ds_write_b128 v10, v[124:127] offset:15360
    s_waitcnt lgkmcnt(0)
    ds_read_b64_tr_b16 v[64:65], v11 offset:0
    ds_read_b64_tr_b16 v[66:67], v11 offset:256
    ds_read_b64_tr_b16 v[68:69], v11 offset:1024
    ds_read_b64_tr_b16 v[70:71], v11 offset:1280
    ds_read_b64_tr_b16 v[72:73], v11 offset:2048
    ds_read_b64_tr_b16 v[74:75], v11 offset:2304
    ds_read_b64_tr_b16 v[76:77], v11 offset:3072
    ds_read_b64_tr_b16 v[78:79], v11 offset:3328
    s_waitcnt lgkmcnt(0)
    ds_read_b64_tr_b16 v[80:81], v11 offset:4096
    ds_read_b64_tr_b16 v[82:83], v11 offset:4352
    ds_read_b64_tr_b16 v[84:85], v11 offset:5120
    ds_read_b64_tr_b16 v[86:87], v11 offset:5376
    ds_read_b64_tr_b16 v[88:89], v11 offset:6144
    ds_read_b64_tr_b16 v[90:91], v11 offset:6400
    ds_read_b64_tr_b16 v[92:93], v11 offset:7168
    ds_read_b64_tr_b16 v[94:95], v11 offset:7424
    s_waitcnt lgkmcnt(0)
    ds_read_b64_tr_b16 v[96:97], v11 offset:8192
    ds_read_b64_tr_b16 v[98:99], v11 offset:8448
    ds_read_b64_tr_b16 v[100:101], v11 offset:9216
    ds_read_b64_tr_b16 v[102:103], v11 offset:9472
    ds_read_b64_tr_b16 v[104:105], v11 offset:10240
    ds_read_b64_tr_b16 v[106:107], v11 offset:10496
    ds_read_b64_tr_b16 v[108:109], v11 offset:11264
    ds_read_b64_tr_b16 v[110:111], v11 offset:11520
    s_waitcnt lgkmcnt(0)
    ds_read_b64_tr_b16 v[112:113], v11 offset:12288
    ds_read_b64_tr_b16 v[114:115], v11 offset:12544
    ds_read_b64_tr_b16 v[116:117], v11 offset:13312
    ds_read_b64_tr_b16 v[118:119], v11 offset:13568
    ds_read_b64_tr_b16 v[120:121], v11 offset:14336
    ds_read_b64_tr_b16 v[122:123], v11 offset:14592
    ds_read_b64_tr_b16 v[124:125], v11 offset:15360
    ds_read_b64_tr_b16 v[126:127], v11 offset:15616
    s_waitcnt lgkmcnt(0)
    s_waitcnt lgkmcnt(0)
    s_waitcnt vmcnt(0)
    ds_write_b128 v13, v[192:195] offset:0
    ds_write_b128 v13, v[196:199] offset:1056
    ds_write_b128 v13, v[200:203] offset:2112
    ds_write_b128 v13, v[204:207] offset:3168
    ds_write_b128 v13, v[208:211] offset:4224
    ds_write_b128 v13, v[212:215] offset:5280
    ds_write_b128 v13, v[216:219] offset:6336
    ds_write_b128 v13, v[220:223] offset:7392
    ds_write_b128 v13, v[224:227] offset:8448
    ds_write_b128 v13, v[228:231] offset:9504
    ds_write_b128 v13, v[232:235] offset:10560
    ds_write_b128 v13, v[236:239] offset:11616
    ds_write_b128 v13, v[240:243] offset:12672
    ds_write_b128 v13, v[244:247] offset:13728
    ds_write_b128 v13, v[248:251] offset:14784
    ds_write_b128 v13, v[252:255] offset:15840
    s_waitcnt lgkmcnt(0)
    s_add_u32 s12, s10, 262144
    buffer_load_dwordx4 v[192:195], v6, s[56:59], s12 offen
    s_add_u32 s12, s12, 16384
    buffer_load_dwordx4 v[196:199], v6, s[56:59], s12 offen
    s_add_u32 s12, s12, 16384
    buffer_load_dwordx4 v[200:203], v6, s[56:59], s12 offen
    s_add_u32 s12, s12, 16384
    buffer_load_dwordx4 v[204:207], v6, s[56:59], s12 offen
    s_add_u32 s12, s12, 16384
    buffer_load_dwordx4 v[208:211], v6, s[56:59], s12 offen
    s_add_u32 s12, s12, 16384
    buffer_load_dwordx4 v[212:215], v6, s[56:59], s12 offen
    s_add_u32 s12, s12, 16384
    buffer_load_dwordx4 v[216:219], v6, s[56:59], s12 offen
    s_add_u32 s12, s12, 16384
    buffer_load_dwordx4 v[220:223], v6, s[56:59], s12 offen
    s_add_u32 s12, s12, 16384
    buffer_load_dwordx4 v[224:227], v6, s[56:59], s12 offen
    s_add_u32 s12, s12, 16384
    buffer_load_dwordx4 v[228:231], v6, s[56:59], s12 offen
    s_add_u32 s12, s12, 16384
    buffer_load_dwordx4 v[232:235], v6, s[56:59], s12 offen
    s_add_u32 s12, s12, 16384
    buffer_load_dwordx4 v[236:239], v6, s[56:59], s12 offen
    s_add_u32 s12, s12, 16384
    buffer_load_dwordx4 v[240:243], v6, s[56:59], s12 offen
    s_add_u32 s12, s12, 16384
    buffer_load_dwordx4 v[244:247], v6, s[56:59], s12 offen
    s_add_u32 s12, s12, 16384
    buffer_load_dwordx4 v[248:251], v6, s[56:59], s12 offen
    s_add_u32 s12, s12, 16384
    buffer_load_dwordx4 v[252:255], v6, s[56:59], s12 offen
    s_add_u32 s12, s12, 16384
    ds_read_b128 v[128:131], v14 offset:0
    ds_read_b128 v[132:135], v14 offset:32
    ds_read_b128 v[136:139], v14 offset:64
    ds_read_b128 v[140:143], v14 offset:96
    ds_read_b128 v[144:147], v14 offset:128
    ds_read_b128 v[148:151], v14 offset:160
    ds_read_b128 v[152:155], v14 offset:192
    ds_read_b128 v[156:159], v14 offset:224
    ds_read_b128 v[160:163], v14 offset:256
    ds_read_b128 v[164:167], v14 offset:288
    ds_read_b128 v[168:171], v14 offset:320
    ds_read_b128 v[172:175], v14 offset:352
    ds_read_b128 v[176:179], v14 offset:384
    ds_read_b128 v[180:183], v14 offset:416
    ds_read_b128 v[184:187], v14 offset:448
    ds_read_b128 v[188:191], v14 offset:480
    s_waitcnt lgkmcnt(0)
    v_mfma_f32_32x32x16_bf16 v[16:31], v[128:131], v[64:67], 0
    v_mfma_f32_32x32x16_bf16 v[16:31], v[132:135], v[68:71], v[16:31]
    v_mfma_f32_32x32x16_bf16 v[16:31], v[136:139], v[72:75], v[16:31]
    v_mfma_f32_32x32x16_bf16 v[16:31], v[140:143], v[76:79], v[16:31]
    v_mfma_f32_32x32x16_bf16 v[16:31], v[144:147], v[80:83], v[16:31]
    v_mfma_f32_32x32x16_bf16 v[16:31], v[148:151], v[84:87], v[16:31]
    v_mfma_f32_32x32x16_bf16 v[16:31], v[152:155], v[88:91], v[16:31]
    v_mfma_f32_32x32x16_bf16 v[16:31], v[156:159], v[92:95], v[16:31]
    v_mfma_f32_32x32x16_bf16 v[16:31], v[160:163], v[96:99], v[16:31]
    v_mfma_f32_32x32x16_bf16 v[16:31], v[164:167], v[100:103], v[16:31]
    v_mfma_f32_32x32x16_bf16 v[16:31], v[168:171], v[104:107], v[16:31]
    v_mfma_f32_32x32x16_bf16 v[16:31], v[172:175], v[108:111], v[16:31]
    v_mfma_f32_32x32x16_bf16 v[16:31], v[176:179], v[112:115], v[16:31]
    v_mfma_f32_32x32x16_bf16 v[16:31], v[180:183], v[116:119], v[16:31]
    v_mfma_f32_32x32x16_bf16 v[16:31], v[184:187], v[120:123], v[16:31]
    v_mfma_f32_32x32x16_bf16 v[16:31], v[188:191], v[124:127], v[16:31]
    s_nop 15
    s_nop 3
    v_cvt_pk_bf16_f32 v32, v16, v17
    v_cvt_pk_bf16_f32 v33, v18, v19
    v_cvt_pk_bf16_f32 v34, v20, v21
    v_cvt_pk_bf16_f32 v35, v22, v23
    v_cvt_pk_bf16_f32 v36, v24, v25
    v_cvt_pk_bf16_f32 v37, v26, v27
    v_cvt_pk_bf16_f32 v38, v28, v29
    v_cvt_pk_bf16_f32 v39, v30, v31
    buffer_store_dwordx2 v[32:33], v7, s[44:47], s11 offen offset:0
    buffer_store_dwordx2 v[34:35], v7, s[44:47], s11 offen offset:512
    buffer_store_dwordx2 v[36:37], v7, s[44:47], s11 offen offset:1024
    buffer_store_dwordx2 v[38:39], v7, s[44:47], s11 offen offset:1536
    s_add_u32 s11, s11, 2048
    s_waitcnt vmcnt(4)
    ds_write_b128 v13, v[192:195] offset:0
    ds_write_b128 v13, v[196:199] offset:1056
    ds_write_b128 v13, v[200:203] offset:2112
    ds_write_b128 v13, v[204:207] offset:3168
    ds_write_b128 v13, v[208:211] offset:4224
    ds_write_b128 v13, v[212:215] offset:5280
    ds_write_b128 v13, v[216:219] offset:6336
    ds_write_b128 v13, v[220:223] offset:7392
    ds_write_b128 v13, v[224:227] offset:8448
    ds_write_b128 v13, v[228:231] offset:9504
    ds_write_b128 v13, v[232:235] offset:10560
    ds_write_b128 v13, v[236:239] offset:11616
    ds_write_b128 v13, v[240:243] offset:12672
    ds_write_b128 v13, v[244:247] offset:13728
    ds_write_b128 v13, v[248:251] offset:14784
    ds_write_b128 v13, v[252:255] offset:15840
    s_waitcnt lgkmcnt(0)
    s_add_u32 s12, s10, 524288
    buffer_load_dwordx4 v[192:195], v6, s[56:59], s12 offen
    s_add_u32 s12, s12, 16384
    buffer_load_dwordx4 v[196:199], v6, s[56:59], s12 offen
    s_add_u32 s12, s12, 16384
    buffer_load_dwordx4 v[200:203], v6, s[56:59], s12 offen
    s_add_u32 s12, s12, 16384
    buffer_load_dwordx4 v[204:207], v6, s[56:59], s12 offen
    s_add_u32 s12, s12, 16384
    buffer_load_dwordx4 v[208:211], v6, s[56:59], s12 offen
    s_add_u32 s12, s12, 16384
    buffer_load_dwordx4 v[212:215], v6, s[56:59], s12 offen
    s_add_u32 s12, s12, 16384
    buffer_load_dwordx4 v[216:219], v6, s[56:59], s12 offen
    s_add_u32 s12, s12, 16384
    buffer_load_dwordx4 v[220:223], v6, s[56:59], s12 offen
    s_add_u32 s12, s12, 16384
    buffer_load_dwordx4 v[224:227], v6, s[56:59], s12 offen
    s_add_u32 s12, s12, 16384
    buffer_load_dwordx4 v[228:231], v6, s[56:59], s12 offen
    s_add_u32 s12, s12, 16384
    buffer_load_dwordx4 v[232:235], v6, s[56:59], s12 offen
    s_add_u32 s12, s12, 16384
    buffer_load_dwordx4 v[236:239], v6, s[56:59], s12 offen
    s_add_u32 s12, s12, 16384
    buffer_load_dwordx4 v[240:243], v6, s[56:59], s12 offen
    s_add_u32 s12, s12, 16384
    buffer_load_dwordx4 v[244:247], v6, s[56:59], s12 offen
    s_add_u32 s12, s12, 16384
    buffer_load_dwordx4 v[248:251], v6, s[56:59], s12 offen
    s_add_u32 s12, s12, 16384
    buffer_load_dwordx4 v[252:255], v6, s[56:59], s12 offen
    s_add_u32 s12, s12, 16384
    ds_read_b128 v[128:131], v14 offset:0
    ds_read_b128 v[132:135], v14 offset:32
    ds_read_b128 v[136:139], v14 offset:64
    ds_read_b128 v[140:143], v14 offset:96
    ds_read_b128 v[144:147], v14 offset:128
    ds_read_b128 v[148:151], v14 offset:160
    ds_read_b128 v[152:155], v14 offset:192
    ds_read_b128 v[156:159], v14 offset:224
    ds_read_b128 v[160:163], v14 offset:256
    ds_read_b128 v[164:167], v14 offset:288
    ds_read_b128 v[168:171], v14 offset:320
    ds_read_b128 v[172:175], v14 offset:352
    ds_read_b128 v[176:179], v14 offset:384
    ds_read_b128 v[180:183], v14 offset:416
    ds_read_b128 v[184:187], v14 offset:448
    ds_read_b128 v[188:191], v14 offset:480
    s_waitcnt lgkmcnt(0)
    v_mfma_f32_32x32x16_bf16 v[16:31], v[128:131], v[64:67], 0
    v_mfma_f32_32x32x16_bf16 v[16:31], v[132:135], v[68:71], v[16:31]
    v_mfma_f32_32x32x16_bf16 v[16:31], v[136:139], v[72:75], v[16:31]
    v_mfma_f32_32x32x16_bf16 v[16:31], v[140:143], v[76:79], v[16:31]
    v_mfma_f32_32x32x16_bf16 v[16:31], v[144:147], v[80:83], v[16:31]
    v_mfma_f32_32x32x16_bf16 v[16:31], v[148:151], v[84:87], v[16:31]
    v_mfma_f32_32x32x16_bf16 v[16:31], v[152:155], v[88:91], v[16:31]
    v_mfma_f32_32x32x16_bf16 v[16:31], v[156:159], v[92:95], v[16:31]
    v_mfma_f32_32x32x16_bf16 v[16:31], v[160:163], v[96:99], v[16:31]
    v_mfma_f32_32x32x16_bf16 v[16:31], v[164:167], v[100:103], v[16:31]
    v_mfma_f32_32x32x16_bf16 v[16:31], v[168:171], v[104:107], v[16:31]
    v_mfma_f32_32x32x16_bf16 v[16:31], v[172:175], v[108:111], v[16:31]
    v_mfma_f32_32x32x16_bf16 v[16:31], v[176:179], v[112:115], v[16:31]
    v_mfma_f32_32x32x16_bf16 v[16:31], v[180:183], v[116:119], v[16:31]
    v_mfma_f32_32x32x16_bf16 v[16:31], v[184:187], v[120:123], v[16:31]
    v_mfma_f32_32x32x16_bf16 v[16:31], v[188:191], v[124:127], v[16:31]
    s_nop 15
    s_nop 3
    v_cvt_pk_bf16_f32 v32, v16, v17
    v_cvt_pk_bf16_f32 v33, v18, v19
    v_cvt_pk_bf16_f32 v34, v20, v21
    v_cvt_pk_bf16_f32 v35, v22, v23
    v_cvt_pk_bf16_f32 v36, v24, v25
    v_cvt_pk_bf16_f32 v37, v26, v27
    v_cvt_pk_bf16_f32 v38, v28, v29
    v_cvt_pk_bf16_f32 v39, v30, v31
    buffer_store_dwordx2 v[32:33], v7, s[44:47], s11 offen offset:0
    buffer_store_dwordx2 v[34:35], v7, s[44:47], s11 offen offset:512
    buffer_store_dwordx2 v[36:37], v7, s[44:47], s11 offen offset:1024
    buffer_store_dwordx2 v[38:39], v7, s[44:47], s11 offen offset:1536
    s_add_u32 s11, s11, 2048
    s_waitcnt vmcnt(4)
    ds_write_b128 v13, v[192:195] offset:0
    ds_write_b128 v13, v[196:199] offset:1056
    ds_write_b128 v13, v[200:203] offset:2112
    ds_write_b128 v13, v[204:207] offset:3168
    ds_write_b128 v13, v[208:211] offset:4224
    ds_write_b128 v13, v[212:215] offset:5280
    ds_write_b128 v13, v[216:219] offset:6336
    ds_write_b128 v13, v[220:223] offset:7392
    ds_write_b128 v13, v[224:227] offset:8448
    ds_write_b128 v13, v[228:231] offset:9504
    ds_write_b128 v13, v[232:235] offset:10560
    ds_write_b128 v13, v[236:239] offset:11616
    ds_write_b128 v13, v[240:243] offset:12672
    ds_write_b128 v13, v[244:247] offset:13728
    ds_write_b128 v13, v[248:251] offset:14784
    ds_write_b128 v13, v[252:255] offset:15840
    s_waitcnt lgkmcnt(0)
    s_add_u32 s12, s10, 786432
    buffer_load_dwordx4 v[192:195], v6, s[56:59], s12 offen
    s_add_u32 s12, s12, 16384
    buffer_load_dwordx4 v[196:199], v6, s[56:59], s12 offen
    s_add_u32 s12, s12, 16384
    buffer_load_dwordx4 v[200:203], v6, s[56:59], s12 offen
    s_add_u32 s12, s12, 16384
    buffer_load_dwordx4 v[204:207], v6, s[56:59], s12 offen
    s_add_u32 s12, s12, 16384
    buffer_load_dwordx4 v[208:211], v6, s[56:59], s12 offen
    s_add_u32 s12, s12, 16384
    buffer_load_dwordx4 v[212:215], v6, s[56:59], s12 offen
    s_add_u32 s12, s12, 16384
    buffer_load_dwordx4 v[216:219], v6, s[56:59], s12 offen
    s_add_u32 s12, s12, 16384
    buffer_load_dwordx4 v[220:223], v6, s[56:59], s12 offen
    s_add_u32 s12, s12, 16384
    buffer_load_dwordx4 v[224:227], v6, s[56:59], s12 offen
    s_add_u32 s12, s12, 16384
    buffer_load_dwordx4 v[228:231], v6, s[56:59], s12 offen
    s_add_u32 s12, s12, 16384
    buffer_load_dwordx4 v[232:235], v6, s[56:59], s12 offen
    s_add_u32 s12, s12, 16384
    buffer_load_dwordx4 v[236:239], v6, s[56:59], s12 offen
    s_add_u32 s12, s12, 16384
    buffer_load_dwordx4 v[240:243], v6, s[56:59], s12 offen
    s_add_u32 s12, s12, 16384
    buffer_load_dwordx4 v[244:247], v6, s[56:59], s12 offen
    s_add_u32 s12, s12, 16384
    buffer_load_dwordx4 v[248:251], v6, s[56:59], s12 offen
    s_add_u32 s12, s12, 16384
    buffer_load_dwordx4 v[252:255], v6, s[56:59], s12 offen
    s_add_u32 s12, s12, 16384
    ds_read_b128 v[128:131], v14 offset:0
    ds_read_b128 v[132:135], v14 offset:32
    ds_read_b128 v[136:139], v14 offset:64
    ds_read_b128 v[140:143], v14 offset:96
    ds_read_b128 v[144:147], v14 offset:128
    ds_read_b128 v[148:151], v14 offset:160
    ds_read_b128 v[152:155], v14 offset:192
    ds_read_b128 v[156:159], v14 offset:224
    ds_read_b128 v[160:163], v14 offset:256
    ds_read_b128 v[164:167], v14 offset:288
    ds_read_b128 v[168:171], v14 offset:320
    ds_read_b128 v[172:175], v14 offset:352
    ds_read_b128 v[176:179], v14 offset:384
    ds_read_b128 v[180:183], v14 offset:416
    ds_read_b128 v[184:187], v14 offset:448
    ds_read_b128 v[188:191], v14 offset:480
    s_waitcnt lgkmcnt(0)
    v_mfma_f32_32x32x16_bf16 v[16:31], v[128:131], v[64:67], 0
    v_mfma_f32_32x32x16_bf16 v[16:31], v[132:135], v[68:71], v[16:31]
    v_mfma_f32_32x32x16_bf16 v[16:31], v[136:139], v[72:75], v[16:31]
    v_mfma_f32_32x32x16_bf16 v[16:31], v[140:143], v[76:79], v[16:31]
    v_mfma_f32_32x32x16_bf16 v[16:31], v[144:147], v[80:83], v[16:31]
    v_mfma_f32_32x32x16_bf16 v[16:31], v[148:151], v[84:87], v[16:31]
    v_mfma_f32_32x32x16_bf16 v[16:31], v[152:155], v[88:91], v[16:31]
    v_mfma_f32_32x32x16_bf16 v[16:31], v[156:159], v[92:95], v[16:31]
    v_mfma_f32_32x32x16_bf16 v[16:31], v[160:163], v[96:99], v[16:31]
    v_mfma_f32_32x32x16_bf16 v[16:31], v[164:167], v[100:103], v[16:31]
    v_mfma_f32_32x32x16_bf16 v[16:31], v[168:171], v[104:107], v[16:31]
    v_mfma_f32_32x32x16_bf16 v[16:31], v[172:175], v[108:111], v[16:31]
    v_mfma_f32_32x32x16_bf16 v[16:31], v[176:179], v[112:115], v[16:31]
    v_mfma_f32_32x32x16_bf16 v[16:31], v[180:183], v[116:119], v[16:31]
    v_mfma_f32_32x32x16_bf16 v[16:31], v[184:187], v[120:123], v[16:31]
    v_mfma_f32_32x32x16_bf16 v[16:31], v[188:191], v[124:127], v[16:31]
    s_nop 15
    s_nop 3
    v_cvt_pk_bf16_f32 v32, v16, v17
    v_cvt_pk_bf16_f32 v33, v18, v19
    v_cvt_pk_bf16_f32 v34, v20, v21
    v_cvt_pk_bf16_f32 v35, v22, v23
    v_cvt_pk_bf16_f32 v36, v24, v25
    v_cvt_pk_bf16_f32 v37, v26, v27
    v_cvt_pk_bf16_f32 v38, v28, v29
    v_cvt_pk_bf16_f32 v39, v30, v31
    buffer_store_dwordx2 v[32:33], v7, s[44:47], s11 offen offset:0
    buffer_store_dwordx2 v[34:35], v7, s[44:47], s11 offen offset:512
    buffer_store_dwordx2 v[36:37], v7, s[44:47], s11 offen offset:1024
    buffer_store_dwordx2 v[38:39], v7, s[44:47], s11 offen offset:1536
    s_add_u32 s11, s11, 2048
    s_cmp_lt_u32 s19, 4
    s_cbranch_scc1 prep_kernel_done
    s_waitcnt vmcnt(4)
    ds_write_b128 v13, v[192:195] offset:0
    ds_write_b128 v13, v[196:199] offset:1056
    ds_write_b128 v13, v[200:203] offset:2112
    ds_write_b128 v13, v[204:207] offset:3168
    ds_write_b128 v13, v[208:211] offset:4224
    ds_write_b128 v13, v[212:215] offset:5280
    ds_write_b128 v13, v[216:219] offset:6336
    ds_write_b128 v13, v[220:223] offset:7392
    ds_write_b128 v13, v[224:227] offset:8448
    ds_write_b128 v13, v[228:231] offset:9504
    ds_write_b128 v13, v[232:235] offset:10560
    ds_write_b128 v13, v[236:239] offset:11616
    ds_write_b128 v13, v[240:243] offset:12672
    ds_write_b128 v13, v[244:247] offset:13728
    ds_write_b128 v13, v[248:251] offset:14784
    ds_write_b128 v13, v[252:255] offset:15840
    s_waitcnt lgkmcnt(0)
    ds_read_b128 v[128:131], v14 offset:0
    ds_read_b128 v[132:135], v14 offset:32
    ds_read_b128 v[136:139], v14 offset:64
    ds_read_b128 v[140:143], v14 offset:96
    ds_read_b128 v[144:147], v14 offset:128
    ds_read_b128 v[148:151], v14 offset:160
    ds_read_b128 v[152:155], v14 offset:192
    ds_read_b128 v[156:159], v14 offset:224
    ds_read_b128 v[160:163], v14 offset:256
    ds_read_b128 v[164:167], v14 offset:288
    ds_read_b128 v[168:171], v14 offset:320
    ds_read_b128 v[172:175], v14 offset:352
    ds_read_b128 v[176:179], v14 offset:384
    ds_read_b128 v[180:183], v14 offset:416
    ds_read_b128 v[184:187], v14 offset:448
    ds_read_b128 v[188:191], v14 offset:480
    s_waitcnt lgkmcnt(0)
    v_mfma_f32_32x32x16_bf16 v[16:31], v[128:131], v[64:67], 0
    v_mfma_f32_32x32x16_bf16 v[16:31], v[132:135], v[68:71], v[16:31]
    v_mfma_f32_32x32x16_bf16 v[16:31], v[136:139], v[72:75], v[16:31]
    v_mfma_f32_32x32x16_bf16 v[16:31], v[140:143], v[76:79], v[16:31]
    v_mfma_f32_32x32x16_bf16 v[16:31], v[144:147], v[80:83], v[16:31]
    v_mfma_f32_32x32x16_bf16 v[16:31], v[148:151], v[84:87], v[16:31]
    v_mfma_f32_32x32x16_bf16 v[16:31], v[152:155], v[88:91], v[16:31]
    v_mfma_f32_32x32x16_bf16 v[16:31], v[156:159], v[92:95], v[16:31]
    v_mfma_f32_32x32x16_bf16 v[16:31], v[160:163], v[96:99], v[16:31]
    v_mfma_f32_32x32x16_bf16 v[16:31], v[164:167], v[100:103], v[16:31]
    v_mfma_f32_32x32x16_bf16 v[16:31], v[168:171], v[104:107], v[16:31]
    v_mfma_f32_32x32x16_bf16 v[16:31], v[172:175], v[108:111], v[16:31]
    v_mfma_f32_32x32x16_bf16 v[16:31], v[176:179], v[112:115], v[16:31]
    v_mfma_f32_32x32x16_bf16 v[16:31], v[180:183], v[116:119], v[16:31]
    v_mfma_f32_32x32x16_bf16 v[16:31], v[184:187], v[120:123], v[16:31]
    v_mfma_f32_32x32x16_bf16 v[16:31], v[188:191], v[124:127], v[16:31]
    s_nop 15
    s_nop 3
    v_cvt_pk_bf16_f32 v32, v16, v17
    v_cvt_pk_bf16_f32 v33, v18, v19
    v_cvt_pk_bf16_f32 v34, v20, v21
    v_cvt_pk_bf16_f32 v35, v22, v23
    v_cvt_pk_bf16_f32 v36, v24, v25
    v_cvt_pk_bf16_f32 v37, v26, v27
    v_cvt_pk_bf16_f32 v38, v28, v29
    v_cvt_pk_bf16_f32 v39, v30, v31
    buffer_store_dwordx2 v[32:33], v7, s[44:47], s11 offen offset:0
    buffer_store_dwordx2 v[34:35], v7, s[44:47], s11 offen offset:512
    buffer_store_dwordx2 v[36:37], v7, s[44:47], s11 offen offset:1024
    buffer_store_dwordx2 v[38:39], v7, s[44:47], s11 offen offset:1536
    s_add_u32 s11, s11, 2048
    s_branch prep_kernel_done
prep_kernel_a1:
    s_sub_u32 s4, s4, 896
    s_lshr_b32 s5, s4, 1
    s_and_b32 s6, s4, 1
    s_cmp_lt_u32 s5, 128
    s_cselect_b32 s48, s26, s28
    s_cselect_b32 s49, s27, s29
    s_mov_b32 s50, 3670016
    s_mov_b32 s51, 0x00020000
    s_and_b32 s7, s5, 127
    s_lshl_b32 s7, s7, 6
    s_mul_i32 s8, s6, 1835008
    s_add_u32 s14, s7, s8
    s_mul_i32 s9, s5, 28672
    s_mul_i32 s10, s6, 14336
    s_add_u32 s9, s9, s10
    s_add_u32 s9, s9, 8257536
    v_lshrrev_b32 v8, 2, v62
    s_mov_b32 s61, 8192
    v_mul_lo_u32 v8, v8, s61
    v_and_b32 v9, 3, v62
    v_lshl_add_u32 v8, v9, 4, v8
    s_mul_i32 s62, s3, 17408
    v_add_u32 v10, s62, v5
    v_lshrrev_b32 v11, 5, v62
    v_lshlrev_b32 v11, 3, v11
    v_bfe_u32 v12, v62, 2, 2
    v_add_u32 v11, v11, v12
    v_lshlrev_b32 v11, 6, v11
    v_bfe_u32 v12, v62, 4, 1
    v_lshl_add_u32 v11, v12, 5, v11
    v_lshl_add_u32 v11, v9, 3, v11
    v_add_u32 v11, s62, v11
    s_mov_b32 s60, s14
    buffer_load_dwordx4 v[64:67], v8, s[48:51], s60 offen
    s_add_u32 s60, s60, 131072
    buffer_load_dwordx4 v[68:71], v8, s[48:51], s60 offen
    s_add_u32 s60, s60, 131072
    buffer_load_dwordx4 v[72:75], v8, s[48:51], s60 offen
    s_add_u32 s60, s60, 131072
    buffer_load_dwordx4 v[76:79], v8, s[48:51], s60 offen
    s_add_u32 s60, s60, 131072
    buffer_load_dwordx4 v[80:83], v8, s[48:51], s60 offen
    s_add_u32 s60, s60, 131072
    buffer_load_dwordx4 v[84:87], v8, s[48:51], s60 offen
    s_add_u32 s60, s60, 131072
    buffer_load_dwordx4 v[88:91], v8, s[48:51], s60 offen
    s_add_u32 s60, s60, 131072
    buffer_load_dwordx4 v[92:95], v8, s[48:51], s60 offen
    s_add_u32 s60, s60, 131072
    buffer_load_dwordx4 v[96:99], v8, s[48:51], s60 offen
    s_add_u32 s60, s60, 131072
    buffer_load_dwordx4 v[100:103], v8, s[48:51], s60 offen
    s_add_u32 s60, s60, 131072
    buffer_load_dwordx4 v[104:107], v8, s[48:51], s60 offen
    s_add_u32 s60, s60, 131072
    buffer_load_dwordx4 v[108:111], v8, s[48:51], s60 offen
    s_add_u32 s60, s60, 131072
    buffer_load_dwordx4 v[112:115], v8, s[48:51], s60 offen
    s_add_u32 s60, s60, 131072
    buffer_load_dwordx4 v[116:119], v8, s[48:51], s60 offen
    s_add_u32 s60, s60, 131072
    s_waitcnt vmcnt(13)
    ds_write_b128 v10, v[64:67] offset:0
    s_waitcnt vmcnt(12)
    ds_write_b128 v10, v[68:71] offset:1024
    s_waitcnt vmcnt(11)
    ds_write_b128 v10, v[72:75] offset:2048
    s_waitcnt vmcnt(10)
    ds_write_b128 v10, v[76:79] offset:3072
    s_waitcnt vmcnt(9)
    ds_write_b128 v10, v[80:83] offset:4096
    s_waitcnt vmcnt(8)
    ds_write_b128 v10, v[84:87] offset:5120
    s_waitcnt vmcnt(7)
    ds_write_b128 v10, v[88:91] offset:6144
    s_waitcnt vmcnt(6)
    ds_write_b128 v10, v[92:95] offset:7168
    s_waitcnt vmcnt(5)
    ds_write_b128 v10, v[96:99] offset:8192
    s_waitcnt vmcnt(4)
    ds_write_b128 v10, v[100:103] offset:9216
    s_waitcnt vmcnt(3)
    ds_write_b128 v10, v[104:107] offset:10240
    s_waitcnt vmcnt(2)
    ds_write_b128 v10, v[108:111] offset:11264
    s_waitcnt vmcnt(1)
    ds_write_b128 v10, v[112:115] offset:12288
    s_waitcnt vmcnt(0)
    ds_write_b128 v10, v[116:119] offset:13312
    s_waitcnt lgkmcnt(0)
    ds_read_b64_tr_b16 v[64:65], v11 offset:0
    ds_read_b64_tr_b16 v[66:67], v11 offset:256
    ds_read_b64_tr_b16 v[68:69], v11 offset:1024
    ds_read_b64_tr_b16 v[70:71], v11 offset:1280
    ds_read_b64_tr_b16 v[72:73], v11 offset:2048
    ds_read_b64_tr_b16 v[74:75], v11 offset:2304
    ds_read_b64_tr_b16 v[76:77], v11 offset:3072
    ds_read_b64_tr_b16 v[78:79], v11 offset:3328
    s_waitcnt lgkmcnt(0)
    ds_read_b64_tr_b16 v[80:81], v11 offset:4096
    ds_read_b64_tr_b16 v[82:83], v11 offset:4352
    ds_read_b64_tr_b16 v[84:85], v11 offset:5120
    ds_read_b64_tr_b16 v[86:87], v11 offset:5376
    ds_read_b64_tr_b16 v[88:89], v11 offset:6144
    ds_read_b64_tr_b16 v[90:91], v11 offset:6400
    ds_read_b64_tr_b16 v[92:93], v11 offset:7168
    ds_read_b64_tr_b16 v[94:95], v11 offset:7424
    s_waitcnt lgkmcnt(0)
    ds_read_b64_tr_b16 v[96:97], v11 offset:8192
    ds_read_b64_tr_b16 v[98:99], v11 offset:8448
    ds_read_b64_tr_b16 v[100:101], v11 offset:9216
    ds_read_b64_tr_b16 v[102:103], v11 offset:9472
    ds_read_b64_tr_b16 v[104:105], v11 offset:10240
    ds_read_b64_tr_b16 v[106:107], v11 offset:10496
    ds_read_b64_tr_b16 v[108:109], v11 offset:11264
    ds_read_b64_tr_b16 v[110:111], v11 offset:11520
    s_waitcnt lgkmcnt(0)
    ds_read_b64_tr_b16 v[112:113], v11 offset:12288
    ds_read_b64_tr_b16 v[114:115], v11 offset:12544
    ds_read_b64_tr_b16 v[116:117], v11 offset:13312
    ds_read_b64_tr_b16 v[118:119], v11 offset:13568
    s_waitcnt lgkmcnt(0)
    buffer_store_dwordx4 v[64:67], v5, s[44:47], s9 offen offset:0
    buffer_store_dwordx4 v[68:71], v5, s[44:47], s9 offen offset:1024
    buffer_store_dwordx4 v[72:75], v5, s[44:47], s9 offen offset:2048
    buffer_store_dwordx4 v[76:79], v5, s[44:47], s9 offen offset:3072
    s_add_u32 s9, s9, 4096
    buffer_store_dwordx4 v[80:83], v5, s[44:47], s9 offen offset:0
    buffer_store_dwordx4 v[84:87], v5, s[44:47], s9 offen offset:1024
    buffer_store_dwordx4 v[88:91], v5, s[44:47], s9 offen offset:2048
    buffer_store_dwordx4 v[92:95], v5, s[44:47], s9 offen offset:3072
    s_add_u32 s9, s9, 4096
    buffer_store_dwordx4 v[96:99], v5, s[44:47], s9 offen offset:0
    buffer_store_dwordx4 v[100:103], v5, s[44:47], s9 offen offset:1024
    buffer_store_dwordx4 v[104:107], v5, s[44:47], s9 offen offset:2048
    buffer_store_dwordx4 v[108:111], v5, s[44:47], s9 offen offset:3072
    s_add_u32 s9, s9, 4096
    buffer_store_dwordx4 v[112:115], v5, s[44:47], s9 offen offset:0
    buffer_store_dwordx4 v[116:119], v5, s[44:47], s9 offen offset:1024
    s_branch prep_kernel_done
prep_kernel_c2:
    s_sub_u32 s4, s4, 1408
    s_lshr_b32 s5, s4, 1
    s_and_b32 s6, s4, 1
    s_mov_b32 s48, s18
    s_mov_b32 s49, s19
    s_mov_b32 s50, 1204224
    s_mov_b32 s51, 0x00020000
    s_mul_i32 s7, s5, 56
    s_mul_i32 s8, s6, 602112
    s_add_u32 s7, s7, s8
    v_mul_u32_u24 v4, 21504, v3
    v_lshl_add_u32 v4, v2, 1, v4
    v_add_u32 v4, s7, v4
    v_mov_b32 v6, 2147483392
    v_cmp_gt_u32 vcc, 28, v2
    s_nop 1
    v_cndmask_b32 v4, v6, v4, vcc
    s_mul_i32 s9, s5, 28672
    s_mul_i32 s10, s6, 14336
    s_add_u32 s9, s9, s10
    s_add_u32 s9, s9, 25690112
    s_mov_b32 s60, 0
    buffer_load_ushort v128, v4, s[48:51], s60 offen
    s_mov_b32 s60, 2688
    buffer_load_ushort v129, v4, s[48:51], s60 offen
    s_mov_b32 s60, 5376
    buffer_load_ushort v130, v4, s[48:51], s60 offen
    s_mov_b32 s60, 8064
    buffer_load_ushort v131, v4, s[48:51], s60 offen
    s_mov_b32 s60, 10752
    buffer_load_ushort v132, v4, s[48:51], s60 offen
    s_mov_b32 s60, 13440
    buffer_load_ushort v133, v4, s[48:51], s60 offen
    s_mov_b32 s60, 16128
    buffer_load_ushort v134, v4, s[48:51], s60 offen
    s_mov_b32 s60, 18816
    buffer_load_ushort v135, v4, s[48:51], s60 offen
    s_mov_b32 s60, 43008
    buffer_load_ushort v136, v4, s[48:51], s60 offen
    s_mov_b32 s60, 45696
    buffer_load_ushort v137, v4, s[48:51], s60 offen
    s_mov_b32 s60, 48384
    buffer_load_ushort v138, v4, s[48:51], s60 offen
    s_mov_b32 s60, 51072
    buffer_load_ushort v139, v4, s[48:51], s60 offen
    s_mov_b32 s60, 53760
    buffer_load_ushort v140, v4, s[48:51], s60 offen
    s_mov_b32 s60, 56448
    buffer_load_ushort v141, v4, s[48:51], s60 offen
    s_mov_b32 s60, 59136
    buffer_load_ushort v142, v4, s[48:51], s60 offen
    s_mov_b32 s60, 61824
    buffer_load_ushort v143, v4, s[48:51], s60 offen
    s_mov_b32 s60, 86016
    buffer_load_ushort v144, v4, s[48:51], s60 offen
    s_mov_b32 s60, 88704
    buffer_load_ushort v145, v4, s[48:51], s60 offen
    s_mov_b32 s60, 91392
    buffer_load_ushort v146, v4, s[48:51], s60 offen
    s_mov_b32 s60, 94080
    buffer_load_ushort v147, v4, s[48:51], s60 offen
    s_mov_b32 s60, 96768
    buffer_load_ushort v148, v4, s[48:51], s60 offen
    s_mov_b32 s60, 99456
    buffer_load_ushort v149, v4, s[48:51], s60 offen
    s_mov_b32 s60, 102144
    buffer_load_ushort v150, v4, s[48:51], s60 offen
    s_mov_b32 s60, 104832
    buffer_load_ushort v151, v4, s[48:51], s60 offen
    s_mov_b32 s60, 129024
    buffer_load_ushort v152, v4, s[48:51], s60 offen
    s_mov_b32 s60, 131712
    buffer_load_ushort v153, v4, s[48:51], s60 offen
    s_mov_b32 s60, 134400
    buffer_load_ushort v154, v4, s[48:51], s60 offen
    s_mov_b32 s60, 137088
    buffer_load_ushort v155, v4, s[48:51], s60 offen
    s_mov_b32 s60, 139776
    buffer_load_ushort v156, v4, s[48:51], s60 offen
    s_mov_b32 s60, 142464
    buffer_load_ushort v157, v4, s[48:51], s60 offen
    s_mov_b32 s60, 145152
    buffer_load_ushort v158, v4, s[48:51], s60 offen
    s_mov_b32 s60, 147840
    buffer_load_ushort v159, v4, s[48:51], s60 offen
    s_mov_b32 s60, 172032
    buffer_load_ushort v160, v4, s[48:51], s60 offen
    s_mov_b32 s60, 174720
    buffer_load_ushort v161, v4, s[48:51], s60 offen
    s_mov_b32 s60, 177408
    buffer_load_ushort v162, v4, s[48:51], s60 offen
    s_mov_b32 s60, 180096
    buffer_load_ushort v163, v4, s[48:51], s60 offen
    s_mov_b32 s60, 182784
    buffer_load_ushort v164, v4, s[48:51], s60 offen
    s_mov_b32 s60, 185472
    buffer_load_ushort v165, v4, s[48:51], s60 offen
    s_mov_b32 s60, 188160
    buffer_load_ushort v166, v4, s[48:51], s60 offen
    s_mov_b32 s60, 190848
    buffer_load_ushort v167, v4, s[48:51], s60 offen
    s_mov_b32 s60, 215040
    buffer_load_ushort v168, v4, s[48:51], s60 offen
    s_mov_b32 s60, 217728
    buffer_load_ushort v169, v4, s[48:51], s60 offen
    s_mov_b32 s60, 220416
    buffer_load_ushort v170, v4, s[48:51], s60 offen
    s_mov_b32 s60, 223104
    buffer_load_ushort v171, v4, s[48:51], s60 offen
    s_mov_b32 s60, 225792
    buffer_load_ushort v172, v4, s[48:51], s60 offen
    s_mov_b32 s60, 228480
    buffer_load_ushort v173, v4, s[48:51], s60 offen
    s_mov_b32 s60, 231168
    buffer_load_ushort v174, v4, s[48:51], s60 offen
    s_mov_b32 s60, 233856
    buffer_load_ushort v175, v4, s[48:51], s60 offen
    s_mov_b32 s60, 258048
    buffer_load_ushort v176, v4, s[48:51], s60 offen
    s_mov_b32 s60, 260736
    buffer_load_ushort v177, v4, s[48:51], s60 offen
    s_mov_b32 s60, 263424
    buffer_load_ushort v178, v4, s[48:51], s60 offen
    s_mov_b32 s60, 266112
    buffer_load_ushort v179, v4, s[48:51], s60 offen
    s_mov_b32 s60, 268800
    buffer_load_ushort v180, v4, s[48:51], s60 offen
    s_mov_b32 s60, 271488
    buffer_load_ushort v181, v4, s[48:51], s60 offen
    s_mov_b32 s60, 274176
    buffer_load_ushort v182, v4, s[48:51], s60 offen
    s_mov_b32 s60, 276864
    buffer_load_ushort v183, v4, s[48:51], s60 offen
    s_mov_b32 s60, 301056
    buffer_load_ushort v184, v4, s[48:51], s60 offen
    s_mov_b32 s60, 303744
    buffer_load_ushort v185, v4, s[48:51], s60 offen
    s_mov_b32 s60, 306432
    buffer_load_ushort v186, v4, s[48:51], s60 offen
    s_mov_b32 s60, 309120
    buffer_load_ushort v187, v4, s[48:51], s60 offen
    s_mov_b32 s60, 311808
    buffer_load_ushort v188, v4, s[48:51], s60 offen
    s_mov_b32 s60, 314496
    buffer_load_ushort v189, v4, s[48:51], s60 offen
    s_mov_b32 s60, 317184
    buffer_load_ushort v190, v4, s[48:51], s60 offen
    s_mov_b32 s60, 319872
    buffer_load_ushort v191, v4, s[48:51], s60 offen
    s_waitcnt vmcnt(0)
    v_lshl_or_b32 v64, v129, 16, v128
    v_lshl_or_b32 v65, v131, 16, v130
    v_lshl_or_b32 v66, v133, 16, v132
    v_lshl_or_b32 v67, v135, 16, v134
    v_lshl_or_b32 v68, v137, 16, v136
    v_lshl_or_b32 v69, v139, 16, v138
    v_lshl_or_b32 v70, v141, 16, v140
    v_lshl_or_b32 v71, v143, 16, v142
    v_lshl_or_b32 v72, v145, 16, v144
    v_lshl_or_b32 v73, v147, 16, v146
    v_lshl_or_b32 v74, v149, 16, v148
    v_lshl_or_b32 v75, v151, 16, v150
    v_lshl_or_b32 v76, v153, 16, v152
    v_lshl_or_b32 v77, v155, 16, v154
    v_lshl_or_b32 v78, v157, 16, v156
    v_lshl_or_b32 v79, v159, 16, v158
    v_lshl_or_b32 v80, v161, 16, v160
    v_lshl_or_b32 v81, v163, 16, v162
    v_lshl_or_b32 v82, v165, 16, v164
    v_lshl_or_b32 v83, v167, 16, v166
    v_lshl_or_b32 v84, v169, 16, v168
    v_lshl_or_b32 v85, v171, 16, v170
    v_lshl_or_b32 v86, v173, 16, v172
    v_lshl_or_b32 v87, v175, 16, v174
    v_lshl_or_b32 v88, v177, 16, v176
    v_lshl_or_b32 v89, v179, 16, v178
    v_lshl_or_b32 v90, v181, 16, v180
    v_lshl_or_b32 v91, v183, 16, v182
    v_lshl_or_b32 v92, v185, 16, v184
    v_lshl_or_b32 v93, v187, 16, v186
    v_lshl_or_b32 v94, v189, 16, v188
    v_lshl_or_b32 v95, v191, 16, v190
    s_mov_b32 s60, 344064
    buffer_load_ushort v128, v4, s[48:51], s60 offen
    s_mov_b32 s60, 346752
    buffer_load_ushort v129, v4, s[48:51], s60 offen
    s_mov_b32 s60, 349440
    buffer_load_ushort v130, v4, s[48:51], s60 offen
    s_mov_b32 s60, 352128
    buffer_load_ushort v131, v4, s[48:51], s60 offen
    s_mov_b32 s60, 354816
    buffer_load_ushort v132, v4, s[48:51], s60 offen
    s_mov_b32 s60, 357504
    buffer_load_ushort v133, v4, s[48:51], s60 offen
    s_mov_b32 s60, 360192
    buffer_load_ushort v134, v4, s[48:51], s60 offen
    s_mov_b32 s60, 362880
    buffer_load_ushort v135, v4, s[48:51], s60 offen
    s_mov_b32 s60, 387072
    buffer_load_ushort v136, v4, s[48:51], s60 offen
    s_mov_b32 s60, 389760
    buffer_load_ushort v137, v4, s[48:51], s60 offen
    s_mov_b32 s60, 392448
    buffer_load_ushort v138, v4, s[48:51], s60 offen
    s_mov_b32 s60, 395136
    buffer_load_ushort v139, v4, s[48:51], s60 offen
    s_mov_b32 s60, 397824
    buffer_load_ushort v140, v4, s[48:51], s60 offen
    s_mov_b32 s60, 400512
    buffer_load_ushort v141, v4, s[48:51], s60 offen
    s_mov_b32 s60, 403200
    buffer_load_ushort v142, v4, s[48:51], s60 offen
    s_mov_b32 s60, 405888
    buffer_load_ushort v143, v4, s[48:51], s60 offen
    s_mov_b32 s60, 430080
    buffer_load_ushort v144, v4, s[48:51], s60 offen
    s_mov_b32 s60, 432768
    buffer_load_ushort v145, v4, s[48:51], s60 offen
    s_mov_b32 s60, 435456
    buffer_load_ushort v146, v4, s[48:51], s60 offen
    s_mov_b32 s60, 438144
    buffer_load_ushort v147, v4, s[48:51], s60 offen
    s_mov_b32 s60, 440832
    buffer_load_ushort v148, v4, s[48:51], s60 offen
    s_mov_b32 s60, 443520
    buffer_load_ushort v149, v4, s[48:51], s60 offen
    s_mov_b32 s60, 446208
    buffer_load_ushort v150, v4, s[48:51], s60 offen
    s_mov_b32 s60, 448896
    buffer_load_ushort v151, v4, s[48:51], s60 offen
    s_mov_b32 s60, 473088
    buffer_load_ushort v152, v4, s[48:51], s60 offen
    s_mov_b32 s60, 475776
    buffer_load_ushort v153, v4, s[48:51], s60 offen
    s_mov_b32 s60, 478464
    buffer_load_ushort v154, v4, s[48:51], s60 offen
    s_mov_b32 s60, 481152
    buffer_load_ushort v155, v4, s[48:51], s60 offen
    s_mov_b32 s60, 483840
    buffer_load_ushort v156, v4, s[48:51], s60 offen
    s_mov_b32 s60, 486528
    buffer_load_ushort v157, v4, s[48:51], s60 offen
    s_mov_b32 s60, 489216
    buffer_load_ushort v158, v4, s[48:51], s60 offen
    s_mov_b32 s60, 491904
    buffer_load_ushort v159, v4, s[48:51], s60 offen
    s_mov_b32 s60, 516096
    buffer_load_ushort v160, v4, s[48:51], s60 offen
    s_mov_b32 s60, 518784
    buffer_load_ushort v161, v4, s[48:51], s60 offen
    s_mov_b32 s60, 521472
    buffer_load_ushort v162, v4, s[48:51], s60 offen
    s_mov_b32 s60, 524160
    buffer_load_ushort v163, v4, s[48:51], s60 offen
    s_mov_b32 s60, 526848
    buffer_load_ushort v164, v4, s[48:51], s60 offen
    s_mov_b32 s60, 529536
    buffer_load_ushort v165, v4, s[48:51], s60 offen
    s_mov_b32 s60, 532224
    buffer_load_ushort v166, v4, s[48:51], s60 offen
    s_mov_b32 s60, 534912
    buffer_load_ushort v167, v4, s[48:51], s60 offen
    s_mov_b32 s60, 559104
    buffer_load_ushort v168, v4, s[48:51], s60 offen
    s_mov_b32 s60, 561792
    buffer_load_ushort v169, v4, s[48:51], s60 offen
    s_mov_b32 s60, 564480
    buffer_load_ushort v170, v4, s[48:51], s60 offen
    s_mov_b32 s60, 567168
    buffer_load_ushort v171, v4, s[48:51], s60 offen
    s_mov_b32 s60, 569856
    buffer_load_ushort v172, v4, s[48:51], s60 offen
    s_mov_b32 s60, 572544
    buffer_load_ushort v173, v4, s[48:51], s60 offen
    s_mov_b32 s60, 575232
    buffer_load_ushort v174, v4, s[48:51], s60 offen
    s_mov_b32 s60, 577920
    buffer_load_ushort v175, v4, s[48:51], s60 offen
    s_waitcnt vmcnt(0)
    v_lshl_or_b32 v96, v129, 16, v128
    v_lshl_or_b32 v97, v131, 16, v130
    v_lshl_or_b32 v98, v133, 16, v132
    v_lshl_or_b32 v99, v135, 16, v134
    v_lshl_or_b32 v100, v137, 16, v136
    v_lshl_or_b32 v101, v139, 16, v138
    v_lshl_or_b32 v102, v141, 16, v140
    v_lshl_or_b32 v103, v143, 16, v142
    v_lshl_or_b32 v104, v145, 16, v144
    v_lshl_or_b32 v105, v147, 16, v146
    v_lshl_or_b32 v106, v149, 16, v148
    v_lshl_or_b32 v107, v151, 16, v150
    v_lshl_or_b32 v108, v153, 16, v152
    v_lshl_or_b32 v109, v155, 16, v154
    v_lshl_or_b32 v110, v157, 16, v156
    v_lshl_or_b32 v111, v159, 16, v158
    v_lshl_or_b32 v112, v161, 16, v160
    v_lshl_or_b32 v113, v163, 16, v162
    v_lshl_or_b32 v114, v165, 16, v164
    v_lshl_or_b32 v115, v167, 16, v166
    v_lshl_or_b32 v116, v169, 16, v168
    v_lshl_or_b32 v117, v171, 16, v170
    v_lshl_or_b32 v118, v173, 16, v172
    v_lshl_or_b32 v119, v175, 16, v174
    buffer_store_dwordx4 v[64:67], v5, s[44:47], s9 offen offset:0
    buffer_store_dwordx4 v[68:71], v5, s[44:47], s9 offen offset:1024
    buffer_store_dwordx4 v[72:75], v5, s[44:47], s9 offen offset:2048
    buffer_store_dwordx4 v[76:79], v5, s[44:47], s9 offen offset:3072
    s_add_u32 s9, s9, 4096
    buffer_store_dwordx4 v[80:83], v5, s[44:47], s9 offen offset:0
    buffer_store_dwordx4 v[84:87], v5, s[44:47], s9 offen offset:1024
    buffer_store_dwordx4 v[88:91], v5, s[44:47], s9 offen offset:2048
    buffer_store_dwordx4 v[92:95], v5, s[44:47], s9 offen offset:3072
    s_add_u32 s9, s9, 4096
    buffer_store_dwordx4 v[96:99], v5, s[44:47], s9 offen offset:0
    buffer_store_dwordx4 v[100:103], v5, s[44:47], s9 offen offset:1024
    buffer_store_dwordx4 v[104:107], v5, s[44:47], s9 offen offset:2048
    buffer_store_dwordx4 v[108:111], v5, s[44:47], s9 offen offset:3072
    s_add_u32 s9, s9, 4096
    buffer_store_dwordx4 v[112:115], v5, s[44:47], s9 offen offset:0
    buffer_store_dwordx4 v[116:119], v5, s[44:47], s9 offen offset:1024
    s_branch prep_kernel_done
prep_kernel_d3:
    s_sub_u32 s4, s4, 1504
    s_lshr_b32 s5, s4, 1
    s_and_b32 s6, s4, 1
    s_mov_b32 s48, s20
    s_mov_b32 s49, s21
    s_mov_b32 s50, 401408
    s_mov_b32 s51, 0x00020000
    s_mul_i32 s7, s6, 200704
    s_lshl_b32 s10, s5, 6
    s_add_u32 s7, s7, s10
    v_mul_u32_u24 v4, 3584, v3
    v_lshl_add_u32 v4, v2, 1, v4
    v_add_u32 v4, s7, v4
    v_mov_b32 v7, 2147483392
    v_cmp_eq_u32 vcc, 0, v3
    s_nop 1
    v_cndmask_b32 v6, v7, v4, vcc
    s_lshl_b32 s9, s5, 15
    s_lshl_b32 s10, s6, 14
    s_add_u32 s9, s9, s10
    s_add_u32 s9, s9, 27066368
    s_mov_b32 s60, 0
    buffer_load_ushort v128, v4, s[48:51], s60 offen
    s_mov_b32 s60, 896
    buffer_load_ushort v129, v4, s[48:51], s60 offen
    s_mov_b32 s60, 1792
    buffer_load_ushort v130, v4, s[48:51], s60 offen
    s_mov_b32 s60, 2688
    buffer_load_ushort v131, v4, s[48:51], s60 offen
    s_mov_b32 s60, 7168
    buffer_load_ushort v132, v4, s[48:51], s60 offen
    s_mov_b32 s60, 8064
    buffer_load_ushort v133, v4, s[48:51], s60 offen
    s_mov_b32 s60, 8960
    buffer_load_ushort v134, v4, s[48:51], s60 offen
    s_mov_b32 s60, 9856
    buffer_load_ushort v135, v4, s[48:51], s60 offen
    s_mov_b32 s60, 14336
    buffer_load_ushort v136, v4, s[48:51], s60 offen
    s_mov_b32 s60, 15232
    buffer_load_ushort v137, v4, s[48:51], s60 offen
    s_mov_b32 s60, 16128
    buffer_load_ushort v138, v4, s[48:51], s60 offen
    s_mov_b32 s60, 17024
    buffer_load_ushort v139, v4, s[48:51], s60 offen
    s_mov_b32 s60, 21504
    buffer_load_ushort v140, v6, s[48:51], s60 offen
    s_mov_b32 s60, 22400
    buffer_load_ushort v141, v6, s[48:51], s60 offen
    s_mov_b32 s60, 23296
    buffer_load_ushort v142, v6, s[48:51], s60 offen
    s_mov_b32 s60, 24192
    buffer_load_ushort v143, v6, s[48:51], s60 offen
    s_mov_b32 s60, 25088
    buffer_load_ushort v144, v4, s[48:51], s60 offen
    s_mov_b32 s60, 25984
    buffer_load_ushort v145, v4, s[48:51], s60 offen
    s_mov_b32 s60, 26880
    buffer_load_ushort v146, v4, s[48:51], s60 offen
    s_mov_b32 s60, 27776
    buffer_load_ushort v147, v4, s[48:51], s60 offen
    s_mov_b32 s60, 32256
    buffer_load_ushort v148, v4, s[48:51], s60 offen
    s_mov_b32 s60, 33152
    buffer_load_ushort v149, v4, s[48:51], s60 offen
    s_mov_b32 s60, 34048
    buffer_load_ushort v150, v4, s[48:51], s60 offen
    s_mov_b32 s60, 34944
    buffer_load_ushort v151, v4, s[48:51], s60 offen
    s_mov_b32 s60, 39424
    buffer_load_ushort v152, v4, s[48:51], s60 offen
    s_mov_b32 s60, 40320
    buffer_load_ushort v153, v4, s[48:51], s60 offen
    s_mov_b32 s60, 41216
    buffer_load_ushort v154, v4, s[48:51], s60 offen
    s_mov_b32 s60, 42112
    buffer_load_ushort v155, v4, s[48:51], s60 offen
    s_mov_b32 s60, 46592
    buffer_load_ushort v156, v6, s[48:51], s60 offen
    s_mov_b32 s60, 47488
    buffer_load_ushort v157, v6, s[48:51], s60 offen
    s_mov_b32 s60, 48384
    buffer_load_ushort v158, v6, s[48:51], s60 offen
    s_mov_b32 s60, 49280
    buffer_load_ushort v159, v6, s[48:51], s60 offen
    s_mov_b32 s60, 50176
    buffer_load_ushort v160, v4, s[48:51], s60 offen
    s_mov_b32 s60, 51072
    buffer_load_ushort v161, v4, s[48:51], s60 offen
    s_mov_b32 s60, 51968
    buffer_load_ushort v162, v4, s[48:51], s60 offen
    s_mov_b32 s60, 52864
    buffer_load_ushort v163, v4, s[48:51], s60 offen
    s_mov_b32 s60, 57344
    buffer_load_ushort v164, v4, s[48:51], s60 offen
    s_mov_b32 s60, 58240
    buffer_load_ushort v165, v4, s[48:51], s60 offen
    s_mov_b32 s60, 59136
    buffer_load_ushort v166, v4, s[48:51], s60 offen
    s_mov_b32 s60, 60032
    buffer_load_ushort v167, v4, s[48:51], s60 offen
    s_mov_b32 s60, 64512
    buffer_load_ushort v168, v4, s[48:51], s60 offen
    s_mov_b32 s60, 65408
    buffer_load_ushort v169, v4, s[48:51], s60 offen
    s_mov_b32 s60, 66304
    buffer_load_ushort v170, v4, s[48:51], s60 offen
    s_mov_b32 s60, 67200
    buffer_load_ushort v171, v4, s[48:51], s60 offen
    s_mov_b32 s60, 71680
    buffer_load_ushort v172, v6, s[48:51], s60 offen
    s_mov_b32 s60, 72576
    buffer_load_ushort v173, v6, s[48:51], s60 offen
    s_mov_b32 s60, 73472
    buffer_load_ushort v174, v6, s[48:51], s60 offen
    s_mov_b32 s60, 74368
    buffer_load_ushort v175, v6, s[48:51], s60 offen
    s_mov_b32 s60, 75264
    buffer_load_ushort v176, v4, s[48:51], s60 offen
    s_mov_b32 s60, 76160
    buffer_load_ushort v177, v4, s[48:51], s60 offen
    s_mov_b32 s60, 77056
    buffer_load_ushort v178, v4, s[48:51], s60 offen
    s_mov_b32 s60, 77952
    buffer_load_ushort v179, v4, s[48:51], s60 offen
    s_mov_b32 s60, 82432
    buffer_load_ushort v180, v4, s[48:51], s60 offen
    s_mov_b32 s60, 83328
    buffer_load_ushort v181, v4, s[48:51], s60 offen
    s_mov_b32 s60, 84224
    buffer_load_ushort v182, v4, s[48:51], s60 offen
    s_mov_b32 s60, 85120
    buffer_load_ushort v183, v4, s[48:51], s60 offen
    s_mov_b32 s60, 89600
    buffer_load_ushort v184, v4, s[48:51], s60 offen
    s_mov_b32 s60, 90496
    buffer_load_ushort v185, v4, s[48:51], s60 offen
    s_mov_b32 s60, 91392
    buffer_load_ushort v186, v4, s[48:51], s60 offen
    s_mov_b32 s60, 92288
    buffer_load_ushort v187, v4, s[48:51], s60 offen
    s_mov_b32 s60, 96768
    buffer_load_ushort v188, v6, s[48:51], s60 offen
    s_mov_b32 s60, 97664
    buffer_load_ushort v189, v6, s[48:51], s60 offen
    s_mov_b32 s60, 98560
    buffer_load_ushort v190, v6, s[48:51], s60 offen
    s_mov_b32 s60, 99456
    buffer_load_ushort v191, v6, s[48:51], s60 offen
    s_waitcnt vmcnt(0)
    v_lshl_or_b32 v64, v129, 16, v128
    v_lshl_or_b32 v65, v131, 16, v130
    v_lshl_or_b32 v66, v133, 16, v132
    v_lshl_or_b32 v67, v135, 16, v134
    v_lshl_or_b32 v68, v137, 16, v136
    v_lshl_or_b32 v69, v139, 16, v138
    v_lshl_or_b32 v70, v141, 16, v140
    v_lshl_or_b32 v71, v143, 16, v142
    v_lshl_or_b32 v72, v145, 16, v144
    v_lshl_or_b32 v73, v147, 16, v146
    v_lshl_or_b32 v74, v149, 16, v148
    v_lshl_or_b32 v75, v151, 16, v150
    v_lshl_or_b32 v76, v153, 16, v152
    v_lshl_or_b32 v77, v155, 16, v154
    v_lshl_or_b32 v78, v157, 16, v156
    v_lshl_or_b32 v79, v159, 16, v158
    v_lshl_or_b32 v80, v161, 16, v160
    v_lshl_or_b32 v81, v163, 16, v162
    v_lshl_or_b32 v82, v165, 16, v164
    v_lshl_or_b32 v83, v167, 16, v166
    v_lshl_or_b32 v84, v169, 16, v168
    v_lshl_or_b32 v85, v171, 16, v170
    v_lshl_or_b32 v86, v173, 16, v172
    v_lshl_or_b32 v87, v175, 16, v174
    v_lshl_or_b32 v88, v177, 16, v176
    v_lshl_or_b32 v89, v179, 16, v178
    v_lshl_or_b32 v90, v181, 16, v180
    v_lshl_or_b32 v91, v183, 16, v182
    v_lshl_or_b32 v92, v185, 16, v184
    v_lshl_or_b32 v93, v187, 16, v186
    v_lshl_or_b32 v94, v189, 16, v188
    v_lshl_or_b32 v95, v191, 16, v190
    s_mov_b32 s60, 100352
    buffer_load_ushort v128, v4, s[48:51], s60 offen
    s_mov_b32 s60, 101248
    buffer_load_ushort v129, v4, s[48:51], s60 offen
    s_mov_b32 s60, 102144
    buffer_load_ushort v130, v4, s[48:51], s60 offen
    s_mov_b32 s60, 103040
    buffer_load_ushort v131, v4, s[48:51], s60 offen
    s_mov_b32 s60, 107520
    buffer_load_ushort v132, v4, s[48:51], s60 offen
    s_mov_b32 s60, 108416
    buffer_load_ushort v133, v4, s[48:51], s60 offen
    s_mov_b32 s60, 109312
    buffer_load_ushort v134, v4, s[48:51], s60 offen
    s_mov_b32 s60, 110208
    buffer_load_ushort v135, v4, s[48:51], s60 offen
    s_mov_b32 s60, 114688
    buffer_load_ushort v136, v4, s[48:51], s60 offen
    s_mov_b32 s60, 115584
    buffer_load_ushort v137, v4, s[48:51], s60 offen
    s_mov_b32 s60, 116480
    buffer_load_ushort v138, v4, s[48:51], s60 offen
    s_mov_b32 s60, 117376
    buffer_load_ushort v139, v4, s[48:51], s60 offen
    s_mov_b32 s60, 121856
    buffer_load_ushort v140, v6, s[48:51], s60 offen
    s_mov_b32 s60, 122752
    buffer_load_ushort v141, v6, s[48:51], s60 offen
    s_mov_b32 s60, 123648
    buffer_load_ushort v142, v6, s[48:51], s60 offen
    s_mov_b32 s60, 124544
    buffer_load_ushort v143, v6, s[48:51], s60 offen
    s_mov_b32 s60, 125440
    buffer_load_ushort v144, v4, s[48:51], s60 offen
    s_mov_b32 s60, 126336
    buffer_load_ushort v145, v4, s[48:51], s60 offen
    s_mov_b32 s60, 127232
    buffer_load_ushort v146, v4, s[48:51], s60 offen
    s_mov_b32 s60, 128128
    buffer_load_ushort v147, v4, s[48:51], s60 offen
    s_mov_b32 s60, 132608
    buffer_load_ushort v148, v4, s[48:51], s60 offen
    s_mov_b32 s60, 133504
    buffer_load_ushort v149, v4, s[48:51], s60 offen
    s_mov_b32 s60, 134400
    buffer_load_ushort v150, v4, s[48:51], s60 offen
    s_mov_b32 s60, 135296
    buffer_load_ushort v151, v4, s[48:51], s60 offen
    s_mov_b32 s60, 139776
    buffer_load_ushort v152, v4, s[48:51], s60 offen
    s_mov_b32 s60, 140672
    buffer_load_ushort v153, v4, s[48:51], s60 offen
    s_mov_b32 s60, 141568
    buffer_load_ushort v154, v4, s[48:51], s60 offen
    s_mov_b32 s60, 142464
    buffer_load_ushort v155, v4, s[48:51], s60 offen
    s_mov_b32 s60, 146944
    buffer_load_ushort v156, v6, s[48:51], s60 offen
    s_mov_b32 s60, 147840
    buffer_load_ushort v157, v6, s[48:51], s60 offen
    s_mov_b32 s60, 148736
    buffer_load_ushort v158, v6, s[48:51], s60 offen
    s_mov_b32 s60, 149632
    buffer_load_ushort v159, v6, s[48:51], s60 offen
    s_mov_b32 s60, 150528
    buffer_load_ushort v160, v4, s[48:51], s60 offen
    s_mov_b32 s60, 151424
    buffer_load_ushort v161, v4, s[48:51], s60 offen
    s_mov_b32 s60, 152320
    buffer_load_ushort v162, v4, s[48:51], s60 offen
    s_mov_b32 s60, 153216
    buffer_load_ushort v163, v4, s[48:51], s60 offen
    s_mov_b32 s60, 157696
    buffer_load_ushort v164, v4, s[48:51], s60 offen
    s_mov_b32 s60, 158592
    buffer_load_ushort v165, v4, s[48:51], s60 offen
    s_mov_b32 s60, 159488
    buffer_load_ushort v166, v4, s[48:51], s60 offen
    s_mov_b32 s60, 160384
    buffer_load_ushort v167, v4, s[48:51], s60 offen
    s_mov_b32 s60, 164864
    buffer_load_ushort v168, v4, s[48:51], s60 offen
    s_mov_b32 s60, 165760
    buffer_load_ushort v169, v4, s[48:51], s60 offen
    s_mov_b32 s60, 166656
    buffer_load_ushort v170, v4, s[48:51], s60 offen
    s_mov_b32 s60, 167552
    buffer_load_ushort v171, v4, s[48:51], s60 offen
    s_mov_b32 s60, 172032
    buffer_load_ushort v172, v6, s[48:51], s60 offen
    s_mov_b32 s60, 172928
    buffer_load_ushort v173, v6, s[48:51], s60 offen
    s_mov_b32 s60, 173824
    buffer_load_ushort v174, v6, s[48:51], s60 offen
    s_mov_b32 s60, 174720
    buffer_load_ushort v175, v6, s[48:51], s60 offen
    s_mov_b32 s60, 175616
    buffer_load_ushort v176, v4, s[48:51], s60 offen
    s_mov_b32 s60, 176512
    buffer_load_ushort v177, v4, s[48:51], s60 offen
    s_mov_b32 s60, 177408
    buffer_load_ushort v178, v4, s[48:51], s60 offen
    s_mov_b32 s60, 178304
    buffer_load_ushort v179, v4, s[48:51], s60 offen
    s_mov_b32 s60, 182784
    buffer_load_ushort v180, v4, s[48:51], s60 offen
    s_mov_b32 s60, 183680
    buffer_load_ushort v181, v4, s[48:51], s60 offen
    s_mov_b32 s60, 184576
    buffer_load_ushort v182, v4, s[48:51], s60 offen
    s_mov_b32 s60, 185472
    buffer_load_ushort v183, v4, s[48:51], s60 offen
    s_mov_b32 s60, 189952
    buffer_load_ushort v184, v4, s[48:51], s60 offen
    s_mov_b32 s60, 190848
    buffer_load_ushort v185, v4, s[48:51], s60 offen
    s_mov_b32 s60, 191744
    buffer_load_ushort v186, v4, s[48:51], s60 offen
    s_mov_b32 s60, 192640
    buffer_load_ushort v187, v4, s[48:51], s60 offen
    s_mov_b32 s60, 197120
    buffer_load_ushort v188, v6, s[48:51], s60 offen
    s_mov_b32 s60, 198016
    buffer_load_ushort v189, v6, s[48:51], s60 offen
    s_mov_b32 s60, 198912
    buffer_load_ushort v190, v6, s[48:51], s60 offen
    s_mov_b32 s60, 199808
    buffer_load_ushort v191, v6, s[48:51], s60 offen
    s_waitcnt vmcnt(0)
    v_lshl_or_b32 v96, v129, 16, v128
    v_lshl_or_b32 v97, v131, 16, v130
    v_lshl_or_b32 v98, v133, 16, v132
    v_lshl_or_b32 v99, v135, 16, v134
    v_lshl_or_b32 v100, v137, 16, v136
    v_lshl_or_b32 v101, v139, 16, v138
    v_lshl_or_b32 v102, v141, 16, v140
    v_lshl_or_b32 v103, v143, 16, v142
    v_lshl_or_b32 v104, v145, 16, v144
    v_lshl_or_b32 v105, v147, 16, v146
    v_lshl_or_b32 v106, v149, 16, v148
    v_lshl_or_b32 v107, v151, 16, v150
    v_lshl_or_b32 v108, v153, 16, v152
    v_lshl_or_b32 v109, v155, 16, v154
    v_lshl_or_b32 v110, v157, 16, v156
    v_lshl_or_b32 v111, v159, 16, v158
    v_lshl_or_b32 v112, v161, 16, v160
    v_lshl_or_b32 v113, v163, 16, v162
    v_lshl_or_b32 v114, v165, 16, v164
    v_lshl_or_b32 v115, v167, 16, v166
    v_lshl_or_b32 v116, v169, 16, v168
    v_lshl_or_b32 v117, v171, 16, v170
    v_lshl_or_b32 v118, v173, 16, v172
    v_lshl_or_b32 v119, v175, 16, v174
    v_lshl_or_b32 v120, v177, 16, v176
    v_lshl_or_b32 v121, v179, 16, v178
    v_lshl_or_b32 v122, v181, 16, v180
    v_lshl_or_b32 v123, v183, 16, v182
    v_lshl_or_b32 v124, v185, 16, v184
    v_lshl_or_b32 v125, v187, 16, v186
    v_lshl_or_b32 v126, v189, 16, v188
    v_lshl_or_b32 v127, v191, 16, v190
    buffer_store_dwordx4 v[64:67], v5, s[44:47], s9 offen offset:0
    buffer_store_dwordx4 v[68:71], v5, s[44:47], s9 offen offset:1024
    buffer_store_dwordx4 v[72:75], v5, s[44:47], s9 offen offset:2048
    buffer_store_dwordx4 v[76:79], v5, s[44:47], s9 offen offset:3072
    s_add_u32 s9, s9, 4096
    buffer_store_dwordx4 v[80:83], v5, s[44:47], s9 offen offset:0
    buffer_store_dwordx4 v[84:87], v5, s[44:47], s9 offen offset:1024
    buffer_store_dwordx4 v[88:91], v5, s[44:47], s9 offen offset:2048
    buffer_store_dwordx4 v[92:95], v5, s[44:47], s9 offen offset:3072
    s_add_u32 s9, s9, 4096
    buffer_store_dwordx4 v[96:99], v5, s[44:47], s9 offen offset:0
    buffer_store_dwordx4 v[100:103], v5, s[44:47], s9 offen offset:1024
    buffer_store_dwordx4 v[104:107], v5, s[44:47], s9 offen offset:2048
    buffer_store_dwordx4 v[108:111], v5, s[44:47], s9 offen offset:3072
    s_add_u32 s9, s9, 4096
    buffer_store_dwordx4 v[112:115], v5, s[44:47], s9 offen offset:0
    buffer_store_dwordx4 v[116:119], v5, s[44:47], s9 offen offset:1024
    buffer_store_dwordx4 v[120:123], v5, s[44:47], s9 offen offset:2048
    buffer_store_dwordx4 v[124:127], v5, s[44:47], s9 offen offset:3072
    s_branch prep_kernel_done
prep_kernel_f5:
    s_sub_u32 s4, s4, 1788
    s_lshl_b32 s9, s4, 14
    s_add_u32 s9, s9, 198447104
    s_sub_u32 s4, s4, 0
    v_mov_b32 v64, 0
    v_mov_b32 v65, 0
    v_mov_b32 v66, 0
    v_mov_b32 v67, 0
    v_mov_b32 v68, 0
    v_mov_b32 v69, 0
    v_mov_b32 v70, 0
    v_mov_b32 v71, 0
    v_mov_b32 v72, 0
    v_mov_b32 v73, 0
    v_mov_b32 v74, 0
    v_mov_b32 v75, 0
    v_mov_b32 v76, 0
    v_mov_b32 v77, 0
    v_mov_b32 v78, 0
    v_mov_b32 v79, 0
    v_mov_b32 v80, 0
    v_mov_b32 v81, 0
    v_mov_b32 v82, 0
    v_mov_b32 v83, 0
    v_mov_b32 v84, 0
    v_mov_b32 v85, 0
    v_mov_b32 v86, 0
    v_mov_b32 v87, 0
    v_mov_b32 v88, 0
    v_mov_b32 v89, 0
    v_mov_b32 v90, 0
    v_mov_b32 v91, 0
    v_mov_b32 v92, 0
    v_mov_b32 v93, 0
    v_mov_b32 v94, 0
    v_mov_b32 v95, 0
    v_mov_b32 v96, 0
    v_mov_b32 v97, 0
    v_mov_b32 v98, 0
    v_mov_b32 v99, 0
    v_mov_b32 v100, 0
    v_mov_b32 v101, 0
    v_mov_b32 v102, 0
    v_mov_b32 v103, 0
    v_mov_b32 v104, 0
    v_mov_b32 v105, 0
    v_mov_b32 v106, 0
    v_mov_b32 v107, 0
    v_mov_b32 v108, 0
    v_mov_b32 v109, 0
    v_mov_b32 v110, 0
    v_mov_b32 v111, 0
    v_mov_b32 v112, 0
    v_mov_b32 v113, 0
    v_mov_b32 v114, 0
    v_mov_b32 v115, 0
    v_mov_b32 v116, 0
    v_mov_b32 v117, 0
    v_mov_b32 v118, 0
    v_mov_b32 v119, 0
    v_mov_b32 v120, 0
    v_mov_b32 v121, 0
    v_mov_b32 v122, 0
    v_mov_b32 v123, 0
    v_mov_b32 v124, 0
    v_mov_b32 v125, 0
    v_mov_b32 v126, 0
    v_mov_b32 v127, 0
    s_and_b32 s5, s4, 31
    s_cmp_ge_u32 s4, 64
    s_cbranch_scc1 prep_kernel_z6
    s_cmp_lg_u32 s5, 0
    s_cbranch_scc1 prep_kernel_z6
    s_mov_b32 s48, s24
    s_mov_b32 s49, s25
    s_mov_b32 s50, 7168
    s_mov_b32 s51, 0x00020000
    v_add_u32 v4, 4096, v5
    buffer_load_dwordx4 v[64:67], v5, s[48:51], 0 offen offset:0
    buffer_load_dwordx4 v[68:71], v5, s[48:51], 0 offen offset:1024
    buffer_load_dwordx4 v[72:75], v5, s[48:51], 0 offen offset:2048
    buffer_load_dwordx4 v[76:79], v5, s[48:51], 0 offen offset:3072
    buffer_load_dwordx4 v[80:83], v4, s[48:51], 0 offen offset:0
    buffer_load_dwordx4 v[84:87], v4, s[48:51], 0 offen offset:1024
    buffer_load_dwordx4 v[88:91], v4, s[48:51], 0 offen offset:2048
    v_mov_b32 v12, 0x80000000
    s_waitcnt vmcnt(0)
    v_cmp_eq_u32 vcc, 0, v64
    s_nop 1
    v_cndmask_b32 v64, v64, v12, vcc
    v_cmp_eq_u32 vcc, 0, v65
    s_nop 1
    v_cndmask_b32 v65, v65, v12, vcc
    v_cmp_eq_u32 vcc, 0, v66
    s_nop 1
    v_cndmask_b32 v66, v66, v12, vcc
    v_cmp_eq_u32 vcc, 0, v67
    s_nop 1
    v_cndmask_b32 v67, v67, v12, vcc
    v_cmp_eq_u32 vcc, 0, v68
    s_nop 1
    v_cndmask_b32 v68, v68, v12, vcc
    v_cmp_eq_u32 vcc, 0, v69
    s_nop 1
    v_cndmask_b32 v69, v69, v12, vcc
    v_cmp_eq_u32 vcc, 0, v70
    s_nop 1
    v_cndmask_b32 v70, v70, v12, vcc
    v_cmp_eq_u32 vcc, 0, v71
    s_nop 1
    v_cndmask_b32 v71, v71, v12, vcc
    v_cmp_eq_u32 vcc, 0, v72
    s_nop 1
    v_cndmask_b32 v72, v72, v12, vcc
    v_cmp_eq_u32 vcc, 0, v73
    s_nop 1
    v_cndmask_b32 v73, v73, v12, vcc
    v_cmp_eq_u32 vcc, 0, v74
    s_nop 1
    v_cndmask_b32 v74, v74, v12, vcc
    v_cmp_eq_u32 vcc, 0, v75
    s_nop 1
    v_cndmask_b32 v75, v75, v12, vcc
    v_cmp_eq_u32 vcc, 0, v76
    s_nop 1
    v_cndmask_b32 v76, v76, v12, vcc
    v_cmp_eq_u32 vcc, 0, v77
    s_nop 1
    v_cndmask_b32 v77, v77, v12, vcc
    v_cmp_eq_u32 vcc, 0, v78
    s_nop 1
    v_cndmask_b32 v78, v78, v12, vcc
    v_cmp_eq_u32 vcc, 0, v79
    s_nop 1
    v_cndmask_b32 v79, v79, v12, vcc
    v_cmp_eq_u32 vcc, 0, v80
    s_nop 1
    v_cndmask_b32 v80, v80, v12, vcc
    v_cmp_eq_u32 vcc, 0, v81
    s_nop 1
    v_cndmask_b32 v81, v81, v12, vcc
    v_cmp_eq_u32 vcc, 0, v82
    s_nop 1
    v_cndmask_b32 v82, v82, v12, vcc
    v_cmp_eq_u32 vcc, 0, v83
    s_nop 1
    v_cndmask_b32 v83, v83, v12, vcc
    v_cmp_eq_u32 vcc, 0, v84
    s_nop 1
    v_cndmask_b32 v84, v84, v12, vcc
    v_cmp_eq_u32 vcc, 0, v85
    s_nop 1
    v_cndmask_b32 v85, v85, v12, vcc
    v_cmp_eq_u32 vcc, 0, v86
    s_nop 1
    v_cndmask_b32 v86, v86, v12, vcc
    v_cmp_eq_u32 vcc, 0, v87
    s_nop 1
    v_cndmask_b32 v87, v87, v12, vcc
    v_cmp_eq_u32 vcc, 0, v88
    s_nop 1
    v_cndmask_b32 v88, v88, v12, vcc
    v_cmp_eq_u32 vcc, 0, v89
    s_nop 1
    v_cndmask_b32 v89, v89, v12, vcc
    v_cmp_eq_u32 vcc, 0, v90
    s_nop 1
    v_cndmask_b32 v90, v90, v12, vcc
    v_cmp_eq_u32 vcc, 0, v91
    s_nop 1
    v_cndmask_b32 v91, v91, v12, vcc
prep_kernel_z6:
    buffer_store_dwordx4 v[64:67], v5, s[44:47], s9 offen offset:0
    buffer_store_dwordx4 v[68:71], v5, s[44:47], s9 offen offset:1024
    buffer_store_dwordx4 v[72:75], v5, s[44:47], s9 offen offset:2048
    buffer_store_dwordx4 v[76:79], v5, s[44:47], s9 offen offset:3072
    s_add_u32 s9, s9, 4096
    buffer_store_dwordx4 v[80:83], v5, s[44:47], s9 offen offset:0
    buffer_store_dwordx4 v[84:87], v5, s[44:47], s9 offen offset:1024
    buffer_store_dwordx4 v[88:91], v5, s[44:47], s9 offen offset:2048
    buffer_store_dwordx4 v[92:95], v5, s[44:47], s9 offen offset:3072
    s_add_u32 s9, s9, 4096
    buffer_store_dwordx4 v[96:99], v5, s[44:47], s9 offen offset:0
    buffer_store_dwordx4 v[100:103], v5, s[44:47], s9 offen offset:1024
    buffer_store_dwordx4 v[104:107], v5, s[44:47], s9 offen offset:2048
    buffer_store_dwordx4 v[108:111], v5, s[44:47], s9 offen offset:3072
    s_add_u32 s9, s9, 4096
    buffer_store_dwordx4 v[112:115], v5, s[44:47], s9 offen offset:0
    buffer_store_dwordx4 v[116:119], v5, s[44:47], s9 offen offset:1024
    buffer_store_dwordx4 v[120:123], v5, s[44:47], s9 offen offset:2048
    buffer_store_dwordx4 v[124:127], v5, s[44:47], s9 offen offset:3072
    s_branch prep_kernel_done
prep_kernel_e4:
    s_sub_u32 s4, s4, 1532
    s_lshl_b32 s4, s4, 3
    s_mov_b32 s48, s16
    s_mov_b32 s49, s17
    s_mov_b32 s50, 1835008
    s_mov_b32 s51, 0x00020000
    s_mul_i32 s5, s4, 896
    v_mov_b32 v6, 2147483392
    v_cmp_gt_u32 vcc, 56, v62
    s_nop 1
    v_cndmask_b32 v4, v6, v5, vcc
    v_lshrrev_b32 v12, 1, v62
    v_lshlrev_b32 v12, 10, v12
    v_and_b32 v13, 1, v62
    v_lshl_add_u32 v12, v13, 9, v12
    v_cndmask_b32 v12, v6, v12, vcc
    v_lshlrev_b32 v14, 8, v62
    v_cmp_gt_u32 vcc, 14, v62
    s_nop 1
    v_cndmask_b32 v14, v6, v14, vcc
    s_lshr_b32 s6, s4, 5
    s_mul_i32 s8, s6, 3584
    s_mul_i32 s6, s6, 28672
    s_and_b32 s7, s4, 31
    s_lshl_b32 s9, s7, 3
    s_add_u32 s8, s8, s9
    s_add_u32 s8, s8, 7340032
    s_lshl_b32 s7, s7, 4
    s_add_u32 s6, s6, s7
    s_add_u32 s6, s6, 0
    buffer_load_dwordx4 v[64:67], v4, s[48:51], s5 offen offset:0
    buffer_load_dwordx4 v[68:71], v4, s[48:51], s5 offen offset:896
    buffer_load_dwordx4 v[72:75], v4, s[48:51], s5 offen offset:1792
    buffer_load_dwordx4 v[76:79], v4, s[48:51], s5 offen offset:2688
    s_add_u32 s10, s5, 3584
    buffer_load_dwordx4 v[80:83], v4, s[48:51], s10 offen offset:0
    buffer_load_dwordx4 v[84:87], v4, s[48:51], s10 offen offset:896
    buffer_load_dwordx4 v[88:91], v4, s[48:51], s10 offen offset:1792
    buffer_load_dwordx4 v[92:95], v4, s[48:51], s10 offen offset:2688
    s_waitcnt vmcnt(0)
    buffer_store_dwordx4 v[64:67], v12, s[44:47], s6 offen offset:0
    v_lshlrev_b32 v16, 16, v64
    v_and_b32 v17, 0xffff0000, v64
    v_lshlrev_b32 v18, 16, v65
    v_and_b32 v19, 0xffff0000, v65
    v_lshlrev_b32 v20, 16, v66
    v_and_b32 v21, 0xffff0000, v66
    v_lshlrev_b32 v22, 16, v67
    v_and_b32 v23, 0xffff0000, v67
    v_add_f32 v100, v16, v17
    v_add_f32 v100, v100, v18
    v_add_f32 v100, v100, v19
    v_add_f32 v100, v100, v20
    v_add_f32 v100, v100, v21
    v_add_f32 v100, v100, v22
    v_add_f32 v100, v100, v23
    v_mul_f32 v101, v16, v16
    v_fmac_f32 v101, v17, v17
    v_fmac_f32 v101, v18, v18
    v_fmac_f32 v101, v19, v19
    v_fmac_f32 v101, v20, v20
    v_fmac_f32 v101, v21, v21
    v_fmac_f32 v101, v22, v22
    v_fmac_f32 v101, v23, v23
    buffer_store_dwordx4 v[68:71], v12, s[44:47], s6 offen offset:16
    v_lshlrev_b32 v16, 16, v68
    v_and_b32 v17, 0xffff0000, v68
    v_lshlrev_b32 v18, 16, v69
    v_and_b32 v19, 0xffff0000, v69
    v_lshlrev_b32 v20, 16, v70
    v_and_b32 v21, 0xffff0000, v70
    v_lshlrev_b32 v22, 16, v71
    v_and_b32 v23, 0xffff0000, v71
    v_add_f32 v102, v16, v17
    v_add_f32 v102, v102, v18
    v_add_f32 v102, v102, v19
    v_add_f32 v102, v102, v20
    v_add_f32 v102, v102, v21
    v_add_f32 v102, v102, v22
    v_add_f32 v102, v102, v23
    v_mul_f32 v103, v16, v16
    v_fmac_f32 v103, v17, v17
    v_fmac_f32 v103, v18, v18
    v_fmac_f32 v103, v19, v19
    v_fmac_f32 v103, v20, v20
    v_fmac_f32 v103, v21, v21
    v_fmac_f32 v103, v22, v22
    v_fmac_f32 v103, v23, v23
    buffer_store_dwordx4 v[72:75], v12, s[44:47], s6 offen offset:32
    v_lshlrev_b32 v16, 16, v72
    v_and_b32 v17, 0xffff0000, v72
    v_lshlrev_b32 v18, 16, v73
    v_and_b32 v19, 0xffff0000, v73
    v_lshlrev_b32 v20, 16, v74
    v_and_b32 v21, 0xffff0000, v74
    v_lshlrev_b32 v22, 16, v75
    v_and_b32 v23, 0xffff0000, v75
    v_add_f32 v104, v16, v17
    v_add_f32 v104, v104, v18
    v_add_f32 v104, v104, v19
    v_add_f32 v104, v104, v20
    v_add_f32 v104, v104, v21
    v_add_f32 v104, v104, v22
    v_add_f32 v104, v104, v23
    v_mul_f32 v105, v16, v16
    v_fmac_f32 v105, v17, v17
    v_fmac_f32 v105, v18, v18
    v_fmac_f32 v105, v19, v19
    v_fmac_f32 v105, v20, v20
    v_fmac_f32 v105, v21, v21
    v_fmac_f32 v105, v22, v22
    v_fmac_f32 v105, v23, v23
    buffer_store_dwordx4 v[76:79], v12, s[44:47], s6 offen offset:48
    v_lshlrev_b32 v16, 16, v76
    v_and_b32 v17, 0xffff0000, v76
    v_lshlrev_b32 v18, 16, v77
    v_and_b32 v19, 0xffff0000, v77
    v_lshlrev_b32 v20, 16, v78
    v_and_b32 v21, 0xffff0000, v78
    v_lshlrev_b32 v22, 16, v79
    v_and_b32 v23, 0xffff0000, v79
    v_add_f32 v106, v16, v17
    v_add_f32 v106, v106, v18
    v_add_f32 v106, v106, v19
    v_add_f32 v106, v106, v20
    v_add_f32 v106, v106, v21
    v_add_f32 v106, v106, v22
    v_add_f32 v106, v106, v23
    v_mul_f32 v107, v16, v16
    v_fmac_f32 v107, v17, v17
    v_fmac_f32 v107, v18, v18
    v_fmac_f32 v107, v19, v19
    v_fmac_f32 v107, v20, v20
    v_fmac_f32 v107, v21, v21
    v_fmac_f32 v107, v22, v22
    v_fmac_f32 v107, v23, v23
    buffer_store_dwordx4 v[80:83], v12, s[44:47], s6 offen offset:64
    v_lshlrev_b32 v16, 16, v80
    v_and_b32 v17, 0xffff0000, v80
    v_lshlrev_b32 v18, 16, v81
    v_and_b32 v19, 0xffff0000, v81
    v_lshlrev_b32 v20, 16, v82
    v_and_b32 v21, 0xffff0000, v82
    v_lshlrev_b32 v22, 16, v83
    v_and_b32 v23, 0xffff0000, v83
    v_add_f32 v108, v16, v17
    v_add_f32 v108, v108, v18
    v_add_f32 v108, v108, v19
    v_add_f32 v108, v108, v20
    v_add_f32 v108, v108, v21
    v_add_f32 v108, v108, v22
    v_add_f32 v108, v108, v23
    v_mul_f32 v109, v16, v16
    v_fmac_f32 v109, v17, v17
    v_fmac_f32 v109, v18, v18
    v_fmac_f32 v109, v19, v19
    v_fmac_f32 v109, v20, v20
    v_fmac_f32 v109, v21, v21
    v_fmac_f32 v109, v22, v22
    v_fmac_f32 v109, v23, v23
    buffer_store_dwordx4 v[84:87], v12, s[44:47], s6 offen offset:80
    v_lshlrev_b32 v16, 16, v84
    v_and_b32 v17, 0xffff0000, v84
    v_lshlrev_b32 v18, 16, v85
    v_and_b32 v19, 0xffff0000, v85
    v_lshlrev_b32 v20, 16, v86
    v_and_b32 v21, 0xffff0000, v86
    v_lshlrev_b32 v22, 16, v87
    v_and_b32 v23, 0xffff0000, v87
    v_add_f32 v110, v16, v17
    v_add_f32 v110, v110, v18
    v_add_f32 v110, v110, v19
    v_add_f32 v110, v110, v20
    v_add_f32 v110, v110, v21
    v_add_f32 v110, v110, v22
    v_add_f32 v110, v110, v23
    v_mul_f32 v111, v16, v16
    v_fmac_f32 v111, v17, v17
    v_fmac_f32 v111, v18, v18
    v_fmac_f32 v111, v19, v19
    v_fmac_f32 v111, v20, v20
    v_fmac_f32 v111, v21, v21
    v_fmac_f32 v111, v22, v22
    v_fmac_f32 v111, v23, v23
    buffer_store_dwordx4 v[88:91], v12, s[44:47], s6 offen offset:96
    v_lshlrev_b32 v16, 16, v88
    v_and_b32 v17, 0xffff0000, v88
    v_lshlrev_b32 v18, 16, v89
    v_and_b32 v19, 0xffff0000, v89
    v_lshlrev_b32 v20, 16, v90
    v_and_b32 v21, 0xffff0000, v90
    v_lshlrev_b32 v22, 16, v91
    v_and_b32 v23, 0xffff0000, v91
    v_add_f32 v112, v16, v17
    v_add_f32 v112, v112, v18
    v_add_f32 v112, v112, v19
    v_add_f32 v112, v112, v20
    v_add_f32 v112, v112, v21
    v_add_f32 v112, v112, v22
    v_add_f32 v112, v112, v23
    v_mul_f32 v113, v16, v16
    v_fmac_f32 v113, v17, v17
    v_fmac_f32 v113, v18, v18
    v_fmac_f32 v113, v19, v19
    v_fmac_f32 v113, v20, v20
    v_fmac_f32 v113, v21, v21
    v_fmac_f32 v113, v22, v22
    v_fmac_f32 v113, v23, v23
    buffer_store_dwordx4 v[92:95], v12, s[44:47], s6 offen offset:112
    v_lshlrev_b32 v16, 16, v92
    v_and_b32 v17, 0xffff0000, v92
    v_lshlrev_b32 v18, 16, v93
    v_and_b32 v19, 0xffff0000, v93
    v_lshlrev_b32 v20, 16, v94
    v_and_b32 v21, 0xffff0000, v94
    v_lshlrev_b32 v22, 16, v95
    v_and_b32 v23, 0xffff0000, v95
    v_add_f32 v114, v16, v17
    v_add_f32 v114, v114, v18
    v_add_f32 v114, v114, v19
    v_add_f32 v114, v114, v20
    v_add_f32 v114, v114, v21
    v_add_f32 v114, v114, v22
    v_add_f32 v114, v114, v23
    v_mul_f32 v115, v16, v16
    v_fmac_f32 v115, v17, v17
    v_fmac_f32 v115, v18, v18
    v_fmac_f32 v115, v19, v19
    v_fmac_f32 v115, v20, v20
    v_fmac_f32 v115, v21, v21
    v_fmac_f32 v115, v22, v22
    v_fmac_f32 v115, v23, v23
    v_xor_b32 v32, 4, v63
    ds_bpermute_b32 v128, v32, v100
    ds_bpermute_b32 v129, v32, v101
    ds_bpermute_b32 v130, v32, v102
    ds_bpermute_b32 v131, v32, v103
    ds_bpermute_b32 v132, v32, v104
    ds_bpermute_b32 v133, v32, v105
    ds_bpermute_b32 v134, v32, v106
    ds_bpermute_b32 v135, v32, v107
    ds_bpermute_b32 v136, v32, v108
    ds_bpermute_b32 v137, v32, v109
    ds_bpermute_b32 v138, v32, v110
    ds_bpermute_b32 v139, v32, v111
    ds_bpermute_b32 v140, v32, v112
    ds_bpermute_b32 v141, v32, v113
    ds_bpermute_b32 v142, v32, v114
    ds_bpermute_b32 v143, v32, v115
    s_waitcnt lgkmcnt(0)
    v_add_f32 v100, v100, v128
    v_add_f32 v101, v101, v129
    v_add_f32 v102, v102, v130
    v_add_f32 v103, v103, v131
    v_add_f32 v104, v104, v132
    v_add_f32 v105, v105, v133
    v_add_f32 v106, v106, v134
    v_add_f32 v107, v107, v135
    v_add_f32 v108, v108, v136
    v_add_f32 v109, v109, v137
    v_add_f32 v110, v110, v138
    v_add_f32 v111, v111, v139
    v_add_f32 v112, v112, v140
    v_add_f32 v113, v113, v141
    v_add_f32 v114, v114, v142
    v_add_f32 v115, v115, v143
    v_xor_b32 v32, 8, v63
    ds_bpermute_b32 v128, v32, v100
    ds_bpermute_b32 v129, v32, v101
    ds_bpermute_b32 v130, v32, v102
    ds_bpermute_b32 v131, v32, v103
    ds_bpermute_b32 v132, v32, v104
    ds_bpermute_b32 v133, v32, v105
    ds_bpermute_b32 v134, v32, v106
    ds_bpermute_b32 v135, v32, v107
    ds_bpermute_b32 v136, v32, v108
    ds_bpermute_b32 v137, v32, v109
    ds_bpermute_b32 v138, v32, v110
    ds_bpermute_b32 v139, v32, v111
    ds_bpermute_b32 v140, v32, v112
    ds_bpermute_b32 v141, v32, v113
    ds_bpermute_b32 v142, v32, v114
    ds_bpermute_b32 v143, v32, v115
    s_waitcnt lgkmcnt(0)
    v_add_f32 v100, v100, v128
    v_add_f32 v101, v101, v129
    v_add_f32 v102, v102, v130
    v_add_f32 v103, v103, v131
    v_add_f32 v104, v104, v132
    v_add_f32 v105, v105, v133
    v_add_f32 v106, v106, v134
    v_add_f32 v107, v107, v135
    v_add_f32 v108, v108, v136
    v_add_f32 v109, v109, v137
    v_add_f32 v110, v110, v138
    v_add_f32 v111, v111, v139
    v_add_f32 v112, v112, v140
    v_add_f32 v113, v113, v141
    v_add_f32 v114, v114, v142
    v_add_f32 v115, v115, v143
    v_xor_b32 v32, 16, v63
    ds_bpermute_b32 v128, v32, v100
    ds_bpermute_b32 v129, v32, v101
    ds_bpermute_b32 v130, v32, v102
    ds_bpermute_b32 v131, v32, v103
    ds_bpermute_b32 v132, v32, v104
    ds_bpermute_b32 v133, v32, v105
    ds_bpermute_b32 v134, v32, v106
    ds_bpermute_b32 v135, v32, v107
    ds_bpermute_b32 v136, v32, v108
    ds_bpermute_b32 v137, v32, v109
    ds_bpermute_b32 v138, v32, v110
    ds_bpermute_b32 v139, v32, v111
    ds_bpermute_b32 v140, v32, v112
    ds_bpermute_b32 v141, v32, v113
    ds_bpermute_b32 v142, v32, v114
    ds_bpermute_b32 v143, v32, v115
    s_waitcnt lgkmcnt(0)
    v_add_f32 v100, v100, v128
    v_add_f32 v101, v101, v129
    v_add_f32 v102, v102, v130
    v_add_f32 v103, v103, v131
    v_add_f32 v104, v104, v132
    v_add_f32 v105, v105, v133
    v_add_f32 v106, v106, v134
    v_add_f32 v107, v107, v135
    v_add_f32 v108, v108, v136
    v_add_f32 v109, v109, v137
    v_add_f32 v110, v110, v138
    v_add_f32 v111, v111, v139
    v_add_f32 v112, v112, v140
    v_add_f32 v113, v113, v141
    v_add_f32 v114, v114, v142
    v_add_f32 v115, v115, v143
    v_xor_b32 v32, 32, v63
    ds_bpermute_b32 v128, v32, v100
    ds_bpermute_b32 v129, v32, v101
    ds_bpermute_b32 v130, v32, v102
    ds_bpermute_b32 v131, v32, v103
    ds_bpermute_b32 v132, v32, v104
    ds_bpermute_b32 v133, v32, v105
    ds_bpermute_b32 v134, v32, v106
    ds_bpermute_b32 v135, v32, v107
    ds_bpermute_b32 v136, v32, v108
    ds_bpermute_b32 v137, v32, v109
    ds_bpermute_b32 v138, v32, v110
    ds_bpermute_b32 v139, v32, v111
    ds_bpermute_b32 v140, v32, v112
    ds_bpermute_b32 v141, v32, v113
    ds_bpermute_b32 v142, v32, v114
    ds_bpermute_b32 v143, v32, v115
    s_waitcnt lgkmcnt(0)
    v_add_f32 v100, v100, v128
    v_add_f32 v101, v101, v129
    v_add_f32 v102, v102, v130
    v_add_f32 v103, v103, v131
    v_add_f32 v104, v104, v132
    v_add_f32 v105, v105, v133
    v_add_f32 v106, v106, v134
    v_add_f32 v107, v107, v135
    v_add_f32 v108, v108, v136
    v_add_f32 v109, v109, v137
    v_add_f32 v110, v110, v138
    v_add_f32 v111, v111, v139
    v_add_f32 v112, v112, v140
    v_add_f32 v113, v113, v141
    v_add_f32 v114, v114, v142
    v_add_f32 v115, v115, v143
    v_xor_b32 v32, 64, v63
    ds_bpermute_b32 v128, v32, v100
    ds_bpermute_b32 v129, v32, v101
    ds_bpermute_b32 v130, v32, v102
    ds_bpermute_b32 v131, v32, v103
    ds_bpermute_b32 v132, v32, v104
    ds_bpermute_b32 v133, v32, v105
    ds_bpermute_b32 v134, v32, v106
    ds_bpermute_b32 v135, v32, v107
    ds_bpermute_b32 v136, v32, v108
    ds_bpermute_b32 v137, v32, v109
    ds_bpermute_b32 v138, v32, v110
    ds_bpermute_b32 v139, v32, v111
    ds_bpermute_b32 v140, v32, v112
    ds_bpermute_b32 v141, v32, v113
    ds_bpermute_b32 v142, v32, v114
    ds_bpermute_b32 v143, v32, v115
    s_waitcnt lgkmcnt(0)
    v_add_f32 v100, v100, v128
    v_add_f32 v101, v101, v129
    v_add_f32 v102, v102, v130
    v_add_f32 v103, v103, v131
    v_add_f32 v104, v104, v132
    v_add_f32 v105, v105, v133
    v_add_f32 v106, v106, v134
    v_add_f32 v107, v107, v135
    v_add_f32 v108, v108, v136
    v_add_f32 v109, v109, v137
    v_add_f32 v110, v110, v138
    v_add_f32 v111, v111, v139
    v_add_f32 v112, v112, v140
    v_add_f32 v113, v113, v141
    v_add_f32 v114, v114, v142
    v_add_f32 v115, v115, v143
    v_xor_b32 v32, 128, v63
    ds_bpermute_b32 v128, v32, v100
    ds_bpermute_b32 v129, v32, v101
    ds_bpermute_b32 v130, v32, v102
    ds_bpermute_b32 v131, v32, v103
    ds_bpermute_b32 v132, v32, v104
    ds_bpermute_b32 v133, v32, v105
    ds_bpermute_b32 v134, v32, v106
    ds_bpermute_b32 v135, v32, v107
    ds_bpermute_b32 v136, v32, v108
    ds_bpermute_b32 v137, v32, v109
    ds_bpermute_b32 v138, v32, v110
    ds_bpermute_b32 v139, v32, v111
    ds_bpermute_b32 v140, v32, v112
    ds_bpermute_b32 v141, v32, v113
    ds_bpermute_b32 v142, v32, v114
    ds_bpermute_b32 v143, v32, v115
    s_waitcnt lgkmcnt(0)
    v_add_f32 v100, v100, v128
    v_add_f32 v101, v101, v129
    v_add_f32 v102, v102, v130
    v_add_f32 v103, v103, v131
    v_add_f32 v104, v104, v132
    v_add_f32 v105, v105, v133
    v_add_f32 v106, v106, v134
    v_add_f32 v107, v107, v135
    v_add_f32 v108, v108, v136
    v_add_f32 v109, v109, v137
    v_add_f32 v110, v110, v138
    v_add_f32 v111, v111, v139
    v_add_f32 v112, v112, v140
    v_add_f32 v113, v113, v141
    v_add_f32 v114, v114, v142
    v_add_f32 v115, v115, v143
    v_cmp_eq_u32 vcc, 0, v62
    s_nop 1
    v_cndmask_b32 v100, 0, v100, vcc
    v_cndmask_b32 v101, 0, v101, vcc
    v_cndmask_b32 v102, 0, v102, vcc
    v_cndmask_b32 v103, 0, v103, vcc
    v_cndmask_b32 v104, 0, v104, vcc
    v_cndmask_b32 v105, 0, v105, vcc
    v_cndmask_b32 v106, 0, v106, vcc
    v_cndmask_b32 v107, 0, v107, vcc
    v_cndmask_b32 v108, 0, v108, vcc
    v_cndmask_b32 v109, 0, v109, vcc
    v_cndmask_b32 v110, 0, v110, vcc
    v_cndmask_b32 v111, 0, v111, vcc
    v_cndmask_b32 v112, 0, v112, vcc
    v_cndmask_b32 v113, 0, v113, vcc
    v_cndmask_b32 v114, 0, v114, vcc
    v_cndmask_b32 v115, 0, v115, vcc
    buffer_store_dwordx2 v[100:101], v14, s[44:47], s8 offen offset:0
    buffer_store_dwordx2 v[102:103], v14, s[44:47], s8 offen offset:8
    buffer_store_dwordx2 v[104:105], v14, s[44:47], s8 offen offset:16
    buffer_store_dwordx2 v[106:107], v14, s[44:47], s8 offen offset:24
    buffer_store_dwordx2 v[108:109], v14, s[44:47], s8 offen offset:32
    buffer_store_dwordx2 v[110:111], v14, s[44:47], s8 offen offset:40
    buffer_store_dwordx2 v[112:113], v14, s[44:47], s8 offen offset:48
    buffer_store_dwordx2 v[114:115], v14, s[44:47], s8 offen offset:56
prep_kernel_done:
    s_endpgm

.text
.globl mega_kernel
.p2align 8
.type mega_kernel,@function
mega_kernel:
    s_cmp_ge_u32 s2, 256
    s_cbranch_scc1 mega_kernel_done
    s_load_dwordx16 s[16:31], s[0:1], 0
    s_load_dwordx8 s[32:39], s[0:1], 64
    s_load_dwordx2 s[40:41], s[0:1], 96
    v_lshrrev_b32 v1, 6, v0
    v_and_b32 v62, 63, v0
    s_nop 0
    v_readfirstlane_b32 s3, v1
    s_getreg_b32 s4, hwreg(HW_REG_XCC_ID)
    s_and_b32 s4, s4, 7
    s_waitcnt lgkmcnt(0)
    s_mov_b32 s44, s40
    s_mov_b32 s45, s41
    s_mov_b32 s46, 268435456
    s_mov_b32 s47, 0x00020000
    s_mov_b32 s48, s38
    s_mov_b32 s49, s39
    s_mov_b32 s50, 256
    s_mov_b32 s51, 0x00020000
    s_mov_b32 s52, s36
    s_mov_b32 s53, s37
    s_mov_b32 s54, 1835008
    s_mov_b32 s55, 0x00020000
    s_cmp_lg_u32 s3, 0
    s_cbranch_scc1 mega_kernel_el1
    s_mov_b64 s[6:7], exec
    s_mov_b64 exec, 1
    s_mov_b32 s14, 201035776
    v_mov_b32 v8, 1
    s_lshl_b32 s5, s4, 8
    v_mov_b32 v9, s5
    buffer_atomic_add v8, v9, s[44:47], s14 offen sc0
    s_waitcnt vmcnt(0)
    v_readfirstlane_b32 s8, v8
    s_lshl_b32 s13, s4, 5
    s_add_u32 s13, s13, s8
    s_cmp_lt_u32 s8, 32
    s_cbranch_scc1 mega_kernel_w3
    v_mov_b32 v8, 1
    v_mov_b32 v9, 2048
    buffer_atomic_add v8, v9, s[44:47], s14 offen sc0
    s_waitcnt vmcnt(0)
    v_readfirstlane_b32 s9, v8
    s_mov_b64 exec, 0xff
    v_lshlrev_b32 v9, 8, v62
    s_mov_b32 s12, 0
mega_kernel_sp4:
    buffer_load_dword v8, v9, s[44:47], s14 offen sc1
    s_waitcnt vmcnt(0)
    s_mov_b32 s10, 0
    v_readlane_b32 s60, v8, 0
    s_add_u32 s10, s10, s60
    v_readlane_b32 s61, v8, 1
    s_add_u32 s10, s10, s61
    v_readlane_b32 s62, v8, 2
    s_add_u32 s10, s10, s62
    v_readlane_b32 s63, v8, 3
    s_add_u32 s10, s10, s63
    v_readlane_b32 s64, v8, 4
    s_add_u32 s10, s10, s64
    v_readlane_b32 s65, v8, 5
    s_add_u32 s10, s10, s65
    v_readlane_b32 s66, v8, 6
    s_add_u32 s10, s10, s66
    v_readlane_b32 s67, v8, 7
    s_add_u32 s10, s10, s67
    s_cmp_ge_u32 s10, 256
    s_cbranch_scc1 mega_kernel_sc5
    s_sleep 4
    s_add_u32 s12, s12, 1
    s_cmp_lt_u32 s12, 2000000
    s_cbranch_scc1 mega_kernel_sp4
mega_kernel_sc5:
    s_mov_b32 s13, 255
    s_min_u32 s10, s60, 32
    s_sub_u32 s11, 32, s10
    s_cmp_ge_u32 s9, s11
    s_cbranch_scc1 mega_kernel_x7
    s_add_u32 s13, s10, s9
    s_add_u32 s13, s13, 0
    s_branch mega_kernel_nx6
mega_kernel_x7:
    s_sub_u32 s9, s9, s11
    s_min_u32 s10, s61, 32
    s_sub_u32 s11, 32, s10
    s_cmp_ge_u32 s9, s11
    s_cbranch_scc1 mega_kernel_x8
    s_add_u32 s13, s10, s9
    s_add_u32 s13, s13, 32
    s_branch mega_kernel_nx6
mega_kernel_x8:
    s_sub_u32 s9, s9, s11
    s_min_u32 s10, s62, 32
    s_sub_u32 s11, 32, s10
    s_cmp_ge_u32 s9, s11
    s_cbranch_scc1 mega_kernel_x9
    s_add_u32 s13, s10, s9
    s_add_u32 s13, s13, 64
    s_branch mega_kernel_nx6
mega_kernel_x9:
    s_sub_u32 s9, s9, s11
    s_min_u32 s10, s63, 32
    s_sub_u32 s11, 32, s10
    s_cmp_ge_u32 s9, s11
    s_cbranch_scc1 mega_kernel_x10
    s_add_u32 s13, s10, s9
    s_add_u32 s13, s13, 96
    s_branch mega_kernel_nx6
mega_kernel_x10:
    s_sub_u32 s9, s9, s11
    s_min_u32 s10, s64, 32
    s_sub_u32 s11, 32, s10
    s_cmp_ge_u32 s9, s11
    s_cbranch_scc1 mega_kernel_x11
    s_add_u32 s13, s10, s9
    s_add_u32 s13, s13, 128
    s_branch mega_kernel_nx6
mega_kernel_x11:
    s_sub_u32 s9, s9, s11
    s_min_u32 s10, s65, 32
    s_sub_u32 s11, 32, s10
    s_cmp_ge_u32 s9, s11
    s_cbranch_scc1 mega_kernel_x12
    s_add_u32 s13, s10, s9
    s_add_u32 s13, s13, 160
    s_branch mega_kernel_nx6
mega_kernel_x12:
    s_sub_u32 s9, s9, s11
    s_min_u32 s10, s66, 32
    s_sub_u32 s11, 32, s10
    s_cmp_ge_u32 s9, s11
    s_cbranch_scc1 mega_kernel_x13
    s_add_u32 s13, s10, s9
    s_add_u32 s13, s13, 192
    s_branch mega_kernel_nx6
mega_kernel_x13:
    s_sub_u32 s9, s9, s11
    s_min_u32 s10, s67, 32
    s_sub_u32 s11, 32, s10
    s_cmp_ge_u32 s9, s11
    s_cbranch_scc1 mega_kernel_x14
    s_add_u32 s13, s10, s9
    s_add_u32 s13, s13, 224
    s_branch mega_kernel_nx6
mega_kernel_x14:
    s_sub_u32 s9, s9, s11
mega_kernel_nx6:
    s_mov_b64 exec, 1
mega_kernel_w3:
    v_mov_b32 v8, s13
    v_mov_b32 v9, 159744
    ds_write_b32 v9, v8
    s_waitcnt lgkmcnt(0)
    s_mov_b64 exec, s[6:7]
mega_kernel_el1:
    s_barrier
    v_mov_b32 v9, 159744
    ds_read_b32 v8, v9
    s_waitcnt lgkmcnt(0)
    v_readfirstlane_b32 s13, v8
    s_nop 3
    s_cmp_lt_u32 s13, 32
    s_cbranch_scc1 mega_kernel_nd16
    s_cmp_lt_u32 s13, 64
    s_cbranch_scc1 mega_kernel_nd16_d
    s_cmp_lt_u32 s13, 158
    s_cbranch_scc1 mega_kernel_nd16
mega_kernel_nd16_d:
    s_mov_b32 s31, 0
    s_mov_b32 s20, 0
    s_lshl_b32 s37, s20, 8
    s_lshl_b32 s33, s31, 14
    s_add_u32 s37, s37, s33
    s_add_u32 s37, s37, 200839168
    v_lshlrev_b32 v9, 2, v62
    v_cmp_gt_u32 s[38:39], 6, v62
    s_mov_b32 s12, 0
mega_kernel_fp17:
    buffer_load_dword v8, v9, s[44:47], s37 offen sc1
    s_waitcnt vmcnt(0)
    v_cmp_eq_u32 vcc, 0, v8
    s_and_b64 s[40:41], vcc, s[38:39]
    s_cbranch_scc0 mega_kernel_fo18
    s_sleep 1
    s_add_u32 s12, s12, 1
    s_cmp_lt_u32 s12, 2000000
    s_cbranch_scc1 mega_kernel_fp17
mega_kernel_fo18:
mega_kernel_nd16:
    s_cmp_ge_u32 s13, 64
    s_cbranch_scc1 mega_kernel_worker15
    v_and_b32 v2, 15, v62
    v_lshrrev_b32 v3, 4, v62
    s_bfe_u32 s31, s13, 0x10005
    s_lshl_b32 s30, s31, 19
    s_add_u32 s30, s30, 198447104
    s_mul_i32 s36, s31, 655360
    s_add_u32 s36, s36, 199495680
    s_lshl_b32 s32, s31, 14
    s_and_b32 s5, s13, 31
    s_lshl_b32 s5, s5, 2
    s_add_u32 s32, s32, s5
    s_add_u32 s32, s32, 200969984
    v_lshlrev_b32 v50, 4, v0
    v_add_u32 v51, 4096, v50
    v_mov_b32 v8, 2147483392
    v_cmp_gt_u32 vcc, 192, v0
    s_nop 1
    v_cndmask_b32 v51, v8, v51, vcc
    v_cndmask_b32 v54, -1, 0, vcc
    v_mul_u32_u24 v9, 1171, v0
    v_lshrrev_b32 v9, 16, v9
    v_mul_u32_u24 v10, 56, v9
    v_sub_u32 v10, v0, v10
    v_mul_u32_u24 v52, 912, v9
    v_lshl_add_u32 v52, v10, 4, v52
    v_add_u32 v52, 131072, v52
    v_add_u32 v11, 256, v0
    v_mul_u32_u24 v9, 1171, v11
    v_lshrrev_b32 v9, 16, v9
    v_mul_u32_u24 v10, 56, v9
    v_sub_u32 v10, v11, v10
    v_mul_u32_u24 v53, 912, v9
    v_lshl_add_u32 v53, v10, 4, v53
    v_add_u32 v53, 131072, v53
    v_mov_b32 v8, 159760
    v_cndmask_b32 v53, v8, v53, vcc
    v_and_b32 v9, 7, v2
    v_mul_u32_u24 v55, 912, v9
    v_lshl_add_u32 v55, v3, 4, v55
    v_add_u32 v55, 131072, v55
    v_lshlrev_b32 v56, 4, v62
    s_lshl_b32 s14, s3, 15
    v_add_u32 v57, s14, v56
    s_and_b32 s5, s13, 16
    s_cmp_lg_u32 s5, 0
    s_cbranch_scc1 mega_kernel_p219
    s_and_b32 s15, s13, 15
    v_lshrrev_b32 v8, 3, v2
    v_lshlrev_b32 v8, 4, v8
    v_bfe_u32 v9, v2, 2, 1
    v_lshl_add_u32 v8, v9, 2, v8
    v_and_b32 v9, 3, v2
    v_add_u32 v8, v8, v9
    v_mov_b32 v58, v8
    v_lshrrev_b32 v9, 1, v3
    v_lshlrev_b32 v9, 10, v9
    v_and_b32 v10, 1, v3
    v_lshl_add_u32 v9, v10, 9, v9
    v_mov_b32 v59, v9
    s_lshl_b32 s16, s15, 3
    s_lshl_b32 s17, s3, 1
    s_add_u32 s16, s16, s17
    s_add_u32 s17, s16, 0
    s_mul_i32 s17, s17, 28672
    v_add_u32 v32, 0, v8
    v_lshl_add_u32 v32, v32, 4, v9
    v_add_u32 v32, s17, v32
    s_add_u32 s17, s16, 0
    s_mul_i32 s17, s17, 28672
    v_add_u32 v33, 8, v8
    v_lshl_add_u32 v33, v33, 4, v9
    v_add_u32 v33, s17, v33
    s_add_u32 s17, s16, 1
    s_mul_i32 s17, s17, 28672
    v_add_u32 v34, 0, v8
    v_lshl_add_u32 v34, v34, 4, v9
    v_add_u32 v34, s17, v34
    s_add_u32 s17, s16, 1
    s_mul_i32 s17, s17, 28672
    v_add_u32 v35, 8, v8
    v_lshl_add_u32 v35, v35, 4, v9
    v_add_u32 v35, s17, v35
    s_add_u32 s17, s16, 128
    s_mul_i32 s17, s17, 28672
    v_add_u32 v36, 0, v8
    v_lshl_add_u32 v36, v36, 4, v9
    v_add_u32 v36, s17, v36
    s_add_u32 s17, s16, 128
    s_mul_i32 s17, s17, 28672
    v_add_u32 v37, 8, v8
    v_lshl_add_u32 v37, v37, 4, v9
    v_add_u32 v37, s17, v37
    s_add_u32 s17, s16, 129
    s_mul_i32 s17, s17, 28672
    v_add_u32 v38, 0, v8
    v_lshl_add_u32 v38, v38, 4, v9
    v_add_u32 v38, s17, v38
    s_add_u32 s17, s16, 129
    s_mul_i32 s17, s17, 28672
    v_add_u32 v39, 8, v8
    v_lshl_add_u32 v39, v39, 4, v9
    v_add_u32 v39, s17, v39
    s_mov_b32 s22, 8257536
    v_add_u32 v4, 0, v32
    buffer_load_dwordx4 a[0:3], v4, s[44:47], s22 offen offset:0
    buffer_load_dwordx4 a[12:15], v4, s[44:47], s22 offen offset:2048
    v_add_u32 v4, 4096, v32
    buffer_load_dwordx4 a[24:27], v4, s[44:47], s22 offen offset:0
    buffer_load_dwordx4 a[36:39], v4, s[44:47], s22 offen offset:2048
    v_add_u32 v4, 8192, v32
    buffer_load_dwordx4 a[48:51], v4, s[44:47], s22 offen offset:0
    buffer_load_dwordx4 v[64:67], v4, s[44:47], s22 offen offset:2048
    v_add_u32 v4, 12288, v32
    buffer_load_dwordx4 v[68:71], v4, s[44:47], s22 offen offset:0
    buffer_load_dwordx4 a[80:83], v4, s[44:47], s22 offen offset:2048
    v_add_u32 v4, 16384, v32
    buffer_load_dwordx4 a[92:95], v4, s[44:47], s22 offen offset:0
    buffer_load_dwordx4 a[104:107], v4, s[44:47], s22 offen offset:2048
    v_add_u32 v4, 20480, v32
    buffer_load_dwordx4 a[116:119], v4, s[44:47], s22 offen offset:0
    buffer_load_dwordx4 a[128:131], v4, s[44:47], s22 offen offset:2048
    v_add_u32 v4, 24576, v32
    buffer_load_dwordx4 v[72:75], v4, s[44:47], s22 offen offset:0
    buffer_load_dwordx4 v[76:79], v4, s[44:47], s22 offen offset:2048
    v_add_u32 v4, 0, v33
    buffer_load_dwordx4 a[4:7], v4, s[44:47], s22 offen offset:0
    buffer_load_dwordx4 a[16:19], v4, s[44:47], s22 offen offset:2048
    v_add_u32 v4, 4096, v33
    buffer_load_dwordx4 a[28:31], v4, s[44:47], s22 offen offset:0
    buffer_load_dwordx4 v[80:83], v4, s[44:47], s22 offen offset:2048
    v_add_u32 v4, 8192, v33
    buffer_load_dwordx4 v[84:87], v4, s[44:47], s22 offen offset:0
    buffer_load_dwordx4 a[60:63], v4, s[44:47], s22 offen offset:2048
    v_add_u32 v4, 12288, v33
    buffer_load_dwordx4 a[72:75], v4, s[44:47], s22 offen offset:0
    buffer_load_dwordx4 a[84:87], v4, s[44:47], s22 offen offset:2048
    v_add_u32 v4, 16384, v33
    buffer_load_dwordx4 a[96:99], v4, s[44:47], s22 offen offset:0
    buffer_load_dwordx4 a[108:111], v4, s[44:47], s22 offen offset:2048
    v_add_u32 v4, 20480, v33
    buffer_load_dwordx4 v[88:91], v4, s[44:47], s22 offen offset:0
    buffer_load_dwordx4 v[92:95], v4, s[44:47], s22 offen offset:2048
    v_add_u32 v4, 24576, v33
    buffer_load_dwordx4 a[140:143], v4, s[44:47], s22 offen offset:0
    buffer_load_dwordx4 a[152:155], v4, s[44:47], s22 offen offset:2048
    v_add_u32 v4, 0, v34
    buffer_load_dwordx4 a[8:11], v4, s[44:47], s22 offen offset:0
    buffer_load_dwordx4 v[96:99], v4, s[44:47], s22 offen offset:2048
    v_add_u32 v4, 4096, v34
    buffer_load_dwordx4 v[100:103], v4, s[44:47], s22 offen offset:0
    buffer_load_dwordx4 a[40:43], v4, s[44:47], s22 offen offset:2048
    v_add_u32 v4, 8192, v34
    buffer_load_dwordx4 a[52:55], v4, s[44:47], s22 offen offset:0
    buffer_load_dwordx4 a[64:67], v4, s[44:47], s22 offen offset:2048
    v_add_u32 v4, 12288, v34
    buffer_load_dwordx4 a[76:79], v4, s[44:47], s22 offen offset:0
    buffer_load_dwordx4 a[88:91], v4, s[44:47], s22 offen offset:2048
    v_add_u32 v4, 16384, v34
    buffer_load_dwordx4 v[104:107], v4, s[44:47], s22 offen offset:0
    buffer_load_dwordx4 v[108:111], v4, s[44:47], s22 offen offset:2048
    v_add_u32 v4, 20480, v34
    buffer_load_dwordx4 a[120:123], v4, s[44:47], s22 offen offset:0
    buffer_load_dwordx4 a[132:135], v4, s[44:47], s22 offen offset:2048
    v_add_u32 v4, 24576, v34
    buffer_load_dwordx4 a[144:147], v4, s[44:47], s22 offen offset:0
    buffer_load_dwordx4 a[156:159], v4, s[44:47], s22 offen offset:2048
    v_add_u32 v4, 0, v35
    buffer_load_dwordx4 v[112:115], v4, s[44:47], s22 offen offset:0
    buffer_load_dwordx4 a[20:23], v4, s[44:47], s22 offen offset:2048
    v_add_u32 v4, 4096, v35
    buffer_load_dwordx4 a[32:35], v4, s[44:47], s22 offen offset:0
    buffer_load_dwordx4 a[44:47], v4, s[44:47], s22 offen offset:2048
    v_add_u32 v4, 8192, v35
    buffer_load_dwordx4 a[56:59], v4, s[44:47], s22 offen offset:0
    buffer_load_dwordx4 a[68:71], v4, s[44:47], s22 offen offset:2048
    v_add_u32 v4, 12288, v35
    buffer_load_dwordx4 v[116:119], v4, s[44:47], s22 offen offset:0
    s_waitcnt vmcnt(0)
    ds_write_b128 v57, v[64:67] offset:5120
    ds_write_b128 v57, v[68:71] offset:6144
    ds_write_b128 v57, v[72:75] offset:13312
    ds_write_b128 v57, v[76:79] offset:14336
    ds_write_b128 v57, v[80:83] offset:3072
    ds_write_b128 v57, v[84:87] offset:4096
    ds_write_b128 v57, v[88:91] offset:11264
    ds_write_b128 v57, v[92:95] offset:12288
    ds_write_b128 v57, v[96:99] offset:1024
    ds_write_b128 v57, v[100:103] offset:2048
    ds_write_b128 v57, v[104:107] offset:9216
    ds_write_b128 v57, v[108:111] offset:10240
    ds_write_b128 v57, v[112:115] offset:0
    ds_write_b128 v57, v[116:119] offset:7168
    s_waitcnt lgkmcnt(0)
    buffer_load_dwordx4 v[64:67], v4, s[44:47], s22 offen offset:2048
    v_add_u32 v4, 16384, v35
    buffer_load_dwordx4 a[100:103], v4, s[44:47], s22 offen offset:0
    buffer_load_dwordx4 a[112:115], v4, s[44:47], s22 offen offset:2048
    v_add_u32 v4, 20480, v35
    buffer_load_dwordx4 a[124:127], v4, s[44:47], s22 offen offset:0
    buffer_load_dwordx4 a[136:139], v4, s[44:47], s22 offen offset:2048
    v_add_u32 v4, 24576, v35
    buffer_load_dwordx4 a[148:151], v4, s[44:47], s22 offen offset:0
    buffer_load_dwordx4 v[68:71], v4, s[44:47], s22 offen offset:2048
    v_add_u32 v4, 0, v36
    buffer_load_dwordx4 a[160:163], v4, s[44:47], s22 offen offset:0
    buffer_load_dwordx4 a[172:175], v4, s[44:47], s22 offen offset:2048
    v_add_u32 v4, 4096, v36
    buffer_load_dwordx4 a[184:187], v4, s[44:47], s22 offen offset:0
    buffer_load_dwordx4 a[196:199], v4, s[44:47], s22 offen offset:2048
    v_add_u32 v4, 8192, v36
    buffer_load_dwordx4 a[208:211], v4, s[44:47], s22 offen offset:0
    buffer_load_dwordx4 v[72:75], v4, s[44:47], s22 offen offset:2048
    v_add_u32 v4, 12288, v36
    buffer_load_dwordx4 v[76:79], v4, s[44:47], s22 offen offset:0
    buffer_load_dwordx4 a[240:243], v4, s[44:47], s22 offen offset:2048
    v_add_u32 v4, 16384, v36
    buffer_load_dwordx4 a[252:255], v4, s[44:47], s22 offen offset:0
    buffer_load_dwordx4 v[200:203], v4, s[44:47], s22 offen offset:2048
    v_add_u32 v4, 20480, v36
    buffer_load_dwordx4 v[212:215], v4, s[44:47], s22 offen offset:0
    buffer_load_dwordx4 v[224:227], v4, s[44:47], s22 offen offset:2048
    v_add_u32 v4, 24576, v36
    buffer_load_dwordx4 v[80:83], v4, s[44:47], s22 offen offset:0
    buffer_load_dwordx4 v[84:87], v4, s[44:47], s22 offen offset:2048
    v_add_u32 v4, 0, v37
    buffer_load_dwordx4 a[164:167], v4, s[44:47], s22 offen offset:0
    buffer_load_dwordx4 a[176:179], v4, s[44:47], s22 offen offset:2048
    v_add_u32 v4, 4096, v37
    buffer_load_dwordx4 a[188:191], v4, s[44:47], s22 offen offset:0
    buffer_load_dwordx4 v[88:91], v4, s[44:47], s22 offen offset:2048
    v_add_u32 v4, 8192, v37
    buffer_load_dwordx4 v[92:95], v4, s[44:47], s22 offen offset:0
    buffer_load_dwordx4 a[220:223], v4, s[44:47], s22 offen offset:2048
    v_add_u32 v4, 12288, v37
    buffer_load_dwordx4 a[232:235], v4, s[44:47], s22 offen offset:0
    buffer_load_dwordx4 a[244:247], v4, s[44:47], s22 offen offset:2048
    v_add_u32 v4, 16384, v37
    buffer_load_dwordx4 v[192:195], v4, s[44:47], s22 offen offset:0
    buffer_load_dwordx4 v[204:207], v4, s[44:47], s22 offen offset:2048
    v_add_u32 v4, 20480, v37
    buffer_load_dwordx4 v[96:99], v4, s[44:47], s22 offen offset:0
    buffer_load_dwordx4 v[100:103], v4, s[44:47], s22 offen offset:2048
    v_add_u32 v4, 24576, v37
    buffer_load_dwordx4 v[236:239], v4, s[44:47], s22 offen offset:0
    buffer_load_dwordx4 v[248:251], v4, s[44:47], s22 offen offset:2048
    v_add_u32 v4, 0, v38
    buffer_load_dwordx4 a[168:171], v4, s[44:47], s22 offen offset:0
    buffer_load_dwordx4 v[104:107], v4, s[44:47], s22 offen offset:2048
    v_add_u32 v4, 4096, v38
    buffer_load_dwordx4 v[108:111], v4, s[44:47], s22 offen offset:0
    buffer_load_dwordx4 a[200:203], v4, s[44:47], s22 offen offset:2048
    v_add_u32 v4, 8192, v38
    buffer_load_dwordx4 a[212:215], v4, s[44:47], s22 offen offset:0
    buffer_load_dwordx4 a[224:227], v4, s[44:47], s22 offen offset:2048
    v_add_u32 v4, 12288, v38
    buffer_load_dwordx4 a[236:239], v4, s[44:47], s22 offen offset:0
    buffer_load_dwordx4 a[248:251], v4, s[44:47], s22 offen offset:2048
    v_add_u32 v4, 16384, v38
    buffer_load_dwordx4 v[112:115], v4, s[44:47], s22 offen offset:0
    buffer_load_dwordx4 v[116:119], v4, s[44:47], s22 offen offset:2048
    s_waitcnt vmcnt(0)
    ds_write_b128 v57, v[64:67] offset:8192
    ds_write_b128 v57, v[68:71] offset:15360
    ds_write_b128 v57, v[72:75] offset:21504
    ds_write_b128 v57, v[76:79] offset:22528
    ds_write_b128 v57, v[80:83] offset:29696
    ds_write_b128 v57, v[84:87] offset:30720
    ds_write_b128 v57, v[88:91] offset:19456
    ds_write_b128 v57, v[92:95] offset:20480
    ds_write_b128 v57, v[96:99] offset:27648
    ds_write_b128 v57, v[100:103] offset:28672
    ds_write_b128 v57, v[104:107] offset:17408
    ds_write_b128 v57, v[108:111] offset:18432
    ds_write_b128 v57, v[112:115] offset:25600
    ds_write_b128 v57, v[116:119] offset:26624
    s_waitcnt lgkmcnt(0)
    v_add_u32 v4, 20480, v38
    buffer_load_dwordx4 v[216:219], v4, s[44:47], s22 offen offset:0
    buffer_load_dwordx4 v[228:231], v4, s[44:47], s22 offen offset:2048
    v_add_u32 v4, 24576, v38
    buffer_load_dwordx4 v[240:243], v4, s[44:47], s22 offen offset:0
    buffer_load_dwordx4 v[252:255], v4, s[44:47], s22 offen offset:2048
    v_add_u32 v4, 0, v39
    buffer_load_dwordx4 v[64:67], v4, s[44:47], s22 offen offset:0
    buffer_load_dwordx4 a[180:183], v4, s[44:47], s22 offen offset:2048
    v_add_u32 v4, 4096, v39
    buffer_load_dwordx4 a[192:195], v4, s[44:47], s22 offen offset:0
    buffer_load_dwordx4 a[204:207], v4, s[44:47], s22 offen offset:2048
    v_add_u32 v4, 8192, v39
    buffer_load_dwordx4 a[216:219], v4, s[44:47], s22 offen offset:0
    buffer_load_dwordx4 a[228:231], v4, s[44:47], s22 offen offset:2048
    v_add_u32 v4, 12288, v39
    buffer_load_dwordx4 v[68:71], v4, s[44:47], s22 offen offset:0
    buffer_load_dwordx4 v[72:75], v4, s[44:47], s22 offen offset:2048
    v_add_u32 v4, 16384, v39
    buffer_load_dwordx4 v[196:199], v4, s[44:47], s22 offen offset:0
    buffer_load_dwordx4 v[208:211], v4, s[44:47], s22 offen offset:2048
    v_add_u32 v4, 20480, v39
    buffer_load_dwordx4 v[220:223], v4, s[44:47], s22 offen offset:0
    buffer_load_dwordx4 v[232:235], v4, s[44:47], s22 offen offset:2048
    v_add_u32 v4, 24576, v39
    buffer_load_dwordx4 v[244:247], v4, s[44:47], s22 offen offset:0
    buffer_load_dwordx4 v[76:79], v4, s[44:47], s22 offen offset:2048
    s_waitcnt vmcnt(0)
    ds_write_b128 v57, v[64:67] offset:16384
    ds_write_b128 v57, v[68:71] offset:23552
    ds_write_b128 v57, v[72:75] offset:24576
    ds_write_b128 v57, v[76:79] offset:31744
    s_waitcnt lgkmcnt(0)
    s_waitcnt vmcnt(0) lgkmcnt(0)
    v_lshl_add_u32 v44, v58, 4, v59
    s_add_u32 s17, s16, 128
    s_lshl_b32 s17, s17, 11
    s_add_u32 s23, s17, 44302336
    s_mul_i32 s17, s31, 33554432
    s_add_u32 s23, s23, s17
    v_lshlrev_b32 v45, 7, v3
    v_lshl_add_u32 v45, v2, 4, v45
    v_mov_b32 v8, 2147483392
    v_cmp_gt_u32 vcc, 8, v2
    s_nop 1
    v_cndmask_b32 v45, v8, v45, vcc
    s_lshl_b32 s24, s15, 12
    s_lshl_b32 s17, s3, 10
    s_add_u32 s24, s24, s17
    s_mul_i32 s17, s31, 4194304
    s_add_u32 s24, s24, s17
    s_add_u32 s24, s24, 170135552
    v_mul_u32_u24 v46, 80, v2
    v_lshl_add_u32 v47, v3, 3, v46
    v_add_u32 v47, 64, v47
    v_lshl_add_u32 v46, v3, 4, v46
    v_cndmask_b32 v46, v8, v46, vcc
    v_cndmask_b32 v47, v8, v47, vcc
    v_cmp_gt_u32 s[26:27], 2, v3
    s_nop 1
    v_cndmask_b32 v47, v8, v47, s[26:27]
    s_mul_i32 s25, s15, 640
    s_add_u32 s25, s25, s36
    v_mul_u32_u24 v48, 48, v62
    s_mul_i32 s17, s3, 3072
    s_add_u32 s17, s17, 139264
    v_add_u32 v49, s17, v48
    v_add_u32 v48, 139264, v48
    s_mov_b32 s28, 0x3db8aa3b
    s_mov_b32 s20, 0
    s_mov_b32 s29, 0
    s_mov_b32 s14, 201035776
    v_lshlrev_b32 v9, 8, v62
    v_mov_b32 v8, 2147483392
    v_cmp_gt_u32 vcc, 8, v62
    s_nop 1
    v_cndmask_b32 v9, v8, v9, vcc
    s_mov_b32 s12, 0
mega_kernel_mp20:
    buffer_load_dword v8, v9, s[44:47], s14 offen sc1
    s_waitcnt vmcnt(0)
    v_readlane_b32 s10, v8, s31
    s_cmp_ge_u32 s10, 32
    s_cbranch_scc1 mega_kernel_mf22
    s_mov_b32 s10, 0
    v_readlane_b32 s11, v8, 0
    s_add_u32 s10, s10, s11
    v_readlane_b32 s11, v8, 1
    s_add_u32 s10, s10, s11
    v_readlane_b32 s11, v8, 2
    s_add_u32 s10, s10, s11
    v_readlane_b32 s11, v8, 3
    s_add_u32 s10, s10, s11
    v_readlane_b32 s11, v8, 4
    s_add_u32 s10, s10, s11
    v_readlane_b32 s11, v8, 5
    s_add_u32 s10, s10, s11
    v_readlane_b32 s11, v8, 6
    s_add_u32 s10, s10, s11
    v_readlane_b32 s11, v8, 7
    s_add_u32 s10, s10, s11
    s_cmp_ge_u32 s10, 256
    s_cbranch_scc1 mega_kernel_mo21
    s_sleep 4
    s_add_u32 s12, s12, 1
    s_cmp_lt_u32 s12, 2000000
    s_cbranch_scc1 mega_kernel_mp20
mega_kernel_mo21:
    s_mov_b32 s29, 1
mega_kernel_mf22:
    s_lshl_b32 s37, s20, 8
    s_lshl_b32 s33, s31, 14
    s_add_u32 s37, s37, s33
    s_add_u32 s37, s37, 200937472
    v_lshlrev_b32 v7, 2, v62
    v_cmp_gt_u32 s[38:39], 60, v62
    s_mov_b32 s12, 0
mega_kernel_fp23:
    buffer_load_dword v6, v7, s[44:47], s37 offen sc1
    s_waitcnt vmcnt(0)
    v_cmp_eq_u32 vcc, 0, v6
    s_and_b64 s[40:41], vcc, s[38:39]
    s_cbranch_scc0 mega_kernel_fo24
    s_sleep 1
    s_add_u32 s12, s12, 1
    s_cmp_lt_u32 s12, 2000000
    s_cbranch_scc1 mega_kernel_fp23
mega_kernel_fo24:
    buffer_load_dwordx4 v[168:171], v44, s[44:47], s23 offen offset:0 sc1
    buffer_load_dwordx4 v[172:175], v44, s[44:47], s23 offen offset:2048 sc1
    buffer_load_dwordx4 v[176:179], v44, s[44:47], s23 offen offset:128 sc1
    buffer_load_dwordx4 v[180:183], v44, s[44:47], s23 offen offset:2176 sc1
    s_lshl_b32 s4, s31, 14
    s_add_u32 s4, s4, 200937728
    v_lshlrev_b32 v7, 2, v62
    v_cmp_gt_u32 s[10:11], 60, v62
mega_kernel_loop25:
    s_lshl_b32 s21, s20, 13
    s_add_u32 s21, s21, s30
    s_mov_b32 s12, 0
    buffer_load_dwordx4 v[8:11], v50, s[44:47], s21 offen sc1
    buffer_load_dwordx4 v[12:15], v51, s[44:47], s21 offen sc1
mega_kernel_gp28:
    buffer_load_dwordx4 v[120:123], v50, s[44:47], s21 offen sc1
    buffer_load_dwordx4 v[124:127], v51, s[44:47], s21 offen sc1
    s_waitcnt vmcnt(2)
    v_min3_u32 v4, v8, v9, v10
    v_min3_u32 v5, v12, v13, v14
    v_min_u32 v4, v4, v11
    v_min_u32 v5, v5, v15
    v_or_b32 v5, v5, v54
    v_min_u32 v4, v4, v5
    v_cmp_eq_u32 vcc, 0, v4
    s_cbranch_vccz mega_kernel_go29
    buffer_load_dwordx4 v[8:11], v50, s[44:47], s21 offen sc1
    buffer_load_dwordx4 v[12:15], v51, s[44:47], s21 offen sc1
    s_waitcnt vmcnt(2)
    v_min3_u32 v4, v120, v121, v122
    v_min3_u32 v5, v124, v125, v126
    v_min_u32 v4, v4, v123
    v_min_u32 v5, v5, v127
    v_or_b32 v5, v5, v54
    v_min_u32 v4, v4, v5
    v_cmp_eq_u32 vcc, 0, v4
    s_cbranch_vccz mega_kernel_gb31
    s_add_u32 s12, s12, 1
    s_cmp_lt_u32 s12, 2000000
    s_cbranch_scc1 mega_kernel_gp28
mega_kernel_gb31:
    ds_write_b128 v52, v[120:123]
    ds_write_b128 v53, v[124:127]
    s_branch mega_kernel_gw32
mega_kernel_go29:
    ds_write_b128 v52, v[8:11]
    ds_write_b128 v53, v[12:15]
mega_kernel_gw32:
    s_waitcnt lgkmcnt(0)
    s_barrier
    ds_read_b128 v[64:67], v55 offset:0
    ds_read_b128 v[68:71], v55 offset:64
    ds_read_b128 v[72:75], v55 offset:128
    ds_read_b128 v[76:79], v55 offset:192
    ds_read_b128 v[80:83], v55 offset:256
    ds_read_b128 v[84:87], v55 offset:320
    ds_read_b128 v[88:91], v55 offset:384
    ds_read_b128 v[92:95], v55 offset:448
    ds_read_b128 v[96:99], v55 offset:512
    ds_read_b128 v[100:103], v55 offset:576
    ds_read_b128 v[104:107], v55 offset:640
    ds_read_b128 v[108:111], v55 offset:704
    ds_read_b128 v[112:115], v55 offset:768
    ds_read_b128 v[116:119], v55 offset:832
    s_cmp_lg_u32 s3, 3
    s_cbranch_scc1 mega_kernel_gs30
    s_cmp_lt_u32 s20, 1
    s_cbranch_scc1 mega_kernel_gs30
    s_lshl_b32 s33, s20, 8
    s_add_u32 s33, s33, s32
    s_sub_u32 s33, s33, 0
    s_mov_b64 s[34:35], exec
    s_mov_b64 exec, 1
    v_mov_b32 v4, 1
    v_mov_b32 v5, 0
    buffer_store_dword v4, v5, s[44:47], s33 offen sc1
    s_mov_b64 exec, s[34:35]
    s_waitcnt vmcnt(1)
    s_branch mega_kernel_gs30_x
mega_kernel_gs30:
    s_waitcnt vmcnt(0)
mega_kernel_gs30_x:
    buffer_load_dword v6, v7, s[44:47], s4 offen sc1
    s_add_u32 s4, s4, 256
    ds_read_b128 v[152:155], v57 offset:0
    ds_read_b128 v[156:159], v57 offset:1024
    ds_read_b128 v[160:163], v57 offset:2048
    s_waitcnt lgkmcnt(3)
    v_mfma_f32_16x16x32_bf16 v[120:123], a[0:3], v[64:67], 0
    v_mfma_f32_16x16x32_bf16 v[124:127], a[4:7], v[64:67], 0
    v_mfma_f32_16x16x32_bf16 v[128:131], a[8:11], v[64:67], 0
    s_waitcnt lgkmcnt(2)
    v_mfma_f32_16x16x32_bf16 v[132:135], v[152:155], v[64:67], 0
    ds_read_b128 v[164:167], v57 offset:3072
    v_mfma_f32_16x16x32_bf16 v[120:123], a[12:15], v[68:71], v[120:123]
    v_mfma_f32_16x16x32_bf16 v[124:127], a[16:19], v[68:71], v[124:127]
    s_waitcnt lgkmcnt(2)
    v_mfma_f32_16x16x32_bf16 v[128:131], v[156:159], v[68:71], v[128:131]
    ds_read_b128 v[152:155], v57 offset:4096
    v_mfma_f32_16x16x32_bf16 v[132:135], a[20:23], v[68:71], v[132:135]
    v_mfma_f32_16x16x32_bf16 v[120:123], a[24:27], v[72:75], v[120:123]
    v_mfma_f32_16x16x32_bf16 v[124:127], a[28:31], v[72:75], v[124:127]
    s_waitcnt lgkmcnt(2)
    v_mfma_f32_16x16x32_bf16 v[128:131], v[160:163], v[72:75], v[128:131]
    ds_read_b128 v[156:159], v57 offset:5120
    v_mfma_f32_16x16x32_bf16 v[132:135], a[32:35], v[72:75], v[132:135]
    v_mfma_f32_16x16x32_bf16 v[120:123], a[36:39], v[76:79], v[120:123]
    s_waitcnt lgkmcnt(2)
    v_mfma_f32_16x16x32_bf16 v[124:127], v[164:167], v[76:79], v[124:127]
    ds_read_b128 v[160:163], v57 offset:6144
    v_mfma_f32_16x16x32_bf16 v[128:131], a[40:43], v[76:79], v[128:131]
    v_mfma_f32_16x16x32_bf16 v[132:135], a[44:47], v[76:79], v[132:135]
    v_mfma_f32_16x16x32_bf16 v[120:123], a[48:51], v[80:83], v[120:123]
    s_waitcnt lgkmcnt(2)
    v_mfma_f32_16x16x32_bf16 v[124:127], v[152:155], v[80:83], v[124:127]
    ds_read_b128 v[164:167], v57 offset:7168
    v_mfma_f32_16x16x32_bf16 v[128:131], a[52:55], v[80:83], v[128:131]
    v_mfma_f32_16x16x32_bf16 v[132:135], a[56:59], v[80:83], v[132:135]
    s_waitcnt lgkmcnt(2)
    v_mfma_f32_16x16x32_bf16 v[120:123], v[156:159], v[84:87], v[120:123]
    ds_read_b128 v[152:155], v57 offset:8192
    v_mfma_f32_16x16x32_bf16 v[124:127], a[60:63], v[84:87], v[124:127]
    v_mfma_f32_16x16x32_bf16 v[128:131], a[64:67], v[84:87], v[128:131]
    v_mfma_f32_16x16x32_bf16 v[132:135], a[68:71], v[84:87], v[132:135]
    s_waitcnt lgkmcnt(2)
    v_mfma_f32_16x16x32_bf16 v[120:123], v[160:163], v[88:91], v[120:123]
    ds_read_b128 v[156:159], v57 offset:9216
    v_mfma_f32_16x16x32_bf16 v[124:127], a[72:75], v[88:91], v[124:127]
    v_mfma_f32_16x16x32_bf16 v[128:131], a[76:79], v[88:91], v[128:131]
    s_waitcnt lgkmcnt(2)
    v_mfma_f32_16x16x32_bf16 v[132:135], v[164:167], v[88:91], v[132:135]
    ds_read_b128 v[160:163], v57 offset:10240
    v_mfma_f32_16x16x32_bf16 v[120:123], a[80:83], v[92:95], v[120:123]
    v_mfma_f32_16x16x32_bf16 v[124:127], a[84:87], v[92:95], v[124:127]
    v_mfma_f32_16x16x32_bf16 v[128:131], a[88:91], v[92:95], v[128:131]
    s_waitcnt lgkmcnt(2)
    v_mfma_f32_16x16x32_bf16 v[132:135], v[152:155], v[92:95], v[132:135]
    ds_read_b128 v[164:167], v57 offset:11264
    v_mfma_f32_16x16x32_bf16 v[120:123], a[92:95], v[96:99], v[120:123]
    v_mfma_f32_16x16x32_bf16 v[124:127], a[96:99], v[96:99], v[124:127]
    s_waitcnt lgkmcnt(2)
    v_mfma_f32_16x16x32_bf16 v[128:131], v[156:159], v[96:99], v[128:131]
    ds_read_b128 v[152:155], v57 offset:12288
    v_mfma_f32_16x16x32_bf16 v[132:135], a[100:103], v[96:99], v[132:135]
    v_mfma_f32_16x16x32_bf16 v[120:123], a[104:107], v[100:103], v[120:123]
    v_mfma_f32_16x16x32_bf16 v[124:127], a[108:111], v[100:103], v[124:127]
    s_waitcnt lgkmcnt(2)
    v_mfma_f32_16x16x32_bf16 v[128:131], v[160:163], v[100:103], v[128:131]
    ds_read_b128 v[156:159], v57 offset:13312
    v_mfma_f32_16x16x32_bf16 v[132:135], a[112:115], v[100:103], v[132:135]
    v_mfma_f32_16x16x32_bf16 v[120:123], a[116:119], v[104:107], v[120:123]
    s_waitcnt lgkmcnt(2)
    v_mfma_f32_16x16x32_bf16 v[124:127], v[164:167], v[104:107], v[124:127]
    ds_read_b128 v[160:163], v57 offset:14336
    v_mfma_f32_16x16x32_bf16 v[128:131], a[120:123], v[104:107], v[128:131]
    v_mfma_f32_16x16x32_bf16 v[132:135], a[124:127], v[104:107], v[132:135]
    v_mfma_f32_16x16x32_bf16 v[120:123], a[128:131], v[108:111], v[120:123]
    s_waitcnt lgkmcnt(2)
    v_mfma_f32_16x16x32_bf16 v[124:127], v[152:155], v[108:111], v[124:127]
    ds_read_b128 v[164:167], v57 offset:15360
    v_mfma_f32_16x16x32_bf16 v[128:131], a[132:135], v[108:111], v[128:131]
    v_mfma_f32_16x16x32_bf16 v[132:135], a[136:139], v[108:111], v[132:135]
    s_waitcnt lgkmcnt(2)
    v_mfma_f32_16x16x32_bf16 v[120:123], v[156:159], v[112:115], v[120:123]
    ds_read_b128 v[152:155], v57 offset:16384
    v_mfma_f32_16x16x32_bf16 v[124:127], a[140:143], v[112:115], v[124:127]
    v_mfma_f32_16x16x32_bf16 v[128:131], a[144:147], v[112:115], v[128:131]
    v_mfma_f32_16x16x32_bf16 v[132:135], a[148:151], v[112:115], v[132:135]
    s_waitcnt lgkmcnt(2)
    v_mfma_f32_16x16x32_bf16 v[120:123], v[160:163], v[116:119], v[120:123]
    ds_read_b128 v[156:159], v57 offset:17408
    v_mfma_f32_16x16x32_bf16 v[124:127], a[152:155], v[116:119], v[124:127]
    v_mfma_f32_16x16x32_bf16 v[128:131], a[156:159], v[116:119], v[128:131]
    s_waitcnt lgkmcnt(2)
    v_mfma_f32_16x16x32_bf16 v[132:135], v[164:167], v[116:119], v[132:135]
    ds_read_b128 v[160:163], v57 offset:18432
    v_mfma_f32_16x16x32_bf16 v[136:139], a[160:163], v[64:67], 0
    v_mfma_f32_16x16x32_bf16 v[140:143], a[164:167], v[64:67], 0
    v_mfma_f32_16x16x32_bf16 v[144:147], a[168:171], v[64:67], 0
    s_waitcnt lgkmcnt(2)
    v_mfma_f32_16x16x32_bf16 v[148:151], v[152:155], v[64:67], 0
    ds_read_b128 v[164:167], v57 offset:19456
    v_mfma_f32_16x16x32_bf16 v[136:139], a[172:175], v[68:71], v[136:139]
    v_mfma_f32_16x16x32_bf16 v[140:143], a[176:179], v[68:71], v[140:143]
    s_waitcnt lgkmcnt(2)
    v_mfma_f32_16x16x32_bf16 v[144:147], v[156:159], v[68:71], v[144:147]
    ds_read_b128 v[152:155], v57 offset:20480
    v_mfma_f32_16x16x32_bf16 v[148:151], a[180:183], v[68:71], v[148:151]
    v_mfma_f32_16x16x32_bf16 v[136:139], a[184:187], v[72:75], v[136:139]
    v_mfma_f32_16x16x32_bf16 v[140:143], a[188:191], v[72:75], v[140:143]
    v_cvt_pk_bf16_f32 v16, v120, v121
    v_cvt_pk_bf16_f32 v17, v122, v123
    v_cvt_pk_bf16_f32 v18, v124, v125
    v_cvt_pk_bf16_f32 v19, v126, v127
    v_cvt_pk_bf16_f32 v20, v128, v129
    v_cvt_pk_bf16_f32 v21, v130, v131
    v_cvt_pk_bf16_f32 v22, v132, v133
    v_cvt_pk_bf16_f32 v23, v134, v135
    s_waitcnt lgkmcnt(2)
    v_mfma_f32_16x16x32_bf16 v[144:147], v[160:163], v[72:75], v[144:147]
    ds_read_b128 v[156:159], v57 offset:21504
    v_mfma_f32_16x16x32_bf16 v[148:151], a[192:195], v[72:75], v[148:151]
    v_mfma_f32_16x16x32_bf16 v[136:139], a[196:199], v[76:79], v[136:139]
    s_waitcnt lgkmcnt(2)
    v_mfma_f32_16x16x32_bf16 v[140:143], v[164:167], v[76:79], v[140:143]
    ds_read_b128 v[160:163], v57 offset:22528
    v_mfma_f32_16x16x32_bf16 v[36:39], v[168:171], v[16:19], 0
    v_mfma_f32_16x16x32_bf16 v[40:43], v[176:179], v[16:19], 0
    v_mfma_f32_16x16x32_bf16 v[36:39], v[172:175], v[20:23], v[36:39]
    v_mfma_f32_16x16x32_bf16 v[40:43], v[180:183], v[20:23], v[40:43]
    v_mfma_f32_16x16x32_bf16 v[144:147], a[200:203], v[76:79], v[144:147]
    v_mfma_f32_16x16x32_bf16 v[148:151], a[204:207], v[76:79], v[148:151]
    v_mfma_f32_16x16x32_bf16 v[136:139], a[208:211], v[80:83], v[136:139]
    s_waitcnt lgkmcnt(2)
    v_mfma_f32_16x16x32_bf16 v[140:143], v[152:155], v[80:83], v[140:143]
    ds_read_b128 v[164:167], v57 offset:23552
    v_mfma_f32_16x16x32_bf16 v[144:147], a[212:215], v[80:83], v[144:147]
    v_mfma_f32_16x16x32_bf16 v[148:151], a[216:219], v[80:83], v[148:151]
    s_waitcnt lgkmcnt(2)
    v_mfma_f32_16x16x32_bf16 v[136:139], v[156:159], v[84:87], v[136:139]
    ds_read_b128 v[152:155], v57 offset:24576
    v_mfma_f32_16x16x32_bf16 v[140:143], a[220:223], v[84:87], v[140:143]
    v_mfma_f32_16x16x32_bf16 v[144:147], a[224:227], v[84:87], v[144:147]
    v_mfma_f32_16x16x32_bf16 v[148:151], a[228:231], v[84:87], v[148:151]
    s_waitcnt lgkmcnt(2)
    v_mfma_f32_16x16x32_bf16 v[136:139], v[160:163], v[88:91], v[136:139]
    ds_read_b128 v[156:159], v57 offset:25600
    v_mfma_f32_16x16x32_bf16 v[140:143], a[232:235], v[88:91], v[140:143]
    v_mfma_f32_16x16x32_bf16 v[144:147], a[236:239], v[88:91], v[144:147]
    s_waitcnt lgkmcnt(2)
    v_mfma_f32_16x16x32_bf16 v[148:151], v[164:167], v[88:91], v[148:151]
    ds_read_b128 v[160:163], v57 offset:26624
    v_mfma_f32_16x16x32_bf16 v[136:139], a[240:243], v[92:95], v[136:139]
    v_mfma_f32_16x16x32_bf16 v[140:143], a[244:247], v[92:95], v[140:143]
    v_mfma_f32_16x16x32_bf16 v[144:147], a[248:251], v[92:95], v[144:147]
    s_waitcnt lgkmcnt(2)
    v_mfma_f32_16x16x32_bf16 v[148:151], v[152:155], v[92:95], v[148:151]
    ds_read_b128 v[164:167], v57 offset:27648
    v_mfma_f32_16x16x32_bf16 v[136:139], a[252:255], v[96:99], v[136:139]
    v_mfma_f32_16x16x32_bf16 v[140:143], v[192:195], v[96:99], v[140:143]
    s_waitcnt lgkmcnt(2)
    v_mfma_f32_16x16x32_bf16 v[144:147], v[156:159], v[96:99], v[144:147]
    ds_read_b128 v[152:155], v57 offset:28672
    v_mfma_f32_16x16x32_bf16 v[148:151], v[196:199], v[96:99], v[148:151]
    v_mfma_f32_16x16x32_bf16 v[136:139], v[200:203], v[100:103], v[136:139]
    v_mfma_f32_16x16x32_bf16 v[140:143], v[204:207], v[100:103], v[140:143]
    s_waitcnt lgkmcnt(2)
    v_mfma_f32_16x16x32_bf16 v[144:147], v[160:163], v[100:103], v[144:147]
    ds_read_b128 v[156:159], v57 offset:29696
    v_mfma_f32_16x16x32_bf16 v[148:151], v[208:211], v[100:103], v[148:151]
    v_mfma_f32_16x16x32_bf16 v[136:139], v[212:215], v[104:107], v[136:139]
    s_waitcnt lgkmcnt(2)
    v_mfma_f32_16x16x32_bf16 v[140:143], v[164:167], v[104:107], v[140:143]
    ds_read_b128 v[160:163], v57 offset:30720
    v_mfma_f32_16x16x32_bf16 v[144:147], v[216:219], v[104:107], v[144:147]
    v_mfma_f32_16x16x32_bf16 v[148:151], v[220:223], v[104:107], v[148:151]
    v_mfma_f32_16x16x32_bf16 v[136:139], v[224:227], v[108:111], v[136:139]
    s_waitcnt lgkmcnt(2)
    v_mfma_f32_16x16x32_bf16 v[140:143], v[152:155], v[108:111], v[140:143]
    ds_read_b128 v[164:167], v57 offset:31744
    v_mfma_f32_16x16x32_bf16 v[144:147], v[228:231], v[108:111], v[144:147]
    v_mfma_f32_16x16x32_bf16 v[148:151], v[232:235], v[108:111], v[148:151]
    s_waitcnt lgkmcnt(2)
    v_mfma_f32_16x16x32_bf16 v[136:139], v[156:159], v[112:115], v[136:139]
    v_mfma_f32_16x16x32_bf16 v[140:143], v[236:239], v[112:115], v[140:143]
    v_mfma_f32_16x16x32_bf16 v[144:147], v[240:243], v[112:115], v[144:147]
    v_mfma_f32_16x16x32_bf16 v[148:151], v[244:247], v[112:115], v[148:151]
    s_waitcnt lgkmcnt(1)
    v_mfma_f32_16x16x32_bf16 v[136:139], v[160:163], v[116:119], v[136:139]
    v_mfma_f32_16x16x32_bf16 v[140:143], v[248:251], v[116:119], v[140:143]
    v_mfma_f32_16x16x32_bf16 v[144:147], v[252:255], v[116:119], v[144:147]
    s_waitcnt lgkmcnt(0)
    v_mfma_f32_16x16x32_bf16 v[148:151], v[164:167], v[116:119], v[148:151]
    ds_write_b128 v49, v[36:39] offset:16
    ds_write_b128 v49, v[40:43] offset:32
    s_nop 5
    v_cvt_pk_bf16_f32 v24, v136, v137
    v_cvt_pk_bf16_f32 v25, v138, v139
    v_cvt_pk_bf16_f32 v26, v140, v141
    v_cvt_pk_bf16_f32 v27, v142, v143
    v_cvt_pk_bf16_f32 v28, v144, v145
    v_cvt_pk_bf16_f32 v29, v146, v147
    v_cvt_pk_bf16_f32 v30, v148, v149
    v_cvt_pk_bf16_f32 v31, v150, v151
    s_cmp_eq_u32 s20, 63
    s_cbranch_scc1 mega_kernel_end26
    v_mfma_f32_16x16x32_bf16 v[32:35], v[24:27], v[16:19], 0
    v_mfma_f32_16x16x32_bf16 v[32:35], v[28:31], v[20:23], v[32:35]
    s_add_u32 s23, s23, 524288
    s_nop 6
    ds_write_b128 v49, v[32:35]
    s_waitcnt lgkmcnt(0)
    s_barrier
    s_cmp_lg_u32 s3, 0
    s_cbranch_scc1 mega_kernel_nw027
    ds_read_b128 v[120:123], v48 offset:3072
    ds_read_b128 v[124:127], v48 offset:3088
    ds_read_b128 v[128:131], v48 offset:3104
    ds_read_b128 v[132:135], v48 offset:6144
    ds_read_b128 v[136:139], v48 offset:6160
    ds_read_b128 v[140:143], v48 offset:6176
    ds_read_b128 v[144:147], v48 offset:9216
    ds_read_b128 v[148:151], v48 offset:9232
    ds_read_b128 v[152:155], v48 offset:9248
    s_waitcnt lgkmcnt(0)
    v_pk_add_f32 v[32:33], v[32:33], v[120:121]
    v_pk_add_f32 v[132:133], v[132:133], v[144:145]
    v_pk_add_f32 v[34:35], v[34:35], v[122:123]
    v_pk_add_f32 v[134:135], v[134:135], v[146:147]
    v_pk_add_f32 v[36:37], v[36:37], v[124:125]
    v_pk_add_f32 v[136:137], v[136:137], v[148:149]
    v_pk_add_f32 v[38:39], v[38:39], v[126:127]
    v_pk_add_f32 v[138:139], v[138:139], v[150:151]
    v_pk_add_f32 v[40:41], v[40:41], v[128:129]
    v_pk_add_f32 v[140:141], v[140:141], v[152:153]
    v_pk_add_f32 v[42:43], v[42:43], v[130:131]
    v_pk_add_f32 v[142:143], v[142:143], v[154:155]
    v_pk_add_f32 v[32:33], v[32:33], v[132:133]
    v_pk_add_f32 v[34:35], v[34:35], v[134:135]
    v_pk_add_f32 v[36:37], v[36:37], v[136:137]
    v_pk_add_f32 v[38:39], v[38:39], v[138:139]
    v_pk_add_f32 v[40:41], v[40:41], v[140:141]
    v_pk_add_f32 v[42:43], v[42:43], v[142:143]
    v_mov_b32 v8, 0xff800000
    v_cndmask_b32 v32, v8, v32, s[26:27]
    v_cndmask_b32 v33, v8, v33, s[26:27]
    v_cndmask_b32 v34, v8, v34, s[26:27]
    v_cndmask_b32 v35, v8, v35, s[26:27]
    v_max3_f32 v8, v32, v33, v34
    v_max3_f32 v9, v35, v36, v37
    v_max3_f32 v10, v38, v39, v40
    v_max3_f32 v11, v41, v42, v43
    v_max_f32 v8, v8, v9
    v_max_f32 v10, v10, v11
    v_max_f32 v8, v8, v10
    v_mov_b32 v9, v8
    s_nop 1
    v_permlane16_swap_b32 v8, v9
    s_nop 1
    v_max_f32 v8, v8, v9
    v_mov_b32 v9, v8
    s_nop 1
    v_permlane32_swap_b32 v8, v9
    s_nop 1
    v_max_f32 v8, v8, v9
    v_mul_f32 v8, s28, v8
    v_fma_f32 v32, v32, s28, -v8
    v_fma_f32 v33, v33, s28, -v8
    v_fma_f32 v34, v34, s28, -v8
    v_fma_f32 v35, v35, s28, -v8
    v_fma_f32 v36, v36, s28, -v8
    v_fma_f32 v37, v37, s28, -v8
    v_fma_f32 v38, v38, s28, -v8
    v_fma_f32 v39, v39, s28, -v8
    v_fma_f32 v40, v40, s28, -v8
    v_fma_f32 v41, v41, s28, -v8
    v_fma_f32 v42, v42, s28, -v8
    v_fma_f32 v43, v43, s28, -v8
    v_exp_f32 v32, v32
    v_exp_f32 v33, v33
    v_exp_f32 v34, v34
    v_exp_f32 v35, v35
    v_exp_f32 v36, v36
    v_exp_f32 v37, v37
    v_exp_f32 v38, v38
    v_exp_f32 v39, v39
    v_exp_f32 v40, v40
    v_exp_f32 v41, v41
    v_exp_f32 v42, v42
    v_exp_f32 v43, v43
    s_nop 0
    v_pk_add_f32 v[8:9], v[32:33], v[34:35]
    v_pk_add_f32 v[10:11], v[36:37], v[38:39]
    v_pk_add_f32 v[12:13], v[40:41], v[42:43]
    v_pk_add_f32 v[8:9], v[8:9], v[10:11]
    v_pk_add_f32 v[8:9], v[8:9], v[12:13]
    v_add_f32 v8, v8, v9
    v_mov_b32 v9, v8
    s_nop 1
    v_permlane16_swap_b32 v8, v9
    s_nop 1
    v_add_f32 v8, v8, v9
    v_mov_b32 v9, v8
    s_nop 1
    v_permlane32_swap_b32 v8, v9
    s_nop 1
    v_add_f32 v8, v8, v9
    v_rcp_f32 v8, v8
    s_nop 0
    v_mov_b32 v9, v8
    v_pk_mul_f32 v[32:33], v[32:33], v[8:9]
    v_pk_mul_f32 v[34:35], v[34:35], v[8:9]
    v_pk_mul_f32 v[36:37], v[36:37], v[8:9]
    v_pk_mul_f32 v[38:39], v[38:39], v[8:9]
    v_pk_mul_f32 v[40:41], v[40:41], v[8:9]
    v_pk_mul_f32 v[42:43], v[42:43], v[8:9]
    v_cvt_pk_bf16_f32 v8, v32, v33
    v_cvt_pk_bf16_f32 v9, v34, v35
    v_cvt_pk_bf16_f32 v10, v36, v37
    v_cvt_pk_bf16_f32 v11, v38, v39
    v_cvt_pk_bf16_f32 v12, v40, v41
    v_cvt_pk_bf16_f32 v13, v42, v43
    v_or_b32 v8, 0x80008000, v8
    v_or_b32 v9, 0x80008000, v9
    v_or_b32 v10, 0x80008000, v10
    v_or_b32 v11, 0x80008000, v11
    v_or_b32 v12, 0x80008000, v12
    v_or_b32 v13, 0x80008000, v13
    s_cmp_lg_u32 s29, 0
    s_cbranch_scc1 mega_kernel_ps33
    buffer_store_dwordx4 v[10:13], v46, s[44:47], s25 offen
    buffer_store_dwordx2 v[8:9], v47, s[44:47], s25 offen
    s_branch mega_kernel_pe34
mega_kernel_ps33:
    buffer_store_dwordx4 v[10:13], v46, s[44:47], s25 offen sc1
    buffer_store_dwordx2 v[8:9], v47, s[44:47], s25 offen sc1
mega_kernel_pe34:
mega_kernel_nw027:
    s_barrier
    s_add_u32 s25, s25, 10240
    s_add_u32 s20, s20, 1
    s_waitcnt vmcnt(0)
    v_cmp_eq_u32 vcc, 0, v6
    s_and_b64 s[40:41], vcc, s[10:11]
    s_cbranch_scc0 mega_kernel_fk35
    s_lshl_b32 s37, s20, 8
    s_lshl_b32 s33, s31, 14
    s_add_u32 s37, s37, s33
    s_add_u32 s37, s37, 200937472
    v_lshlrev_b32 v5, 2, v62
    v_cmp_gt_u32 s[38:39], 60, v62
    s_mov_b32 s12, 0
mega_kernel_fp36:
    buffer_load_dword v4, v5, s[44:47], s37 offen sc1
    s_waitcnt vmcnt(0)
    v_cmp_eq_u32 vcc, 0, v4
    s_and_b64 s[40:41], vcc, s[38:39]
    s_cbranch_scc0 mega_kernel_fo37
    s_sleep 1
    s_add_u32 s12, s12, 1
    s_cmp_lt_u32 s12, 2000000
    s_cbranch_scc1 mega_kernel_fp36
mega_kernel_fo37:
mega_kernel_fk35:
    buffer_load_dwordx4 v[168:171], v44, s[44:47], s23 offen offset:0 sc1
    buffer_load_dwordx4 v[172:175], v44, s[44:47], s23 offen offset:2048 sc1
    buffer_load_dwordx4 v[176:179], v44, s[44:47], s23 offen offset:128 sc1
    buffer_load_dwordx4 v[180:183], v44, s[44:47], s23 offen offset:2176 sc1
    buffer_store_dwordx4 v[24:27], v45, s[44:47], s24 offen sc1
    buffer_store_dwordx4 v[28:31], v45, s[44:47], s24 offen offset:512 sc1
    s_add_u32 s24, s24, 65536
    s_branch mega_kernel_loop25
mega_kernel_end26:
    buffer_store_dwordx4 v[24:27], v45, s[44:47], s24 offen sc1
    buffer_store_dwordx4 v[28:31], v45, s[44:47], s24 offen offset:512 sc1
    s_add_u32 s24, s24, 65536
    s_waitcnt vmcnt(0)
    s_barrier
    s_cmp_lg_u32 s3, 0
    s_cbranch_scc1 mega_kernel_fs38
    s_add_u32 s33, s32, 16384
    s_mov_b64 exec, 1
    v_mov_b32 v8, 1
    v_mov_b32 v9, 0
    buffer_store_dword v8, v9, s[44:47], s33 offen sc1
mega_kernel_fs38:
    s_branch mega_kernel_done
mega_kernel_p219:
    s_and_b32 s15, s13, 15
    s_mul_i32 s16, s15, 28
    v_lshrrev_b32 v9, 1, v3
    v_lshlrev_b32 v9, 10, v9
    v_and_b32 v10, 1, v3
    v_lshl_add_u32 v9, v10, 9, v9
    v_mov_b32 v59, v9
    s_lshl_b32 s17, s3, 2
    v_mov_b32 v60, 2147483392
    v_cmp_gt_u32 s[26:27], 2, v3
    v_add_u32 v8, 0, v2
    v_mul_u32_u24 v10, 2341, v8
    v_lshrrev_b32 v10, 16, v10
    v_mul_u32_u24 v11, 28, v10
    v_sub_u32 v11, v8, v11
    v_add_u32 v10, s17, v10
    v_add_u32 v11, s16, v11
    v_mul_u32_u24 v12, 448, v10
    v_add_u32 v12, v12, v11
    v_lshrrev_b32 v13, 5, v12
    v_add_u32 v13, 256, v13
    v_mul_u32_u24 v13, 28672, v13
    v_and_b32 v14, 31, v12
    v_lshl_add_u32 v13, v14, 4, v13
    v_add_u32 v32, v13, v9
    v_lshrrev_b32 v13, 1, v10
    v_mul_u32_u24 v13, 14336, v13
    v_lshrrev_b32 v14, 5, v11
    v_lshl_add_u32 v13, v14, 10, v13
    v_and_b32 v14, 31, v11
    v_lshl_add_u32 v14, v3, 5, v14
    v_lshl_add_u32 v13, v14, 4, v13
    v_and_b32 v14, 1, v10
    v_lshl_add_u32 v13, v14, 3, v13
    v_cndmask_b32 v40, v60, v13, s[26:27]
    v_add_u32 v8, 16, v2
    v_mul_u32_u24 v10, 2341, v8
    v_lshrrev_b32 v10, 16, v10
    v_mul_u32_u24 v11, 28, v10
    v_sub_u32 v11, v8, v11
    v_add_u32 v10, s17, v10
    v_add_u32 v11, s16, v11
    v_mul_u32_u24 v12, 448, v10
    v_add_u32 v12, v12, v11
    v_lshrrev_b32 v13, 5, v12
    v_add_u32 v13, 256, v13
    v_mul_u32_u24 v13, 28672, v13
    v_and_b32 v14, 31, v12
    v_lshl_add_u32 v13, v14, 4, v13
    v_add_u32 v33, v13, v9
    v_lshrrev_b32 v13, 1, v10
    v_mul_u32_u24 v13, 14336, v13
    v_lshrrev_b32 v14, 5, v11
    v_lshl_add_u32 v13, v14, 10, v13
    v_and_b32 v14, 31, v11
    v_lshl_add_u32 v14, v3, 5, v14
    v_lshl_add_u32 v13, v14, 4, v13
    v_and_b32 v14, 1, v10
    v_lshl_add_u32 v13, v14, 3, v13
    v_cndmask_b32 v41, v60, v13, s[26:27]
    v_add_u32 v8, 32, v2
    v_mul_u32_u24 v10, 2341, v8
    v_lshrrev_b32 v10, 16, v10
    v_mul_u32_u24 v11, 28, v10
    v_sub_u32 v11, v8, v11
    v_add_u32 v10, s17, v10
    v_add_u32 v11, s16, v11
    v_mul_u32_u24 v12, 448, v10
    v_add_u32 v12, v12, v11
    v_lshrrev_b32 v13, 5, v12
    v_add_u32 v13, 256, v13
    v_mul_u32_u24 v13, 28672, v13
    v_and_b32 v14, 31, v12
    v_lshl_add_u32 v13, v14, 4, v13
    v_add_u32 v34, v13, v9
    v_lshrrev_b32 v13, 1, v10
    v_mul_u32_u24 v13, 14336, v13
    v_lshrrev_b32 v14, 5, v11
    v_lshl_add_u32 v13, v14, 10, v13
    v_and_b32 v14, 31, v11
    v_lshl_add_u32 v14, v3, 5, v14
    v_lshl_add_u32 v13, v14, 4, v13
    v_and_b32 v14, 1, v10
    v_lshl_add_u32 v13, v14, 3, v13
    v_cndmask_b32 v42, v60, v13, s[26:27]
    v_add_u32 v8, 48, v2
    v_mul_u32_u24 v10, 2341, v8
    v_lshrrev_b32 v10, 16, v10
    v_mul_u32_u24 v11, 28, v10
    v_sub_u32 v11, v8, v11
    v_add_u32 v10, s17, v10
    v_add_u32 v11, s16, v11
    v_mul_u32_u24 v12, 448, v10
    v_add_u32 v12, v12, v11
    v_lshrrev_b32 v13, 5, v12
    v_add_u32 v13, 256, v13
    v_mul_u32_u24 v13, 28672, v13
    v_and_b32 v14, 31, v12
    v_lshl_add_u32 v13, v14, 4, v13
    v_add_u32 v35, v13, v9
    v_lshrrev_b32 v13, 1, v10
    v_mul_u32_u24 v13, 14336, v13
    v_lshrrev_b32 v14, 5, v11
    v_lshl_add_u32 v13, v14, 10, v13
    v_and_b32 v14, 31, v11
    v_lshl_add_u32 v14, v3, 5, v14
    v_lshl_add_u32 v13, v14, 4, v13
    v_and_b32 v14, 1, v10
    v_lshl_add_u32 v13, v14, 3, v13
    v_cndmask_b32 v43, v60, v13, s[26:27]
    v_add_u32 v8, 64, v2
    v_mul_u32_u24 v10, 2341, v8
    v_lshrrev_b32 v10, 16, v10
    v_mul_u32_u24 v11, 28, v10
    v_sub_u32 v11, v8, v11
    v_add_u32 v10, s17, v10
    v_add_u32 v11, s16, v11
    v_mul_u32_u24 v12, 448, v10
    v_add_u32 v12, v12, v11
    v_lshrrev_b32 v13, 5, v12
    v_add_u32 v13, 256, v13
    v_mul_u32_u24 v13, 28672, v13
    v_and_b32 v14, 31, v12
    v_lshl_add_u32 v13, v14, 4, v13
    v_add_u32 v36, v13, v9
    v_lshrrev_b32 v13, 1, v10
    v_mul_u32_u24 v13, 14336, v13
    v_lshrrev_b32 v14, 5, v11
    v_lshl_add_u32 v13, v14, 10, v13
    v_and_b32 v14, 31, v11
    v_lshl_add_u32 v14, v3, 5, v14
    v_lshl_add_u32 v13, v14, 4, v13
    v_and_b32 v14, 1, v10
    v_lshl_add_u32 v13, v14, 3, v13
    v_cndmask_b32 v44, v60, v13, s[26:27]
    v_add_u32 v8, 80, v2
    v_mul_u32_u24 v10, 2341, v8
    v_lshrrev_b32 v10, 16, v10
    v_mul_u32_u24 v11, 28, v10
    v_sub_u32 v11, v8, v11
    v_add_u32 v10, s17, v10
    v_add_u32 v11, s16, v11
    v_mul_u32_u24 v12, 448, v10
    v_add_u32 v12, v12, v11
    v_lshrrev_b32 v13, 5, v12
    v_add_u32 v13, 256, v13
    v_mul_u32_u24 v13, 28672, v13
    v_and_b32 v14, 31, v12
    v_lshl_add_u32 v13, v14, 4, v13
    v_add_u32 v37, v13, v9
    v_lshrrev_b32 v13, 1, v10
    v_mul_u32_u24 v13, 14336, v13
    v_lshrrev_b32 v14, 5, v11
    v_lshl_add_u32 v13, v14, 10, v13
    v_and_b32 v14, 31, v11
    v_lshl_add_u32 v14, v3, 5, v14
    v_lshl_add_u32 v13, v14, 4, v13
    v_and_b32 v14, 1, v10
    v_lshl_add_u32 v13, v14, 3, v13
    v_cndmask_b32 v45, v60, v13, s[26:27]
    v_add_u32 v8, 96, v2
    v_mul_u32_u24 v10, 2341, v8
    v_lshrrev_b32 v10, 16, v10
    v_mul_u32_u24 v11, 28, v10
    v_sub_u32 v11, v8, v11
    v_add_u32 v10, s17, v10
    v_add_u32 v11, s16, v11
    v_mul_u32_u24 v12, 448, v10
    v_add_u32 v12, v12, v11
    v_lshrrev_b32 v13, 5, v12
    v_add_u32 v13, 256, v13
    v_mul_u32_u24 v13, 28672, v13
    v_and_b32 v14, 31, v12
    v_lshl_add_u32 v13, v14, 4, v13
    v_add_u32 v38, v13, v9
    v_lshrrev_b32 v13, 1, v10
    v_mul_u32_u24 v13, 14336, v13
    v_lshrrev_b32 v14, 5, v11
    v_lshl_add_u32 v13, v14, 10, v13
    v_and_b32 v14, 31, v11
    v_lshl_add_u32 v14, v3, 5, v14
    v_lshl_add_u32 v13, v14, 4, v13
    v_and_b32 v14, 1, v10
    v_lshl_add_u32 v13, v14, 3, v13
    v_cndmask_b32 v46, v60, v13, s[26:27]
    s_mov_b32 s22, 8257536
    v_add_u32 v4, 0, v32
    buffer_load_dwordx4 a[0:3], v4, s[44:47], s22 offen offset:0
    buffer_load_dwordx4 a[4:7], v4, s[44:47], s22 offen offset:2048
    v_add_u32 v4, 4096, v32
    buffer_load_dwordx4 a[8:11], v4, s[44:47], s22 offen offset:0
    buffer_load_dwordx4 a[12:15], v4, s[44:47], s22 offen offset:2048
    v_add_u32 v4, 8192, v32
    buffer_load_dwordx4 a[16:19], v4, s[44:47], s22 offen offset:0
    buffer_load_dwordx4 a[20:23], v4, s[44:47], s22 offen offset:2048
    v_add_u32 v4, 12288, v32
    buffer_load_dwordx4 a[24:27], v4, s[44:47], s22 offen offset:0
    buffer_load_dwordx4 a[28:31], v4, s[44:47], s22 offen offset:2048
    v_add_u32 v4, 16384, v32
    buffer_load_dwordx4 a[32:35], v4, s[44:47], s22 offen offset:0
    buffer_load_dwordx4 a[36:39], v4, s[44:47], s22 offen offset:2048
    v_add_u32 v4, 20480, v32
    buffer_load_dwordx4 a[40:43], v4, s[44:47], s22 offen offset:0
    buffer_load_dwordx4 a[44:47], v4, s[44:47], s22 offen offset:2048
    v_add_u32 v4, 24576, v32
    buffer_load_dwordx4 a[48:51], v4, s[44:47], s22 offen offset:0
    buffer_load_dwordx4 a[52:55], v4, s[44:47], s22 offen offset:2048
    v_add_u32 v4, 0, v33
    buffer_load_dwordx4 a[56:59], v4, s[44:47], s22 offen offset:0
    buffer_load_dwordx4 a[60:63], v4, s[44:47], s22 offen offset:2048
    v_add_u32 v4, 4096, v33
    buffer_load_dwordx4 a[64:67], v4, s[44:47], s22 offen offset:0
    buffer_load_dwordx4 a[68:71], v4, s[44:47], s22 offen offset:2048
    v_add_u32 v4, 8192, v33
    buffer_load_dwordx4 a[72:75], v4, s[44:47], s22 offen offset:0
    buffer_load_dwordx4 a[76:79], v4, s[44:47], s22 offen offset:2048
    v_add_u32 v4, 12288, v33
    buffer_load_dwordx4 a[80:83], v4, s[44:47], s22 offen offset:0
    buffer_load_dwordx4 a[84:87], v4, s[44:47], s22 offen offset:2048
    v_add_u32 v4, 16384, v33
    buffer_load_dwordx4 a[88:91], v4, s[44:47], s22 offen offset:0
    buffer_load_dwordx4 a[92:95], v4, s[44:47], s22 offen offset:2048
    v_add_u32 v4, 20480, v33
    buffer_load_dwordx4 a[96:99], v4, s[44:47], s22 offen offset:0
    buffer_load_dwordx4 a[100:103], v4, s[44:47], s22 offen offset:2048
    v_add_u32 v4, 24576, v33
    buffer_load_dwordx4 a[104:107], v4, s[44:47], s22 offen offset:0
    buffer_load_dwordx4 a[108:111], v4, s[44:47], s22 offen offset:2048
    v_add_u32 v4, 0, v34
    buffer_load_dwordx4 a[112:115], v4, s[44:47], s22 offen offset:0
    buffer_load_dwordx4 a[116:119], v4, s[44:47], s22 offen offset:2048
    v_add_u32 v4, 4096, v34
    buffer_load_dwordx4 a[120:123], v4, s[44:47], s22 offen offset:0
    buffer_load_dwordx4 a[124:127], v4, s[44:47], s22 offen offset:2048
    v_add_u32 v4, 8192, v34
    buffer_load_dwordx4 a[128:131], v4, s[44:47], s22 offen offset:0
    buffer_load_dwordx4 a[132:135], v4, s[44:47], s22 offen offset:2048
    v_add_u32 v4, 12288, v34
    buffer_load_dwordx4 a[136:139], v4, s[44:47], s22 offen offset:0
    buffer_load_dwordx4 a[140:143], v4, s[44:47], s22 offen offset:2048
    v_add_u32 v4, 16384, v34
    buffer_load_dwordx4 a[144:147], v4, s[44:47], s22 offen offset:0
    buffer_load_dwordx4 a[148:151], v4, s[44:47], s22 offen offset:2048
    v_add_u32 v4, 20480, v34
    buffer_load_dwordx4 a[152:155], v4, s[44:47], s22 offen offset:0
    buffer_load_dwordx4 a[156:159], v4, s[44:47], s22 offen offset:2048
    v_add_u32 v4, 24576, v34
    buffer_load_dwordx4 a[160:163], v4, s[44:47], s22 offen offset:0
    buffer_load_dwordx4 a[164:167], v4, s[44:47], s22 offen offset:2048
    v_add_u32 v4, 0, v35
    buffer_load_dwordx4 a[168:171], v4, s[44:47], s22 offen offset:0
    buffer_load_dwordx4 a[172:175], v4, s[44:47], s22 offen offset:2048
    v_add_u32 v4, 4096, v35
    buffer_load_dwordx4 a[176:179], v4, s[44:47], s22 offen offset:0
    buffer_load_dwordx4 a[180:183], v4, s[44:47], s22 offen offset:2048
    v_add_u32 v4, 8192, v35
    buffer_load_dwordx4 a[184:187], v4, s[44:47], s22 offen offset:0
    buffer_load_dwordx4 a[188:191], v4, s[44:47], s22 offen offset:2048
    v_add_u32 v4, 12288, v35
    buffer_load_dwordx4 a[192:195], v4, s[44:47], s22 offen offset:0
    buffer_load_dwordx4 a[196:199], v4, s[44:47], s22 offen offset:2048
    v_add_u32 v4, 16384, v35
    buffer_load_dwordx4 a[200:203], v4, s[44:47], s22 offen offset:0
    buffer_load_dwordx4 a[204:207], v4, s[44:47], s22 offen offset:2048
    v_add_u32 v4, 20480, v35
    buffer_load_dwordx4 a[208:211], v4, s[44:47], s22 offen offset:0
    buffer_load_dwordx4 a[212:215], v4, s[44:47], s22 offen offset:2048
    v_add_u32 v4, 24576, v35
    buffer_load_dwordx4 a[216:219], v4, s[44:47], s22 offen offset:0
    buffer_load_dwordx4 a[220:223], v4, s[44:47], s22 offen offset:2048
    v_add_u32 v4, 0, v36
    buffer_load_dwordx4 a[224:227], v4, s[44:47], s22 offen offset:0
    buffer_load_dwordx4 a[228:231], v4, s[44:47], s22 offen offset:2048
    v_add_u32 v4, 4096, v36
    buffer_load_dwordx4 a[232:235], v4, s[44:47], s22 offen offset:0
    buffer_load_dwordx4 a[236:239], v4, s[44:47], s22 offen offset:2048
    v_add_u32 v4, 8192, v36
    buffer_load_dwordx4 a[240:243], v4, s[44:47], s22 offen offset:0
    buffer_load_dwordx4 a[244:247], v4, s[44:47], s22 offen offset:2048
    v_add_u32 v4, 12288, v36
    buffer_load_dwordx4 a[248:251], v4, s[44:47], s22 offen offset:0
    buffer_load_dwordx4 a[252:255], v4, s[44:47], s22 offen offset:2048
    v_add_u32 v4, 16384, v36
    buffer_load_dwordx4 v[232:235], v4, s[44:47], s22 offen offset:0
    buffer_load_dwordx4 v[236:239], v4, s[44:47], s22 offen offset:2048
    v_add_u32 v4, 20480, v36
    buffer_load_dwordx4 v[240:243], v4, s[44:47], s22 offen offset:0
    buffer_load_dwordx4 v[244:247], v4, s[44:47], s22 offen offset:2048
    v_add_u32 v4, 24576, v36
    buffer_load_dwordx4 v[248:251], v4, s[44:47], s22 offen offset:0
    buffer_load_dwordx4 v[252:255], v4, s[44:47], s22 offen offset:2048
    v_add_u32 v4, 0, v37
    buffer_load_dwordx4 v[64:67], v4, s[44:47], s22 offen offset:0
    buffer_load_dwordx4 v[68:71], v4, s[44:47], s22 offen offset:2048
    v_add_u32 v4, 4096, v37
    buffer_load_dwordx4 v[72:75], v4, s[44:47], s22 offen offset:0
    buffer_load_dwordx4 v[76:79], v4, s[44:47], s22 offen offset:2048
    v_add_u32 v4, 8192, v37
    buffer_load_dwordx4 v[80:83], v4, s[44:47], s22 offen offset:0
    buffer_load_dwordx4 v[84:87], v4, s[44:47], s22 offen offset:2048
    v_add_u32 v4, 12288, v37
    buffer_load_dwordx4 v[88:91], v4, s[44:47], s22 offen offset:0
    buffer_load_dwordx4 v[92:95], v4, s[44:47], s22 offen offset:2048
    v_add_u32 v4, 16384, v37
    buffer_load_dwordx4 v[96:99], v4, s[44:47], s22 offen offset:0
    buffer_load_dwordx4 v[100:103], v4, s[44:47], s22 offen offset:2048
    v_add_u32 v4, 20480, v37
    buffer_load_dwordx4 v[104:107], v4, s[44:47], s22 offen offset:0
    buffer_load_dwordx4 v[108:111], v4, s[44:47], s22 offen offset:2048
    v_add_u32 v4, 24576, v37
    buffer_load_dwordx4 v[112:115], v4, s[44:47], s22 offen offset:0
    buffer_load_dwordx4 v[116:119], v4, s[44:47], s22 offen offset:2048
    s_waitcnt vmcnt(0)
    ds_write_b128 v57, v[64:67] offset:0
    ds_write_b128 v57, v[68:71] offset:1024
    ds_write_b128 v57, v[72:75] offset:2048
    ds_write_b128 v57, v[76:79] offset:3072
    ds_write_b128 v57, v[80:83] offset:4096
    ds_write_b128 v57, v[84:87] offset:5120
    ds_write_b128 v57, v[88:91] offset:6144
    ds_write_b128 v57, v[92:95] offset:7168
    ds_write_b128 v57, v[96:99] offset:8192
    ds_write_b128 v57, v[100:103] offset:9216
    ds_write_b128 v57, v[104:107] offset:10240
    ds_write_b128 v57, v[108:111] offset:11264
    ds_write_b128 v57, v[112:115] offset:12288
    ds_write_b128 v57, v[116:119] offset:13312
    s_waitcnt lgkmcnt(0)
    v_add_u32 v4, 0, v38
    buffer_load_dwordx4 v[64:67], v4, s[44:47], s22 offen offset:0
    buffer_load_dwordx4 v[68:71], v4, s[44:47], s22 offen offset:2048
    v_add_u32 v4, 4096, v38
    buffer_load_dwordx4 v[72:75], v4, s[44:47], s22 offen offset:0
    buffer_load_dwordx4 v[76:79], v4, s[44:47], s22 offen offset:2048
    v_add_u32 v4, 8192, v38
    buffer_load_dwordx4 v[80:83], v4, s[44:47], s22 offen offset:0
    buffer_load_dwordx4 v[84:87], v4, s[44:47], s22 offen offset:2048
    v_add_u32 v4, 12288, v38
    buffer_load_dwordx4 v[88:91], v4, s[44:47], s22 offen offset:0
    buffer_load_dwordx4 v[92:95], v4, s[44:47], s22 offen offset:2048
    v_add_u32 v4, 16384, v38
    buffer_load_dwordx4 v[96:99], v4, s[44:47], s22 offen offset:0
    buffer_load_dwordx4 v[100:103], v4, s[44:47], s22 offen offset:2048
    v_add_u32 v4, 20480, v38
    buffer_load_dwordx4 v[104:107], v4, s[44:47], s22 offen offset:0
    buffer_load_dwordx4 v[108:111], v4, s[44:47], s22 offen offset:2048
    v_add_u32 v4, 24576, v38
    buffer_load_dwordx4 v[112:115], v4, s[44:47], s22 offen offset:0
    buffer_load_dwordx4 v[116:119], v4, s[44:47], s22 offen offset:2048
    s_waitcnt vmcnt(0)
    ds_write_b128 v57, v[64:67] offset:14336
    ds_write_b128 v57, v[68:71] offset:15360
    ds_write_b128 v57, v[72:75] offset:16384
    ds_write_b128 v57, v[76:79] offset:17408
    ds_write_b128 v57, v[80:83] offset:18432
    ds_write_b128 v57, v[84:87] offset:19456
    ds_write_b128 v57, v[88:91] offset:20480
    ds_write_b128 v57, v[92:95] offset:21504
    ds_write_b128 v57, v[96:99] offset:22528
    ds_write_b128 v57, v[100:103] offset:23552
    ds_write_b128 v57, v[104:107] offset:24576
    ds_write_b128 v57, v[108:111] offset:25600
    ds_write_b128 v57, v[112:115] offset:26624
    ds_write_b128 v57, v[116:119] offset:27648
    s_waitcnt lgkmcnt(0)
    s_waitcnt vmcnt(0) lgkmcnt(0)
    s_add_u32 s18, s17, 0
    s_mul_i32 s18, s18, 448
    s_add_u32 s18, s18, s16
    s_add_u32 s18, s18, 0
    v_add_u32 v8, s18, v2
    v_lshrrev_b32 v10, 5, v8
    v_lshlrev_b32 v10, 11, v10
    v_and_b32 v11, 31, v8
    v_lshl_add_u32 v10, v11, 4, v10
    v_add_u32 v24, v10, v59
    s_add_u32 s18, s17, 0
    s_mul_i32 s18, s18, 448
    s_add_u32 s18, s18, s16
    s_add_u32 s18, s18, 16
    v_add_u32 v8, s18, v2
    v_lshrrev_b32 v10, 5, v8
    v_lshlrev_b32 v10, 11, v10
    v_and_b32 v11, 31, v8
    v_lshl_add_u32 v10, v11, 4, v10
    v_add_u32 v25, v10, v59
    s_add_u32 s18, s17, 1
    s_mul_i32 s18, s18, 448
    s_add_u32 s18, s18, s16
    s_add_u32 s18, s18, 0
    v_add_u32 v8, s18, v2
    v_lshrrev_b32 v10, 5, v8
    v_lshlrev_b32 v10, 11, v10
    v_and_b32 v11, 31, v8
    v_lshl_add_u32 v10, v11, 4, v10
    v_add_u32 v26, v10, v59
    s_add_u32 s18, s17, 1
    s_mul_i32 s18, s18, 448
    s_add_u32 s18, s18, s16
    s_add_u32 s18, s18, 16
    v_add_u32 v8, s18, v2
    v_lshrrev_b32 v10, 5, v8
    v_lshlrev_b32 v10, 11, v10
    v_and_b32 v11, 31, v8
    v_lshl_add_u32 v10, v11, 4, v10
    v_add_u32 v27, v10, v59
    s_add_u32 s18, s17, 2
    s_mul_i32 s18, s18, 448
    s_add_u32 s18, s18, s16
    s_add_u32 s18, s18, 0
    v_add_u32 v8, s18, v2
    v_lshrrev_b32 v10, 5, v8
    v_lshlrev_b32 v10, 11, v10
    v_and_b32 v11, 31, v8
    v_lshl_add_u32 v10, v11, 4, v10
    v_add_u32 v28, v10, v59
    s_add_u32 s18, s17, 2
    s_mul_i32 s18, s18, 448
    s_add_u32 s18, s18, s16
    s_add_u32 s18, s18, 16
    v_add_u32 v8, s18, v2
    v_lshrrev_b32 v10, 5, v8
    v_lshlrev_b32 v10, 11, v10
    v_and_b32 v11, 31, v8
    v_lshl_add_u32 v10, v11, 4, v10
    v_add_u32 v29, v10, v59
    s_add_u32 s18, s17, 3
    s_mul_i32 s18, s18, 448
    s_add_u32 s18, s18, s16
    s_add_u32 s18, s18, 0
    v_add_u32 v8, s18, v2
    v_lshrrev_b32 v10, 5, v8
    v_lshlrev_b32 v10, 11, v10
    v_and_b32 v11, 31, v8
    v_lshl_add_u32 v10, v11, 4, v10
    v_add_u32 v30, v10, v59
    s_add_u32 s18, s17, 3
    s_mul_i32 s18, s18, 448
    s_add_u32 s18, s18, s16
    s_add_u32 s18, s18, 16
    v_add_u32 v8, s18, v2
    v_lshrrev_b32 v10, 5, v8
    v_lshlrev_b32 v10, 11, v10
    v_and_b32 v11, 31, v8
    v_lshl_add_u32 v10, v11, 4, v10
    v_add_u32 v31, v10, v59
    s_mul_i32 s23, s31, 29360128
    s_add_u32 s23, s23, 111411200
    s_mul_i32 s24, s31, 7340032
    s_add_u32 s24, s24, 178524160
    s_lshl_b32 s18, s3, 11
    s_add_u32 s18, s18, 151552
    v_lshlrev_b32 v47, 4, v2
    v_lshl_add_u32 v47, v3, 3, v47
    v_add_u32 v47, s18, v47
    v_mov_b32 v8, 159776
    v_cndmask_b32 v47, v8, v47, s[26:27]
    v_mul_u32_u24 v48, 28, v3
    v_add_u32 v48, v48, v2
    v_lshlrev_b32 v48, 4, v48
    v_add_u32 v48, s18, v48
    v_and_b32 v8, 7, v2
    v_mul_u32_u24 v49, 80, v8
    v_mul_u32_u24 v9, 640, v3
    v_add_u32 v61, v49, v9
    v_add_u32 v61, 64, v61
    v_lshl_add_u32 v49, v3, 4, v49
    s_mul_i32 s25, s3, 2560
    s_add_u32 s25, s25, s36
    v_lshlrev_b32 v22, 5, v62
    v_lshlrev_b32 v8, 11, v1
    v_add_u32 v23, v22, v8
    v_add_u32 v23, 139264, v23
    v_add_u32 v22, 139264, v22
    v_mul_u32_u24 v21, 896, v2
    v_lshl_add_u32 v21, v3, 3, v21
    s_mul_i32 s18, s15, 56
    v_add_u32 v21, s18, v21
    v_cmp_gt_u32 vcc, 8, v2
    s_nop 1
    v_cndmask_b32 v21, v60, v21, vcc
    v_cmp_gt_u32 vcc, 3, v3
    s_nop 1
    v_cndmask_b32 v20, v60, v21, vcc
    s_mov_b32 s20, 0
    s_mov_b32 s29, 0
    s_mov_b32 s14, 201035776
    v_lshlrev_b32 v9, 8, v62
    v_mov_b32 v8, 2147483392
    v_cmp_gt_u32 vcc, 8, v62
    s_nop 1
    v_cndmask_b32 v9, v8, v9, vcc
    s_mov_b32 s12, 0
mega_kernel_mp39:
    buffer_load_dword v8, v9, s[44:47], s14 offen sc1
    s_waitcnt vmcnt(0)
    v_readlane_b32 s10, v8, s31
    s_cmp_ge_u32 s10, 32
    s_cbranch_scc1 mega_kernel_mf41
    s_mov_b32 s10, 0
    v_readlane_b32 s11, v8, 0
    s_add_u32 s10, s10, s11
    v_readlane_b32 s11, v8, 1
    s_add_u32 s10, s10, s11
    v_readlane_b32 s11, v8, 2
    s_add_u32 s10, s10, s11
    v_readlane_b32 s11, v8, 3
    s_add_u32 s10, s10, s11
    v_readlane_b32 s11, v8, 4
    s_add_u32 s10, s10, s11
    v_readlane_b32 s11, v8, 5
    s_add_u32 s10, s10, s11
    v_readlane_b32 s11, v8, 6
    s_add_u32 s10, s10, s11
    v_readlane_b32 s11, v8, 7
    s_add_u32 s10, s10, s11
    s_cmp_ge_u32 s10, 256
    s_cbranch_scc1 mega_kernel_mo40
    s_sleep 4
    s_add_u32 s12, s12, 1
    s_cmp_lt_u32 s12, 2000000
    s_cbranch_scc1 mega_kernel_mp39
mega_kernel_mo40:
    s_mov_b32 s29, 1
mega_kernel_mf41:
    s_lshl_b32 s37, s20, 8
    s_lshl_b32 s33, s31, 14
    s_add_u32 s37, s37, s33
    s_add_u32 s37, s37, 200937472
    v_lshlrev_b32 v7, 2, v62
    v_cmp_gt_u32 s[38:39], 60, v62
    s_mov_b32 s12, 0
mega_kernel_fp42:
    buffer_load_dword v6, v7, s[44:47], s37 offen sc1
    s_waitcnt vmcnt(0)
    v_cmp_eq_u32 vcc, 0, v6
    s_and_b64 s[40:41], vcc, s[38:39]
    s_cbranch_scc0 mega_kernel_fo43
    s_sleep 1
    s_add_u32 s12, s12, 1
    s_cmp_lt_u32 s12, 2000000
    s_cbranch_scc1 mega_kernel_fp42
mega_kernel_fo43:
    s_lshl_b32 s4, s31, 14
    s_add_u32 s4, s4, 200937728
    v_lshlrev_b32 v7, 2, v62
    v_cmp_gt_u32 s[10:11], 60, v62
    s_lshl_b32 s18, s3, 11
    s_add_u32 s18, s18, 151552
    v_add_u32 v40, s18, v56
    s_mul_i32 s18, s15, 7168
    s_mul_i32 s19, s3, 1792
    s_add_u32 s18, s18, s19
    v_add_u32 v41, s18, v56
    v_add_u32 v42, 1024, v41
    v_cmp_gt_u32 vcc, 48, v62
    s_nop 1
    v_cndmask_b32 v42, v60, v42, vcc
mega_kernel_loop44:
    s_lshl_b32 s21, s20, 13
    s_add_u32 s21, s21, s30
    s_mov_b32 s12, 0
    buffer_load_dwordx4 v[8:11], v50, s[44:47], s21 offen sc1
    buffer_load_dwordx4 v[12:15], v51, s[44:47], s21 offen sc1
mega_kernel_gp49:
    buffer_load_dwordx4 v[120:123], v50, s[44:47], s21 offen sc1
    buffer_load_dwordx4 v[124:127], v51, s[44:47], s21 offen sc1
    s_waitcnt vmcnt(2)
    v_min3_u32 v4, v8, v9, v10
    v_min3_u32 v5, v12, v13, v14
    v_min_u32 v4, v4, v11
    v_min_u32 v5, v5, v15
    v_or_b32 v5, v5, v54
    v_min_u32 v4, v4, v5
    v_cmp_eq_u32 vcc, 0, v4
    s_cbranch_vccz mega_kernel_go50
    buffer_load_dwordx4 v[8:11], v50, s[44:47], s21 offen sc1
    buffer_load_dwordx4 v[12:15], v51, s[44:47], s21 offen sc1
    s_waitcnt vmcnt(2)
    v_min3_u32 v4, v120, v121, v122
    v_min3_u32 v5, v124, v125, v126
    v_min_u32 v4, v4, v123
    v_min_u32 v5, v5, v127
    v_or_b32 v5, v5, v54
    v_min_u32 v4, v4, v5
    v_cmp_eq_u32 vcc, 0, v4
    s_cbranch_vccz mega_kernel_gb52
    s_add_u32 s12, s12, 1
    s_cmp_lt_u32 s12, 2000000
    s_cbranch_scc1 mega_kernel_gp49
mega_kernel_gb52:
    ds_write_b128 v52, v[120:123]
    ds_write_b128 v53, v[124:127]
    s_branch mega_kernel_gw53
mega_kernel_go50:
    ds_write_b128 v52, v[8:11]
    ds_write_b128 v53, v[12:15]
mega_kernel_gw53:
    s_waitcnt lgkmcnt(0)
    s_barrier
    ds_read_b128 v[64:67], v55 offset:0
    ds_read_b128 v[68:71], v55 offset:64
    ds_read_b128 v[72:75], v55 offset:128
    ds_read_b128 v[76:79], v55 offset:192
    ds_read_b128 v[80:83], v55 offset:256
    ds_read_b128 v[84:87], v55 offset:320
    ds_read_b128 v[88:91], v55 offset:384
    ds_read_b128 v[92:95], v55 offset:448
    ds_read_b128 v[96:99], v55 offset:512
    ds_read_b128 v[100:103], v55 offset:576
    ds_read_b128 v[104:107], v55 offset:640
    ds_read_b128 v[108:111], v55 offset:704
    ds_read_b128 v[112:115], v55 offset:768
    ds_read_b128 v[116:119], v55 offset:832
    s_cmp_lg_u32 s3, 3
    s_cbranch_scc1 mega_kernel_gs51
    s_cmp_lt_u32 s20, 2
    s_cbranch_scc1 mega_kernel_gs51
    s_lshl_b32 s33, s20, 8
    s_add_u32 s33, s33, s32
    s_sub_u32 s33, s33, 256
    s_mov_b64 s[34:35], exec
    s_mov_b64 exec, 1
    v_mov_b32 v4, 1
    v_mov_b32 v5, 0
    buffer_store_dword v4, v5, s[44:47], s33 offen sc1
    s_mov_b64 exec, s[34:35]
    s_waitcnt vmcnt(1)
    s_branch mega_kernel_gs51_x
mega_kernel_gs51:
    s_waitcnt vmcnt(0)
mega_kernel_gs51_x:
    buffer_load_dword v6, v7, s[44:47], s4 offen sc1
    s_add_u32 s4, s4, 256
    buffer_load_dwordx4 v[168:171], v24, s[44:47], s23 offen sc1
    buffer_load_dwordx4 v[172:175], v25, s[44:47], s23 offen sc1
    buffer_load_dwordx4 v[176:179], v26, s[44:47], s23 offen sc1
    buffer_load_dwordx4 v[180:183], v27, s[44:47], s23 offen sc1
    buffer_load_dwordx4 v[184:187], v28, s[44:47], s23 offen sc1
    buffer_load_dwordx4 v[188:191], v29, s[44:47], s23 offen sc1
    buffer_load_dwordx4 v[192:195], v30, s[44:47], s23 offen sc1
    buffer_load_dwordx4 v[196:199], v31, s[44:47], s23 offen sc1
    s_cmp_eq_u32 s20, 0
    s_cbranch_scc1 mega_kernel_hk54
    ds_read_b128 v[16:19], v40
    ds_read_b128 v[32:35], v40 offset:1024
    s_waitcnt lgkmcnt(0)
    buffer_store_dwordx4 v[16:19], v41, s[44:47], s24 offen sc1
    buffer_store_dwordx4 v[32:35], v42, s[44:47], s24 offen sc1
    s_add_u32 s24, s24, 114688
mega_kernel_hk54:
    ds_read_b128 v[152:155], v57 offset:0
    ds_read_b128 v[156:159], v57 offset:14336
    ds_read_b128 v[160:163], v57 offset:1024
    s_waitcnt lgkmcnt(3)
    v_mfma_f32_16x16x32_bf16 v[120:123], v[64:67], a[0:3], 0
    v_mfma_f32_16x16x32_bf16 v[124:127], v[64:67], a[56:59], 0
    v_mfma_f32_16x16x32_bf16 v[128:131], v[64:67], a[112:115], 0
    v_mfma_f32_16x16x32_bf16 v[132:135], v[64:67], a[168:171], 0
    v_mfma_f32_16x16x32_bf16 v[136:139], v[64:67], a[224:227], 0
    s_waitcnt lgkmcnt(2)
    v_mfma_f32_16x16x32_bf16 v[140:143], v[64:67], v[152:155], 0
    ds_read_b128 v[164:167], v57 offset:15360
    s_waitcnt lgkmcnt(2)
    v_mfma_f32_16x16x32_bf16 v[144:147], v[64:67], v[156:159], 0
    ds_read_b128 v[152:155], v57 offset:2048
    v_mfma_f32_16x16x32_bf16 v[120:123], v[68:71], a[4:7], v[120:123]
    v_mfma_f32_16x16x32_bf16 v[124:127], v[68:71], a[60:63], v[124:127]
    v_mfma_f32_16x16x32_bf16 v[128:131], v[68:71], a[116:119], v[128:131]
    v_mfma_f32_16x16x32_bf16 v[132:135], v[68:71], a[172:175], v[132:135]
    v_mfma_f32_16x16x32_bf16 v[136:139], v[68:71], a[228:231], v[136:139]
    s_waitcnt lgkmcnt(2)
    v_mfma_f32_16x16x32_bf16 v[140:143], v[68:71], v[160:163], v[140:143]
    ds_read_b128 v[156:159], v57 offset:16384
    s_waitcnt lgkmcnt(2)
    v_mfma_f32_16x16x32_bf16 v[144:147], v[68:71], v[164:167], v[144:147]
    ds_read_b128 v[160:163], v57 offset:3072
    v_mfma_f32_16x16x32_bf16 v[120:123], v[72:75], a[8:11], v[120:123]
    v_mfma_f32_16x16x32_bf16 v[124:127], v[72:75], a[64:67], v[124:127]
    v_mfma_f32_16x16x32_bf16 v[128:131], v[72:75], a[120:123], v[128:131]
    v_mfma_f32_16x16x32_bf16 v[132:135], v[72:75], a[176:179], v[132:135]
    v_mfma_f32_16x16x32_bf16 v[136:139], v[72:75], a[232:235], v[136:139]
    s_waitcnt lgkmcnt(2)
    v_mfma_f32_16x16x32_bf16 v[140:143], v[72:75], v[152:155], v[140:143]
    ds_read_b128 v[164:167], v57 offset:17408
    s_waitcnt lgkmcnt(2)
    v_mfma_f32_16x16x32_bf16 v[144:147], v[72:75], v[156:159], v[144:147]
    ds_read_b128 v[152:155], v57 offset:4096
    v_mfma_f32_16x16x32_bf16 v[120:123], v[76:79], a[12:15], v[120:123]
    v_mfma_f32_16x16x32_bf16 v[124:127], v[76:79], a[68:71], v[124:127]
    v_mfma_f32_16x16x32_bf16 v[128:131], v[76:79], a[124:127], v[128:131]
    v_mfma_f32_16x16x32_bf16 v[132:135], v[76:79], a[180:183], v[132:135]
    v_mfma_f32_16x16x32_bf16 v[136:139], v[76:79], a[236:239], v[136:139]
    s_waitcnt lgkmcnt(2)
    v_mfma_f32_16x16x32_bf16 v[140:143], v[76:79], v[160:163], v[140:143]
    ds_read_b128 v[156:159], v57 offset:18432
    s_waitcnt lgkmcnt(2)
    v_mfma_f32_16x16x32_bf16 v[144:147], v[76:79], v[164:167], v[144:147]
    ds_read_b128 v[160:163], v57 offset:5120
    v_mfma_f32_16x16x32_bf16 v[120:123], v[80:83], a[16:19], v[120:123]
    v_mfma_f32_16x16x32_bf16 v[124:127], v[80:83], a[72:75], v[124:127]
    v_mfma_f32_16x16x32_bf16 v[128:131], v[80:83], a[128:131], v[128:131]
    v_mfma_f32_16x16x32_bf16 v[132:135], v[80:83], a[184:187], v[132:135]
    v_mfma_f32_16x16x32_bf16 v[136:139], v[80:83], a[240:243], v[136:139]
    s_waitcnt lgkmcnt(2)
    v_mfma_f32_16x16x32_bf16 v[140:143], v[80:83], v[152:155], v[140:143]
    ds_read_b128 v[164:167], v57 offset:19456
    s_waitcnt lgkmcnt(2)
    v_mfma_f32_16x16x32_bf16 v[144:147], v[80:83], v[156:159], v[144:147]
    ds_read_b128 v[152:155], v57 offset:6144
    v_mfma_f32_16x16x32_bf16 v[120:123], v[84:87], a[20:23], v[120:123]
    v_mfma_f32_16x16x32_bf16 v[124:127], v[84:87], a[76:79], v[124:127]
    v_mfma_f32_16x16x32_bf16 v[128:131], v[84:87], a[132:135], v[128:131]
    v_mfma_f32_16x16x32_bf16 v[132:135], v[84:87], a[188:191], v[132:135]
    v_mfma_f32_16x16x32_bf16 v[136:139], v[84:87], a[244:247], v[136:139]
    s_waitcnt lgkmcnt(2)
    v_mfma_f32_16x16x32_bf16 v[140:143], v[84:87], v[160:163], v[140:143]
    ds_read_b128 v[156:159], v57 offset:20480
    s_waitcnt lgkmcnt(2)
    v_mfma_f32_16x16x32_bf16 v[144:147], v[84:87], v[164:167], v[144:147]
    ds_read_b128 v[160:163], v57 offset:7168
    v_mfma_f32_16x16x32_bf16 v[120:123], v[88:91], a[24:27], v[120:123]
    v_mfma_f32_16x16x32_bf16 v[124:127], v[88:91], a[80:83], v[124:127]
    v_mfma_f32_16x16x32_bf16 v[128:131], v[88:91], a[136:139], v[128:131]
    v_mfma_f32_16x16x32_bf16 v[132:135], v[88:91], a[192:195], v[132:135]
    v_mfma_f32_16x16x32_bf16 v[136:139], v[88:91], a[248:251], v[136:139]
    s_waitcnt lgkmcnt(2)
    v_mfma_f32_16x16x32_bf16 v[140:143], v[88:91], v[152:155], v[140:143]
    ds_read_b128 v[164:167], v57 offset:21504
    s_waitcnt lgkmcnt(2)
    v_mfma_f32_16x16x32_bf16 v[144:147], v[88:91], v[156:159], v[144:147]
    ds_read_b128 v[152:155], v57 offset:8192
    v_mfma_f32_16x16x32_bf16 v[120:123], v[92:95], a[28:31], v[120:123]
    v_mfma_f32_16x16x32_bf16 v[124:127], v[92:95], a[84:87], v[124:127]
    v_mfma_f32_16x16x32_bf16 v[128:131], v[92:95], a[140:143], v[128:131]
    v_mfma_f32_16x16x32_bf16 v[132:135], v[92:95], a[196:199], v[132:135]
    v_mfma_f32_16x16x32_bf16 v[136:139], v[92:95], a[252:255], v[136:139]
    s_waitcnt lgkmcnt(2)
    v_mfma_f32_16x16x32_bf16 v[140:143], v[92:95], v[160:163], v[140:143]
    ds_read_b128 v[156:159], v57 offset:22528
    s_waitcnt lgkmcnt(2)
    v_mfma_f32_16x16x32_bf16 v[144:147], v[92:95], v[164:167], v[144:147]
    ds_read_b128 v[160:163], v57 offset:9216
    v_mfma_f32_16x16x32_bf16 v[120:123], v[96:99], a[32:35], v[120:123]
    v_mfma_f32_16x16x32_bf16 v[124:127], v[96:99], a[88:91], v[124:127]
    v_mfma_f32_16x16x32_bf16 v[128:131], v[96:99], a[144:147], v[128:131]
    v_mfma_f32_16x16x32_bf16 v[132:135], v[96:99], a[200:203], v[132:135]
    v_mfma_f32_16x16x32_bf16 v[136:139], v[96:99], v[232:235], v[136:139]
    s_waitcnt lgkmcnt(2)
    v_mfma_f32_16x16x32_bf16 v[140:143], v[96:99], v[152:155], v[140:143]
    ds_read_b128 v[164:167], v57 offset:23552
    s_waitcnt lgkmcnt(2)
    v_mfma_f32_16x16x32_bf16 v[144:147], v[96:99], v[156:159], v[144:147]
    ds_read_b128 v[152:155], v57 offset:10240
    v_mfma_f32_16x16x32_bf16 v[120:123], v[100:103], a[36:39], v[120:123]
    v_mfma_f32_16x16x32_bf16 v[124:127], v[100:103], a[92:95], v[124:127]
    v_mfma_f32_16x16x32_bf16 v[128:131], v[100:103], a[148:151], v[128:131]
    v_mfma_f32_16x16x32_bf16 v[132:135], v[100:103], a[204:207], v[132:135]
    v_mfma_f32_16x16x32_bf16 v[136:139], v[100:103], v[236:239], v[136:139]
    s_waitcnt lgkmcnt(2)
    v_mfma_f32_16x16x32_bf16 v[140:143], v[100:103], v[160:163], v[140:143]
    ds_read_b128 v[156:159], v57 offset:24576
    s_waitcnt lgkmcnt(2)
    v_mfma_f32_16x16x32_bf16 v[144:147], v[100:103], v[164:167], v[144:147]
    ds_read_b128 v[160:163], v57 offset:11264
    v_mfma_f32_16x16x32_bf16 v[120:123], v[104:107], a[40:43], v[120:123]
    v_mfma_f32_16x16x32_bf16 v[124:127], v[104:107], a[96:99], v[124:127]
    v_mfma_f32_16x16x32_bf16 v[128:131], v[104:107], a[152:155], v[128:131]
    v_mfma_f32_16x16x32_bf16 v[132:135], v[104:107], a[208:211], v[132:135]
    v_mfma_f32_16x16x32_bf16 v[136:139], v[104:107], v[240:243], v[136:139]
    s_waitcnt lgkmcnt(2)
    v_mfma_f32_16x16x32_bf16 v[140:143], v[104:107], v[152:155], v[140:143]
    ds_read_b128 v[164:167], v57 offset:25600
    s_waitcnt lgkmcnt(2)
    v_mfma_f32_16x16x32_bf16 v[144:147], v[104:107], v[156:159], v[144:147]
    ds_read_b128 v[152:155], v57 offset:12288
    v_mfma_f32_16x16x32_bf16 v[120:123], v[108:111], a[44:47], v[120:123]
    v_mfma_f32_16x16x32_bf16 v[124:127], v[108:111], a[100:103], v[124:127]
    v_mfma_f32_16x16x32_bf16 v[128:131], v[108:111], a[156:159], v[128:131]
    v_mfma_f32_16x16x32_bf16 v[132:135], v[108:111], a[212:215], v[132:135]
    v_mfma_f32_16x16x32_bf16 v[136:139], v[108:111], v[244:247], v[136:139]
    s_waitcnt lgkmcnt(2)
    v_mfma_f32_16x16x32_bf16 v[140:143], v[108:111], v[160:163], v[140:143]
    ds_read_b128 v[156:159], v57 offset:26624
    s_waitcnt lgkmcnt(2)
    v_mfma_f32_16x16x32_bf16 v[144:147], v[108:111], v[164:167], v[144:147]
    ds_read_b128 v[160:163], v57 offset:13312
    v_mfma_f32_16x16x32_bf16 v[120:123], v[112:115], a[48:51], v[120:123]
    v_mfma_f32_16x16x32_bf16 v[124:127], v[112:115], a[104:107], v[124:127]
    v_mfma_f32_16x16x32_bf16 v[128:131], v[112:115], a[160:163], v[128:131]
    v_mfma_f32_16x16x32_bf16 v[132:135], v[112:115], a[216:219], v[132:135]
    v_mfma_f32_16x16x32_bf16 v[136:139], v[112:115], v[248:251], v[136:139]
    s_waitcnt lgkmcnt(2)
    v_mfma_f32_16x16x32_bf16 v[140:143], v[112:115], v[152:155], v[140:143]
    ds_read_b128 v[164:167], v57 offset:27648
    s_waitcnt lgkmcnt(2)
    v_mfma_f32_16x16x32_bf16 v[144:147], v[112:115], v[156:159], v[144:147]
    v_mfma_f32_16x16x32_bf16 v[120:123], v[116:119], a[52:55], v[120:123]
    v_mfma_f32_16x16x32_bf16 v[124:127], v[116:119], a[108:111], v[124:127]
    v_mfma_f32_16x16x32_bf16 v[128:131], v[116:119], a[164:167], v[128:131]
    v_mfma_f32_16x16x32_bf16 v[132:135], v[116:119], a[220:223], v[132:135]
    v_mfma_f32_16x16x32_bf16 v[136:139], v[116:119], v[252:255], v[136:139]
    s_waitcnt lgkmcnt(1)
    v_mfma_f32_16x16x32_bf16 v[140:143], v[116:119], v[160:163], v[140:143]
    s_waitcnt lgkmcnt(0)
    v_mfma_f32_16x16x32_bf16 v[144:147], v[116:119], v[164:167], v[144:147]
    s_nop 7
    v_cvt_pk_bf16_f32 v16, v120, v121
    v_cvt_pk_bf16_f32 v17, v122, v123
    ds_write_b64 v47, v[16:17] offset:0
    v_cvt_pk_bf16_f32 v18, v124, v125
    v_cvt_pk_bf16_f32 v19, v126, v127
    ds_write_b64 v47, v[18:19] offset:256
    v_cvt_pk_bf16_f32 v32, v128, v129
    v_cvt_pk_bf16_f32 v33, v130, v131
    ds_write_b64 v47, v[32:33] offset:512
    v_cvt_pk_bf16_f32 v34, v132, v133
    v_cvt_pk_bf16_f32 v35, v134, v135
    ds_write_b64 v47, v[34:35] offset:768
    v_cvt_pk_bf16_f32 v36, v136, v137
    v_cvt_pk_bf16_f32 v37, v138, v139
    ds_write_b64 v47, v[36:37] offset:1024
    v_cvt_pk_bf16_f32 v38, v140, v141
    v_cvt_pk_bf16_f32 v39, v142, v143
    ds_write_b64 v47, v[38:39] offset:1280
    v_cvt_pk_bf16_f32 v148, v144, v145
    v_cvt_pk_bf16_f32 v149, v146, v147
    ds_write_b64 v47, v[148:149] offset:1536
    s_cmp_eq_u32 s20, 63
    s_cbranch_scc1 mega_kernel_end45
    s_waitcnt lgkmcnt(0)
    ds_read_b128 v[220:223], v48
    ds_read_b128 v[224:227], v48 offset:256
    s_mov_b32 s12, 0
    buffer_load_dwordx4 v[200:203], v49, s[44:47], s25 offen offset:0 sc1
    buffer_load_dwordx4 v[204:207], v49, s[44:47], s25 offen offset:640 sc1
    buffer_load_dwordx4 v[208:211], v49, s[44:47], s25 offen offset:1280 sc1
    buffer_load_dwordx4 v[212:215], v49, s[44:47], s25 offen offset:1920 sc1
    buffer_load_dwordx4 v[216:219], v61, s[44:47], s25 offen sc1
mega_kernel_pp47:
    buffer_load_dwordx4 v[64:67], v49, s[44:47], s25 offen offset:0 sc1
    buffer_load_dwordx4 v[68:71], v49, s[44:47], s25 offen offset:640 sc1
    buffer_load_dwordx4 v[72:75], v49, s[44:47], s25 offen offset:1280 sc1
    buffer_load_dwordx4 v[76:79], v49, s[44:47], s25 offen offset:1920 sc1
    buffer_load_dwordx4 v[80:83], v61, s[44:47], s25 offen sc1
    s_waitcnt vmcnt(5)
    v_and_b32 v8, v200, v204
    v_and_b32 v9, v201, v205
    v_and_b32 v10, v202, v206
    v_and_b32 v11, v203, v207
    v_and_b32 v12, v208, v212
    v_and_b32 v13, v209, v213
    v_and_b32 v14, v210, v214
    v_and_b32 v15, v211, v215
    v_and_b32 v8, v8, v216
    v_and_b32 v9, v9, v217
    v_and_b32 v10, v10, v218
    v_and_b32 v11, v11, v219
    v_and_b32 v8, v8, v12
    v_and_b32 v9, v9, v13
    v_and_b32 v10, v10, v14
    v_and_b32 v11, v11, v15
    v_and_b32 v8, v8, v9
    v_and_b32 v10, v10, v11
    v_and_b32 v8, v8, v10
    v_and_b32 v8, 0x80008000, v8
    v_cmp_ne_u32 vcc, 0x80008000, v8
    s_cbranch_vccz mega_kernel_po48
    buffer_load_dwordx4 v[200:203], v49, s[44:47], s25 offen offset:0 sc1
    buffer_load_dwordx4 v[204:207], v49, s[44:47], s25 offen offset:640 sc1
    buffer_load_dwordx4 v[208:211], v49, s[44:47], s25 offen offset:1280 sc1
    buffer_load_dwordx4 v[212:215], v49, s[44:47], s25 offen offset:1920 sc1
    buffer_load_dwordx4 v[216:219], v61, s[44:47], s25 offen sc1
    s_waitcnt vmcnt(5)
    v_and_b32 v8, v64, v68
    v_and_b32 v9, v65, v69
    v_and_b32 v10, v66, v70
    v_and_b32 v11, v67, v71
    v_and_b32 v12, v72, v76
    v_and_b32 v13, v73, v77
    v_and_b32 v14, v74, v78
    v_and_b32 v15, v75, v79
    v_and_b32 v8, v8, v80
    v_and_b32 v9, v9, v81
    v_and_b32 v10, v10, v82
    v_and_b32 v11, v11, v83
    v_and_b32 v8, v8, v12
    v_and_b32 v9, v9, v13
    v_and_b32 v10, v10, v14
    v_and_b32 v11, v11, v15
    v_and_b32 v8, v8, v9
    v_and_b32 v10, v10, v11
    v_and_b32 v8, v8, v10
    v_and_b32 v8, 0x80008000, v8
    v_cmp_ne_u32 vcc, 0x80008000, v8
    s_cbranch_vccz mega_kernel_pb55
    s_add_u32 s12, s12, 1
    s_cmp_lt_u32 s12, 2000000
    s_cbranch_scc1 mega_kernel_pp47
mega_kernel_pb55:
    s_waitcnt lgkmcnt(0)
    v_mfma_f32_16x16x32_bf16 v[8:11], v[220:223], v[80:83], 0
    v_mfma_f32_16x16x32_bf16 v[12:15], v[224:227], v[80:83], 0
    v_mfma_f32_16x16x32_bf16 v[8:11], v[168:171], v[64:67], v[8:11]
    v_mfma_f32_16x16x32_bf16 v[12:15], v[172:175], v[64:67], v[12:15]
    v_mfma_f32_16x16x32_bf16 v[8:11], v[176:179], v[68:71], v[8:11]
    v_mfma_f32_16x16x32_bf16 v[12:15], v[180:183], v[68:71], v[12:15]
    v_mfma_f32_16x16x32_bf16 v[8:11], v[184:187], v[72:75], v[8:11]
    v_mfma_f32_16x16x32_bf16 v[12:15], v[188:191], v[72:75], v[12:15]
    v_mfma_f32_16x16x32_bf16 v[8:11], v[192:195], v[76:79], v[8:11]
    v_mfma_f32_16x16x32_bf16 v[12:15], v[196:199], v[76:79], v[12:15]
    s_branch mega_kernel_pw56
mega_kernel_po48:
    s_waitcnt lgkmcnt(0)
    v_mfma_f32_16x16x32_bf16 v[8:11], v[220:223], v[216:219], 0
    v_mfma_f32_16x16x32_bf16 v[12:15], v[224:227], v[216:219], 0
    v_mfma_f32_16x16x32_bf16 v[8:11], v[168:171], v[200:203], v[8:11]
    v_mfma_f32_16x16x32_bf16 v[12:15], v[172:175], v[200:203], v[12:15]
    v_mfma_f32_16x16x32_bf16 v[8:11], v[176:179], v[204:207], v[8:11]
    v_mfma_f32_16x16x32_bf16 v[12:15], v[180:183], v[204:207], v[12:15]
    v_mfma_f32_16x16x32_bf16 v[8:11], v[184:187], v[208:211], v[8:11]
    v_mfma_f32_16x16x32_bf16 v[12:15], v[188:191], v[208:211], v[12:15]
    v_mfma_f32_16x16x32_bf16 v[8:11], v[192:195], v[212:215], v[8:11]
    v_mfma_f32_16x16x32_bf16 v[12:15], v[196:199], v[212:215], v[12:15]
mega_kernel_pw56:
    s_add_u32 s23, s23, 458752
    s_add_u32 s25, s25, 10240
    s_nop 7
    ds_write_b128 v23, v[8:11]
    ds_write_b128 v23, v[12:15] offset:16
    s_waitcnt lgkmcnt(0)
    s_barrier
    s_cmp_lg_u32 s3, 0
    s_cbranch_scc1 mega_kernel_nw046
    ds_read_b128 v[120:123], v22 offset:2048
    ds_read_b128 v[124:127], v22 offset:2064
    ds_read_b128 v[128:131], v22 offset:4096
    ds_read_b128 v[132:135], v22 offset:4112
    ds_read_b128 v[136:139], v22 offset:6144
    ds_read_b128 v[140:143], v22 offset:6160
    s_waitcnt lgkmcnt(0)
    v_pk_add_f32 v[8:9], v[8:9], v[120:121]
    v_pk_add_f32 v[128:129], v[128:129], v[136:137]
    v_pk_add_f32 v[10:11], v[10:11], v[122:123]
    v_pk_add_f32 v[130:131], v[130:131], v[138:139]
    v_pk_add_f32 v[12:13], v[12:13], v[124:125]
    v_pk_add_f32 v[132:133], v[132:133], v[140:141]
    v_pk_add_f32 v[14:15], v[14:15], v[126:127]
    v_pk_add_f32 v[134:135], v[134:135], v[142:143]
    v_pk_add_f32 v[8:9], v[8:9], v[128:129]
    v_pk_add_f32 v[10:11], v[10:11], v[130:131]
    v_pk_add_f32 v[12:13], v[12:13], v[132:133]
    v_pk_add_f32 v[14:15], v[14:15], v[134:135]
    v_cvt_pk_bf16_f32 v8, -v8, -v9
    v_cvt_pk_bf16_f32 v9, -v10, -v11
    v_cvt_pk_bf16_f32 v10, -v12, -v13
    v_cvt_pk_bf16_f32 v11, -v14, -v15
    v_max_u32 v8, 1, v8
    v_max_u32 v9, 1, v9
    v_max_u32 v10, 1, v10
    v_max_u32 v11, 1, v11
    s_add_u32 s21, s20, 1
    s_lshl_b32 s21, s21, 13
    s_add_u32 s21, s21, s30
    s_cmp_lg_u32 s29, 0
    s_cbranch_scc1 mega_kernel_ps57
    buffer_store_dwordx2 v[8:9], v21, s[44:47], s21 offen
    buffer_store_dwordx2 v[10:11], v20, s[44:47], s21 offen offset:32
    s_branch mega_kernel_pe58
mega_kernel_ps57:
    buffer_store_dwordx2 v[8:9], v21, s[44:47], s21 offen sc1
    buffer_store_dwordx2 v[10:11], v20, s[44:47], s21 offen offset:32 sc1
mega_kernel_pe58:
mega_kernel_nw046:
    s_barrier
    s_add_u32 s20, s20, 1
    v_cmp_eq_u32 vcc, 0, v6
    s_and_b64 s[40:41], vcc, s[10:11]
    s_cbranch_scc0 mega_kernel_fk59
    s_lshl_b32 s37, s20, 8
    s_lshl_b32 s33, s31, 14
    s_add_u32 s37, s37, s33
    s_add_u32 s37, s37, 200937472
    v_lshlrev_b32 v5, 2, v62
    v_cmp_gt_u32 s[38:39], 60, v62
    s_mov_b32 s12, 0
mega_kernel_fp60:
    buffer_load_dword v4, v5, s[44:47], s37 offen sc1
    s_waitcnt vmcnt(0)
    v_cmp_eq_u32 vcc, 0, v4
    s_and_b64 s[40:41], vcc, s[38:39]
    s_cbranch_scc0 mega_kernel_fo61
    s_sleep 1
    s_add_u32 s12, s12, 1
    s_cmp_lt_u32 s12, 2000000
    s_cbranch_scc1 mega_kernel_fp60
mega_kernel_fo61:
mega_kernel_fk59:
    s_branch mega_kernel_loop44
mega_kernel_end45:
    ds_read_b128 v[16:19], v40
    ds_read_b128 v[32:35], v40 offset:1024
    s_waitcnt lgkmcnt(0)
    buffer_store_dwordx4 v[16:19], v41, s[44:47], s24 offen sc1
    buffer_store_dwordx4 v[32:35], v42, s[44:47], s24 offen sc1
    s_add_u32 s24, s24, 114688
    s_waitcnt vmcnt(0)
    s_barrier
    s_cmp_lg_u32 s3, 0
    s_cbranch_scc1 mega_kernel_fs62
    s_add_u32 s33, s32, 16384
    s_mov_b64 exec, 1
    v_mov_b32 v8, 1
    v_mov_b32 v9, 0
    buffer_store_dword v8, v9, s[44:47], s33 offen sc1
    s_sub_u32 s33, s33, 256
    buffer_store_dword v8, v9, s[44:47], s33 offen sc1
mega_kernel_fs62:
    s_branch mega_kernel_done
mega_kernel_worker15:
    v_and_b32 v2, 31, v62
    v_lshrrev_b32 v3, 5, v62
    v_lshlrev_b32 v5, 4, v62
    s_sub_u32 s6, s13, 64
    s_mov_b32 s94, s6
    s_mov_b32 s95, 0
    s_mov_b32 s96, 0
    s_cmp_ge_u32 s6, 188
    s_cbranch_scc1 mega_kernel_done
    s_cmp_ge_u32 s6, 94
    s_cselect_b32 s31, 1, 0
    s_mul_i32 s7, s31, 94
    s_sub_u32 s15, s6, s7
    s_cmp_ge_u32 s15, 86
    s_cbranch_scc1 mega_kernel_z67
    s_cmp_ge_u32 s15, 78
    s_cbranch_scc1 mega_kernel_s66
    s_cmp_ge_u32 s15, 74
    s_cbranch_scc1 mega_kernel_g365
    s_cmp_ge_u32 s15, 66
    s_cbranch_scc1 mega_kernel_t364
    s_cmp_ge_u32 s15, 60
    s_cbranch_scc1 mega_kernel_g263
    s_lshl_b32 s16, s15, 3
    s_lshl_b32 s17, s3, 1
    s_add_u32 s16, s16, s17
    s_mul_i32 s17, s16, 28672
    s_add_u32 s17, s17, 8257536
    s_add_u32 s18, s17, 28672
    v_mul_u32_u24 v61, 1792, v3
    v_lshl_add_u32 v61, v2, 3, v61
    v_mov_b32 v4, v5
    buffer_load_dwordx4 a[0:3], v4, s[44:47], s17 offen offset:0
    buffer_load_dwordx4 a[4:7], v4, s[44:47], s17 offen offset:1024
    buffer_load_dwordx4 a[8:11], v4, s[44:47], s17 offen offset:2048
    buffer_load_dwordx4 a[12:15], v4, s[44:47], s17 offen offset:3072
    v_add_u32 v4, 4096, v4
    buffer_load_dwordx4 a[16:19], v4, s[44:47], s17 offen offset:0
    buffer_load_dwordx4 a[20:23], v4, s[44:47], s17 offen offset:1024
    buffer_load_dwordx4 a[24:27], v4, s[44:47], s17 offen offset:2048
    buffer_load_dwordx4 a[28:31], v4, s[44:47], s17 offen offset:3072
    v_add_u32 v4, 4096, v4
    buffer_load_dwordx4 a[32:35], v4, s[44:47], s17 offen offset:0
    buffer_load_dwordx4 a[36:39], v4, s[44:47], s17 offen offset:1024
    buffer_load_dwordx4 a[40:43], v4, s[44:47], s17 offen offset:2048
    buffer_load_dwordx4 a[44:47], v4, s[44:47], s17 offen offset:3072
    v_add_u32 v4, 4096, v4
    buffer_load_dwordx4 a[48:51], v4, s[44:47], s17 offen offset:0
    buffer_load_dwordx4 a[52:55], v4, s[44:47], s17 offen offset:1024
    buffer_load_dwordx4 a[56:59], v4, s[44:47], s17 offen offset:2048
    buffer_load_dwordx4 a[60:63], v4, s[44:47], s17 offen offset:3072
    v_add_u32 v4, 4096, v4
    buffer_load_dwordx4 a[64:67], v4, s[44:47], s17 offen offset:0
    buffer_load_dwordx4 a[68:71], v4, s[44:47], s17 offen offset:1024
    buffer_load_dwordx4 a[72:75], v4, s[44:47], s17 offen offset:2048
    buffer_load_dwordx4 a[76:79], v4, s[44:47], s17 offen offset:3072
    v_add_u32 v4, 4096, v4
    buffer_load_dwordx4 a[80:83], v4, s[44:47], s17 offen offset:0
    buffer_load_dwordx4 a[84:87], v4, s[44:47], s17 offen offset:1024
    buffer_load_dwordx4 a[88:91], v4, s[44:47], s17 offen offset:2048
    buffer_load_dwordx4 a[92:95], v4, s[44:47], s17 offen offset:3072
    v_add_u32 v4, 4096, v4
    buffer_load_dwordx4 a[96:99], v4, s[44:47], s17 offen offset:0
    buffer_load_dwordx4 a[100:103], v4, s[44:47], s17 offen offset:1024
    buffer_load_dwordx4 a[104:107], v4, s[44:47], s17 offen offset:2048
    buffer_load_dwordx4 a[108:111], v4, s[44:47], s17 offen offset:3072
    v_mov_b32 v4, v5
    buffer_load_dwordx4 a[112:115], v4, s[44:47], s18 offen offset:0
    buffer_load_dwordx4 a[116:119], v4, s[44:47], s18 offen offset:1024
    buffer_load_dwordx4 a[120:123], v4, s[44:47], s18 offen offset:2048
    buffer_load_dwordx4 a[124:127], v4, s[44:47], s18 offen offset:3072
    v_add_u32 v4, 4096, v4
    buffer_load_dwordx4 a[128:131], v4, s[44:47], s18 offen offset:0
    buffer_load_dwordx4 a[132:135], v4, s[44:47], s18 offen offset:1024
    buffer_load_dwordx4 a[136:139], v4, s[44:47], s18 offen offset:2048
    buffer_load_dwordx4 a[140:143], v4, s[44:47], s18 offen offset:3072
    v_add_u32 v4, 4096, v4
    buffer_load_dwordx4 a[144:147], v4, s[44:47], s18 offen offset:0
    buffer_load_dwordx4 a[148:151], v4, s[44:47], s18 offen offset:1024
    buffer_load_dwordx4 a[152:155], v4, s[44:47], s18 offen offset:2048
    buffer_load_dwordx4 a[156:159], v4, s[44:47], s18 offen offset:3072
    v_add_u32 v4, 4096, v4
    buffer_load_dwordx4 a[160:163], v4, s[44:47], s18 offen offset:0
    buffer_load_dwordx4 a[164:167], v4, s[44:47], s18 offen offset:1024
    buffer_load_dwordx4 a[168:171], v4, s[44:47], s18 offen offset:2048
    buffer_load_dwordx4 a[172:175], v4, s[44:47], s18 offen offset:3072
    v_add_u32 v4, 4096, v4
    buffer_load_dwordx4 a[176:179], v4, s[44:47], s18 offen offset:0
    buffer_load_dwordx4 a[180:183], v4, s[44:47], s18 offen offset:1024
    buffer_load_dwordx4 a[184:187], v4, s[44:47], s18 offen offset:2048
    buffer_load_dwordx4 a[188:191], v4, s[44:47], s18 offen offset:3072
    v_add_u32 v4, 4096, v4
    buffer_load_dwordx4 a[192:195], v4, s[44:47], s18 offen offset:0
    buffer_load_dwordx4 a[196:199], v4, s[44:47], s18 offen offset:1024
    buffer_load_dwordx4 a[200:203], v4, s[44:47], s18 offen offset:2048
    buffer_load_dwordx4 a[204:207], v4, s[44:47], s18 offen offset:3072
    v_add_u32 v4, 4096, v4
    buffer_load_dwordx4 a[208:211], v4, s[44:47], s18 offen offset:0
    buffer_load_dwordx4 a[212:215], v4, s[44:47], s18 offen offset:1024
    buffer_load_dwordx4 a[216:219], v4, s[44:47], s18 offen offset:2048
    buffer_load_dwordx4 a[220:223], v4, s[44:47], s18 offen offset:3072
    s_lshl_b32 s26, s31, 1
    s_add_u32 s26, s26, 1
    s_mul_i32 s27, s26, 229376
    s_add_u32 s27, s27, 7340032
    s_mul_i32 s26, s26, 1835008
    s_add_u32 s26, s26, 0
    s_cmp_ge_u32 s16, 256
    s_cbranch_scc1 mega_kernel_vo68
    s_mul_i32 s22, s31, 33554432
    s_add_u32 s22, s22, 44302336
    s_lshl_b32 s19, s16, 11
    s_add_u32 s22, s22, s19
    s_mov_b32 s23, 524288
    s_mov_b32 s24, 0
    s_branch mega_kernel_set69
mega_kernel_vo68:
    s_mul_i32 s22, s31, 29360128
    s_add_u32 s22, s22, 111411200
    s_sub_u32 s19, s16, 256
    s_lshl_b32 s19, s19, 11
    s_add_u32 s22, s22, s19
    s_mov_b32 s23, 458752
    s_mov_b32 s24, 1
mega_kernel_set69:
    s_mov_b32 s20, 0
    s_waitcnt vmcnt(0)
mega_kernel_gl70:
    s_cmp_lg_u32 s96, 0
    s_cbranch_scc1 mega_kernel_pf74
    s_lshl_b32 s37, s20, 8
    s_lshl_b32 s33, s31, 14
    s_add_u32 s37, s37, s33
    s_add_u32 s37, s37, 200904704
    v_lshlrev_b32 v9, 2, v62
    v_cmp_gt_u32 s[38:39], 4, v62
    s_mov_b32 s12, 0
    buffer_load_dword v8, v9, s[44:47], s37 offen sc1
    s_waitcnt vmcnt(0)
    s_cmp_eq_u32 s95, 0
    s_cbranch_scc1 mega_kernel_f180
    s_barrier
    s_cmp_lg_u32 s3, 0
    s_cbranch_scc1 mega_kernel_f180
    s_sub_u32 s32, s20, 1
    s_lshl_b32 s32, s32, 8
    s_add_u32 s32, s32, s33
    s_lshl_b32 s33, s15, 2
    s_add_u32 s32, s32, s33
    s_add_u32 s32, s32, 200937472
    s_mov_b64 s[34:35], exec
    s_mov_b64 exec, 1
    v_mov_b32 v10, 1
    v_mov_b32 v11, 0
    buffer_store_dword v10, v11, s[44:47], s32 offen sc1
    s_mov_b64 exec, s[34:35]
mega_kernel_f180:
    s_mov_b32 s95, 1
    s_branch mega_kernel_f281
mega_kernel_fp78:
    s_sleep 1
    buffer_load_dword v8, v9, s[44:47], s37 offen sc1
    s_waitcnt vmcnt(0)
mega_kernel_f281:
    v_cmp_eq_u32 vcc, 0, v8
    s_and_b64 s[40:41], vcc, s[38:39]
    s_cbranch_scc0 mega_kernel_fo79
    s_add_u32 s12, s12, 1
    s_cmp_lt_u32 s12, 2000000
    s_cbranch_scc1 mega_kernel_fp78
mega_kernel_fo79:
    s_mul_i32 s6, s20, 28672
    s_add_u32 s6, s6, s26
    s_mul_i32 s7, s3, 7168
    s_add_u32 s6, s6, s7
    s_mul_i32 s8, s20, 3584
    s_add_u32 s8, s8, s27
    v_add_u32 v4, 4096, v5
    buffer_load_dwordx4 v[128:131], v5, s[44:47], s6 offen offset:0 sc1
    buffer_load_dwordx4 v[132:135], v5, s[44:47], s6 offen offset:1024 sc1
    buffer_load_dwordx4 v[136:139], v5, s[44:47], s6 offen offset:2048 sc1
    buffer_load_dwordx4 v[140:143], v5, s[44:47], s6 offen offset:3072 sc1
    buffer_load_dwordx4 v[144:147], v4, s[44:47], s6 offen offset:0 sc1
    buffer_load_dwordx4 v[148:151], v4, s[44:47], s6 offen offset:1024 sc1
    buffer_load_dwordx4 v[152:155], v4, s[44:47], s6 offen offset:2048 sc1
    buffer_load_dwordx2 v[160:161], v61, s[44:47], s8 offen offset:0 sc1
    buffer_load_dwordx2 v[162:163], v61, s[44:47], s8 offen offset:256 sc1
    buffer_load_dwordx2 v[164:165], v61, s[44:47], s8 offen offset:512 sc1
    buffer_load_dwordx2 v[166:167], v61, s[44:47], s8 offen offset:768 sc1
    buffer_load_dwordx2 v[168:169], v61, s[44:47], s8 offen offset:1024 sc1
    buffer_load_dwordx2 v[170:171], v61, s[44:47], s8 offen offset:1280 sc1
    buffer_load_dwordx2 v[172:173], v61, s[44:47], s8 offen offset:1536 sc1
    s_add_u32 s37, s20, 1
    s_lshl_b32 s37, s37, 8
    s_lshl_b32 s33, s31, 14
    s_add_u32 s37, s37, s33
    s_add_u32 s37, s37, 200904704
    v_lshlrev_b32 v13, 2, v62
    buffer_load_dword v12, v13, s[44:47], s37 offen sc1
    s_waitcnt vmcnt(0)
    s_branch mega_kernel_go75
mega_kernel_pf74:
    s_add_u32 s37, s20, 1
    s_lshl_b32 s37, s37, 8
    s_lshl_b32 s33, s31, 14
    s_add_u32 s37, s37, s33
    s_add_u32 s37, s37, 200904704
    v_lshlrev_b32 v13, 2, v62
    buffer_load_dword v12, v13, s[44:47], s37 offen sc1
    s_waitcnt vmcnt(0)
    s_barrier
    s_cmp_lg_u32 s3, 0
    s_cbranch_scc1 mega_kernel_sg77
    s_sub_u32 s32, s20, 1
    s_lshl_b32 s32, s32, 8
    s_lshl_b32 s33, s31, 14
    s_add_u32 s32, s32, s33
    s_lshl_b32 s33, s15, 2
    s_add_u32 s32, s32, s33
    s_add_u32 s32, s32, 200937472
    s_mov_b64 s[34:35], exec
    s_mov_b64 exec, 1
    v_mov_b32 v10, 1
    v_mov_b32 v11, 0
    buffer_store_dword v10, v11, s[44:47], s32 offen sc1
    s_mov_b64 exec, s[34:35]
mega_kernel_sg77:
mega_kernel_go75:
    v_add_f32 v160, v160, v162
    v_add_f32 v161, v161, v163
    v_add_f32 v160, v160, v164
    v_add_f32 v161, v161, v165
    v_add_f32 v160, v160, v166
    v_add_f32 v161, v161, v167
    v_add_f32 v160, v160, v168
    v_add_f32 v161, v161, v169
    v_add_f32 v160, v160, v170
    v_add_f32 v161, v161, v171
    v_add_f32 v160, v160, v172
    v_add_f32 v161, v161, v173
    v_mov_b32 v162, v160
    v_mov_b32 v163, v161
    s_nop 1
    v_permlane32_swap_b32 v160, v162
    v_permlane32_swap_b32 v161, v163
    s_nop 1
    v_add_f32 v160, v160, v162
    v_add_f32 v161, v161, v163
    v_mul_f32 v160, 0x3b124925, v160
    v_mul_f32 v161, 0x3b124925, v161
    v_fma_f32 v161, -v160, v160, v161
    v_max_f32 v161, 0, v161
    v_add_f32 v161, 0x3727c5ac, v161
    v_rsq_f32 v161, v161
    s_nop 0
    v_mul_f32 v160, v160, v161
    v_lshlrev_b32 v164, 16, v128
    v_and_b32 v165, 0xffff0000, v128
    v_fma_f32 v164, v164, v161, -v160
    v_fma_f32 v165, v165, v161, -v160
    v_cvt_pk_bf16_f32 v64, v164, v165
    v_lshlrev_b32 v164, 16, v129
    v_and_b32 v165, 0xffff0000, v129
    v_fma_f32 v164, v164, v161, -v160
    v_fma_f32 v165, v165, v161, -v160
    v_cvt_pk_bf16_f32 v65, v164, v165
    v_lshlrev_b32 v164, 16, v130
    v_and_b32 v165, 0xffff0000, v130
    v_fma_f32 v164, v164, v161, -v160
    v_fma_f32 v165, v165, v161, -v160
    v_cvt_pk_bf16_f32 v66, v164, v165
    v_lshlrev_b32 v164, 16, v131
    v_and_b32 v165, 0xffff0000, v131
    v_fma_f32 v164, v164, v161, -v160
    v_fma_f32 v165, v165, v161, -v160
    v_cvt_pk_bf16_f32 v67, v164, v165
    v_lshlrev_b32 v164, 16, v132
    v_and_b32 v165, 0xffff0000, v132
    v_fma_f32 v164, v164, v161, -v160
    v_fma_f32 v165, v165, v161, -v160
    v_cvt_pk_bf16_f32 v68, v164, v165
    v_lshlrev_b32 v164, 16, v133
    v_and_b32 v165, 0xffff0000, v133
    v_fma_f32 v164, v164, v161, -v160
    v_fma_f32 v165, v165, v161, -v160
    v_cvt_pk_bf16_f32 v69, v164, v165
    v_lshlrev_b32 v164, 16, v134
    v_and_b32 v165, 0xffff0000, v134
    v_fma_f32 v164, v164, v161, -v160
    v_fma_f32 v165, v165, v161, -v160
    v_cvt_pk_bf16_f32 v70, v164, v165
    v_lshlrev_b32 v164, 16, v135
    v_and_b32 v165, 0xffff0000, v135
    v_fma_f32 v164, v164, v161, -v160
    v_fma_f32 v165, v165, v161, -v160
    v_cvt_pk_bf16_f32 v71, v164, v165
    v_lshlrev_b32 v164, 16, v136
    v_and_b32 v165, 0xffff0000, v136
    v_fma_f32 v164, v164, v161, -v160
    v_fma_f32 v165, v165, v161, -v160
    v_cvt_pk_bf16_f32 v72, v164, v165
    v_lshlrev_b32 v164, 16, v137
    v_and_b32 v165, 0xffff0000, v137
    v_fma_f32 v164, v164, v161, -v160
    v_fma_f32 v165, v165, v161, -v160
    v_cvt_pk_bf16_f32 v73, v164, v165
    v_lshlrev_b32 v164, 16, v138
    v_and_b32 v165, 0xffff0000, v138
    v_fma_f32 v164, v164, v161, -v160
    v_fma_f32 v165, v165, v161, -v160
    v_cvt_pk_bf16_f32 v74, v164, v165
    v_lshlrev_b32 v164, 16, v139
    v_and_b32 v165, 0xffff0000, v139
    v_fma_f32 v164, v164, v161, -v160
    v_fma_f32 v165, v165, v161, -v160
    v_cvt_pk_bf16_f32 v75, v164, v165
    v_lshlrev_b32 v164, 16, v140
    v_and_b32 v165, 0xffff0000, v140
    v_fma_f32 v164, v164, v161, -v160
    v_fma_f32 v165, v165, v161, -v160
    v_cvt_pk_bf16_f32 v76, v164, v165
    v_lshlrev_b32 v164, 16, v141
    v_and_b32 v165, 0xffff0000, v141
    v_fma_f32 v164, v164, v161, -v160
    v_fma_f32 v165, v165, v161, -v160
    v_cvt_pk_bf16_f32 v77, v164, v165
    v_lshlrev_b32 v164, 16, v142
    v_and_b32 v165, 0xffff0000, v142
    v_fma_f32 v164, v164, v161, -v160
    v_fma_f32 v165, v165, v161, -v160
    v_cvt_pk_bf16_f32 v78, v164, v165
    v_lshlrev_b32 v164, 16, v143
    v_and_b32 v165, 0xffff0000, v143
    v_fma_f32 v164, v164, v161, -v160
    v_fma_f32 v165, v165, v161, -v160
    v_cvt_pk_bf16_f32 v79, v164, v165
    v_lshlrev_b32 v164, 16, v144
    v_and_b32 v165, 0xffff0000, v144
    v_fma_f32 v164, v164, v161, -v160
    v_fma_f32 v165, v165, v161, -v160
    v_cvt_pk_bf16_f32 v80, v164, v165
    v_lshlrev_b32 v164, 16, v145
    v_and_b32 v165, 0xffff0000, v145
    v_fma_f32 v164, v164, v161, -v160
    v_fma_f32 v165, v165, v161, -v160
    v_cvt_pk_bf16_f32 v81, v164, v165
    v_lshlrev_b32 v164, 16, v146
    v_and_b32 v165, 0xffff0000, v146
    v_fma_f32 v164, v164, v161, -v160
    v_fma_f32 v165, v165, v161, -v160
    v_cvt_pk_bf16_f32 v82, v164, v165
    v_lshlrev_b32 v164, 16, v147
    v_and_b32 v165, 0xffff0000, v147
    v_fma_f32 v164, v164, v161, -v160
    v_fma_f32 v165, v165, v161, -v160
    v_cvt_pk_bf16_f32 v83, v164, v165
    v_lshlrev_b32 v164, 16, v148
    v_and_b32 v165, 0xffff0000, v148
    v_fma_f32 v164, v164, v161, -v160
    v_fma_f32 v165, v165, v161, -v160
    v_cvt_pk_bf16_f32 v84, v164, v165
    v_lshlrev_b32 v164, 16, v149
    v_and_b32 v165, 0xffff0000, v149
    v_fma_f32 v164, v164, v161, -v160
    v_fma_f32 v165, v165, v161, -v160
    v_cvt_pk_bf16_f32 v85, v164, v165
    v_lshlrev_b32 v164, 16, v150
    v_and_b32 v165, 0xffff0000, v150
    v_fma_f32 v164, v164, v161, -v160
    v_fma_f32 v165, v165, v161, -v160
    v_cvt_pk_bf16_f32 v86, v164, v165
    v_lshlrev_b32 v164, 16, v151
    v_and_b32 v165, 0xffff0000, v151
    v_fma_f32 v164, v164, v161, -v160
    v_fma_f32 v165, v165, v161, -v160
    v_cvt_pk_bf16_f32 v87, v164, v165
    v_lshlrev_b32 v164, 16, v152
    v_and_b32 v165, 0xffff0000, v152
    v_fma_f32 v164, v164, v161, -v160
    v_fma_f32 v165, v165, v161, -v160
    v_cvt_pk_bf16_f32 v88, v164, v165
    v_lshlrev_b32 v164, 16, v153
    v_and_b32 v165, 0xffff0000, v153
    v_fma_f32 v164, v164, v161, -v160
    v_fma_f32 v165, v165, v161, -v160
    v_cvt_pk_bf16_f32 v89, v164, v165
    v_lshlrev_b32 v164, 16, v154
    v_and_b32 v165, 0xffff0000, v154
    v_fma_f32 v164, v164, v161, -v160
    v_fma_f32 v165, v165, v161, -v160
    v_cvt_pk_bf16_f32 v90, v164, v165
    v_lshlrev_b32 v164, 16, v155
    v_and_b32 v165, 0xffff0000, v155
    v_fma_f32 v164, v164, v161, -v160
    v_fma_f32 v165, v165, v161, -v160
    v_cvt_pk_bf16_f32 v91, v164, v165
    s_mul_i32 s7, s3, 7168
    v_add_u32 v4, s7, v5
    ds_write_b128 v4, v[64:67] offset:0
    ds_write_b128 v4, v[68:71] offset:1024
    ds_write_b128 v4, v[72:75] offset:2048
    ds_write_b128 v4, v[76:79] offset:3072
    ds_write_b128 v4, v[80:83] offset:4096
    ds_write_b128 v4, v[84:87] offset:5120
    ds_write_b128 v4, v[88:91] offset:6144
    s_mov_b32 s96, 0
    s_cmp_ge_u32 s20, 63
    s_cbranch_scc1 mega_kernel_np76
    v_cmp_gt_u32 s[38:39], 4, v62
    v_cmp_eq_u32 vcc, 0, v12
    s_and_b64 s[40:41], vcc, s[38:39]
    s_cbranch_scc1 mega_kernel_np76
    s_mov_b32 s96, 1
    s_add_u32 s19, s20, 1
    s_mul_i32 s6, s19, 28672
    s_add_u32 s6, s6, s26
    s_mul_i32 s7, s3, 7168
    s_add_u32 s6, s6, s7
    s_mul_i32 s8, s19, 3584
    s_add_u32 s8, s8, s27
    v_add_u32 v4, 4096, v5
    buffer_load_dwordx4 v[128:131], v5, s[44:47], s6 offen offset:0 sc1
    buffer_load_dwordx4 v[132:135], v5, s[44:47], s6 offen offset:1024 sc1
    buffer_load_dwordx4 v[136:139], v5, s[44:47], s6 offen offset:2048 sc1
    buffer_load_dwordx4 v[140:143], v5, s[44:47], s6 offen offset:3072 sc1
    buffer_load_dwordx4 v[144:147], v4, s[44:47], s6 offen offset:0 sc1
    buffer_load_dwordx4 v[148:151], v4, s[44:47], s6 offen offset:1024 sc1
    buffer_load_dwordx4 v[152:155], v4, s[44:47], s6 offen offset:2048 sc1
    buffer_load_dwordx2 v[160:161], v61, s[44:47], s8 offen offset:0 sc1
    buffer_load_dwordx2 v[162:163], v61, s[44:47], s8 offen offset:256 sc1
    buffer_load_dwordx2 v[164:165], v61, s[44:47], s8 offen offset:512 sc1
    buffer_load_dwordx2 v[166:167], v61, s[44:47], s8 offen offset:768 sc1
    buffer_load_dwordx2 v[168:169], v61, s[44:47], s8 offen offset:1024 sc1
    buffer_load_dwordx2 v[170:171], v61, s[44:47], s8 offen offset:1280 sc1
    buffer_load_dwordx2 v[172:173], v61, s[44:47], s8 offen offset:1536 sc1
mega_kernel_np76:
    s_waitcnt lgkmcnt(0)
    s_barrier
    s_cmp_lg_u32 s24, 0
    s_cbranch_scc1 mega_kernel_f171
    ds_read_b128 v[64:67], v5 offset:0
    ds_read_b128 v[68:71], v5 offset:1024
    ds_read_b128 v[72:75], v5 offset:2048
    ds_read_b128 v[76:79], v5 offset:3072
    s_waitcnt lgkmcnt(3)
    v_mfma_f32_32x32x16_bf16 v[16:31], a[0:3], v[64:67], 0
    ds_read_b128 v[80:83], v5 offset:4096
    v_mfma_f32_32x32x16_bf16 v[32:47], a[112:115], v[64:67], 0
    s_waitcnt lgkmcnt(3)
    v_mfma_f32_32x32x16_bf16 v[16:31], a[4:7], v[68:71], v[16:31]
    ds_read_b128 v[64:67], v5 offset:5120
    v_mfma_f32_32x32x16_bf16 v[32:47], a[116:119], v[68:71], v[32:47]
    s_waitcnt lgkmcnt(3)
    v_mfma_f32_32x32x16_bf16 v[16:31], a[8:11], v[72:75], v[16:31]
    ds_read_b128 v[68:71], v5 offset:6144
    v_mfma_f32_32x32x16_bf16 v[32:47], a[120:123], v[72:75], v[32:47]
    s_waitcnt lgkmcnt(3)
    v_mfma_f32_32x32x16_bf16 v[16:31], a[12:15], v[76:79], v[16:31]
    ds_read_b128 v[72:75], v5 offset:7168
    v_mfma_f32_32x32x16_bf16 v[32:47], a[124:127], v[76:79], v[32:47]
    s_waitcnt lgkmcnt(3)
    v_mfma_f32_32x32x16_bf16 v[16:31], a[16:19], v[80:83], v[16:31]
    ds_read_b128 v[76:79], v5 offset:8192
    v_mfma_f32_32x32x16_bf16 v[32:47], a[128:131], v[80:83], v[32:47]
    s_waitcnt lgkmcnt(3)
    v_mfma_f32_32x32x16_bf16 v[16:31], a[20:23], v[64:67], v[16:31]
    ds_read_b128 v[80:83], v5 offset:9216
    v_mfma_f32_32x32x16_bf16 v[32:47], a[132:135], v[64:67], v[32:47]
    s_waitcnt lgkmcnt(3)
    v_mfma_f32_32x32x16_bf16 v[16:31], a[24:27], v[68:71], v[16:31]
    ds_read_b128 v[64:67], v5 offset:10240
    v_mfma_f32_32x32x16_bf16 v[32:47], a[136:139], v[68:71], v[32:47]
    s_waitcnt lgkmcnt(3)
    v_mfma_f32_32x32x16_bf16 v[16:31], a[28:31], v[72:75], v[16:31]
    ds_read_b128 v[68:71], v5 offset:11264
    v_mfma_f32_32x32x16_bf16 v[32:47], a[140:143], v[72:75], v[32:47]
    s_waitcnt lgkmcnt(3)
    v_mfma_f32_32x32x16_bf16 v[16:31], a[32:35], v[76:79], v[16:31]
    ds_read_b128 v[72:75], v5 offset:12288
    v_mfma_f32_32x32x16_bf16 v[32:47], a[144:147], v[76:79], v[32:47]
    s_waitcnt lgkmcnt(3)
    v_mfma_f32_32x32x16_bf16 v[16:31], a[36:39], v[80:83], v[16:31]
    ds_read_b128 v[76:79], v5 offset:13312
    v_mfma_f32_32x32x16_bf16 v[32:47], a[148:151], v[80:83], v[32:47]
    s_waitcnt lgkmcnt(3)
    v_mfma_f32_32x32x16_bf16 v[16:31], a[40:43], v[64:67], v[16:31]
    ds_read_b128 v[80:83], v5 offset:14336
    v_mfma_f32_32x32x16_bf16 v[32:47], a[152:155], v[64:67], v[32:47]
    s_waitcnt lgkmcnt(3)
    v_mfma_f32_32x32x16_bf16 v[16:31], a[44:47], v[68:71], v[16:31]
    ds_read_b128 v[64:67], v5 offset:15360
    v_mfma_f32_32x32x16_bf16 v[32:47], a[156:159], v[68:71], v[32:47]
    s_waitcnt lgkmcnt(3)
    v_mfma_f32_32x32x16_bf16 v[16:31], a[48:51], v[72:75], v[16:31]
    ds_read_b128 v[68:71], v5 offset:16384
    v_mfma_f32_32x32x16_bf16 v[32:47], a[160:163], v[72:75], v[32:47]
    s_waitcnt lgkmcnt(3)
    v_mfma_f32_32x32x16_bf16 v[16:31], a[52:55], v[76:79], v[16:31]
    ds_read_b128 v[72:75], v5 offset:17408
    v_mfma_f32_32x32x16_bf16 v[32:47], a[164:167], v[76:79], v[32:47]
    s_waitcnt lgkmcnt(3)
    v_mfma_f32_32x32x16_bf16 v[16:31], a[56:59], v[80:83], v[16:31]
    ds_read_b128 v[76:79], v5 offset:18432
    v_mfma_f32_32x32x16_bf16 v[32:47], a[168:171], v[80:83], v[32:47]
    s_waitcnt lgkmcnt(3)
    v_mfma_f32_32x32x16_bf16 v[16:31], a[60:63], v[64:67], v[16:31]
    ds_read_b128 v[80:83], v5 offset:19456
    v_mfma_f32_32x32x16_bf16 v[32:47], a[172:175], v[64:67], v[32:47]
    s_waitcnt lgkmcnt(3)
    v_mfma_f32_32x32x16_bf16 v[16:31], a[64:67], v[68:71], v[16:31]
    ds_read_b128 v[64:67], v5 offset:20480
    v_mfma_f32_32x32x16_bf16 v[32:47], a[176:179], v[68:71], v[32:47]
    s_waitcnt lgkmcnt(3)
    v_mfma_f32_32x32x16_bf16 v[16:31], a[68:71], v[72:75], v[16:31]
    ds_read_b128 v[68:71], v5 offset:21504
    v_mfma_f32_32x32x16_bf16 v[32:47], a[180:183], v[72:75], v[32:47]
    s_waitcnt lgkmcnt(3)
    v_mfma_f32_32x32x16_bf16 v[16:31], a[72:75], v[76:79], v[16:31]
    ds_read_b128 v[72:75], v5 offset:22528
    v_mfma_f32_32x32x16_bf16 v[32:47], a[184:187], v[76:79], v[32:47]
    s_waitcnt lgkmcnt(3)
    v_mfma_f32_32x32x16_bf16 v[16:31], a[76:79], v[80:83], v[16:31]
    ds_read_b128 v[76:79], v5 offset:23552
    v_mfma_f32_32x32x16_bf16 v[32:47], a[188:191], v[80:83], v[32:47]
    s_waitcnt lgkmcnt(3)
    v_mfma_f32_32x32x16_bf16 v[16:31], a[80:83], v[64:67], v[16:31]
    ds_read_b128 v[80:83], v5 offset:24576
    v_mfma_f32_32x32x16_bf16 v[32:47], a[192:195], v[64:67], v[32:47]
    s_waitcnt lgkmcnt(3)
    v_mfma_f32_32x32x16_bf16 v[16:31], a[84:87], v[68:71], v[16:31]
    ds_read_b128 v[64:67], v5 offset:25600
    v_mfma_f32_32x32x16_bf16 v[32:47], a[196:199], v[68:71], v[32:47]
    s_waitcnt lgkmcnt(3)
    v_mfma_f32_32x32x16_bf16 v[16:31], a[88:91], v[72:75], v[16:31]
    ds_read_b128 v[68:71], v5 offset:26624
    v_mfma_f32_32x32x16_bf16 v[32:47], a[200:203], v[72:75], v[32:47]
    s_waitcnt lgkmcnt(3)
    v_mfma_f32_32x32x16_bf16 v[16:31], a[92:95], v[76:79], v[16:31]
    ds_read_b128 v[72:75], v5 offset:27648
    v_mfma_f32_32x32x16_bf16 v[32:47], a[204:207], v[76:79], v[32:47]
    s_waitcnt lgkmcnt(3)
    v_mfma_f32_32x32x16_bf16 v[16:31], a[96:99], v[80:83], v[16:31]
    v_mfma_f32_32x32x16_bf16 v[32:47], a[208:211], v[80:83], v[32:47]
    s_waitcnt lgkmcnt(2)
    v_mfma_f32_32x32x16_bf16 v[16:31], a[100:103], v[64:67], v[16:31]
    v_mfma_f32_32x32x16_bf16 v[32:47], a[212:215], v[64:67], v[32:47]
    s_waitcnt lgkmcnt(1)
    v_mfma_f32_32x32x16_bf16 v[16:31], a[104:107], v[68:71], v[16:31]
    v_mfma_f32_32x32x16_bf16 v[32:47], a[216:219], v[68:71], v[32:47]
    s_waitcnt lgkmcnt(0)
    v_mfma_f32_32x32x16_bf16 v[16:31], a[108:111], v[72:75], v[16:31]
    v_mfma_f32_32x32x16_bf16 v[32:47], a[220:223], v[72:75], v[32:47]
    s_branch mega_kernel_ge72
mega_kernel_f171:
    ds_read_b128 v[64:67], v5 offset:0
    ds_read_b128 v[68:71], v5 offset:1024
    ds_read_b128 v[72:75], v5 offset:2048
    ds_read_b128 v[76:79], v5 offset:3072
    s_waitcnt lgkmcnt(3)
    v_mfma_f32_32x32x16_bf16 v[16:31], v[64:67], a[0:3], 0
    ds_read_b128 v[80:83], v5 offset:4096
    v_mfma_f32_32x32x16_bf16 v[32:47], v[64:67], a[112:115], 0
    s_waitcnt lgkmcnt(3)
    v_mfma_f32_32x32x16_bf16 v[16:31], v[68:71], a[4:7], v[16:31]
    ds_read_b128 v[64:67], v5 offset:5120
    v_mfma_f32_32x32x16_bf16 v[32:47], v[68:71], a[116:119], v[32:47]
    s_waitcnt lgkmcnt(3)
    v_mfma_f32_32x32x16_bf16 v[16:31], v[72:75], a[8:11], v[16:31]
    ds_read_b128 v[68:71], v5 offset:6144
    v_mfma_f32_32x32x16_bf16 v[32:47], v[72:75], a[120:123], v[32:47]
    s_waitcnt lgkmcnt(3)
    v_mfma_f32_32x32x16_bf16 v[16:31], v[76:79], a[12:15], v[16:31]
    ds_read_b128 v[72:75], v5 offset:7168
    v_mfma_f32_32x32x16_bf16 v[32:47], v[76:79], a[124:127], v[32:47]
    s_waitcnt lgkmcnt(3)
    v_mfma_f32_32x32x16_bf16 v[16:31], v[80:83], a[16:19], v[16:31]
    ds_read_b128 v[76:79], v5 offset:8192
    v_mfma_f32_32x32x16_bf16 v[32:47], v[80:83], a[128:131], v[32:47]
    s_waitcnt lgkmcnt(3)
    v_mfma_f32_32x32x16_bf16 v[16:31], v[64:67], a[20:23], v[16:31]
    ds_read_b128 v[80:83], v5 offset:9216
    v_mfma_f32_32x32x16_bf16 v[32:47], v[64:67], a[132:135], v[32:47]
    s_waitcnt lgkmcnt(3)
    v_mfma_f32_32x32x16_bf16 v[16:31], v[68:71], a[24:27], v[16:31]
    ds_read_b128 v[64:67], v5 offset:10240
    v_mfma_f32_32x32x16_bf16 v[32:47], v[68:71], a[136:139], v[32:47]
    s_waitcnt lgkmcnt(3)
    v_mfma_f32_32x32x16_bf16 v[16:31], v[72:75], a[28:31], v[16:31]
    ds_read_b128 v[68:71], v5 offset:11264
    v_mfma_f32_32x32x16_bf16 v[32:47], v[72:75], a[140:143], v[32:47]
    s_waitcnt lgkmcnt(3)
    v_mfma_f32_32x32x16_bf16 v[16:31], v[76:79], a[32:35], v[16:31]
    ds_read_b128 v[72:75], v5 offset:12288
    v_mfma_f32_32x32x16_bf16 v[32:47], v[76:79], a[144:147], v[32:47]
    s_waitcnt lgkmcnt(3)
    v_mfma_f32_32x32x16_bf16 v[16:31], v[80:83], a[36:39], v[16:31]
    ds_read_b128 v[76:79], v5 offset:13312
    v_mfma_f32_32x32x16_bf16 v[32:47], v[80:83], a[148:151], v[32:47]
    s_waitcnt lgkmcnt(3)
    v_mfma_f32_32x32x16_bf16 v[16:31], v[64:67], a[40:43], v[16:31]
    ds_read_b128 v[80:83], v5 offset:14336
    v_mfma_f32_32x32x16_bf16 v[32:47], v[64:67], a[152:155], v[32:47]
    s_waitcnt lgkmcnt(3)
    v_mfma_f32_32x32x16_bf16 v[16:31], v[68:71], a[44:47], v[16:31]
    ds_read_b128 v[64:67], v5 offset:15360
    v_mfma_f32_32x32x16_bf16 v[32:47], v[68:71], a[156:159], v[32:47]
    s_waitcnt lgkmcnt(3)
    v_mfma_f32_32x32x16_bf16 v[16:31], v[72:75], a[48:51], v[16:31]
    ds_read_b128 v[68:71], v5 offset:16384
    v_mfma_f32_32x32x16_bf16 v[32:47], v[72:75], a[160:163], v[32:47]
    s_waitcnt lgkmcnt(3)
    v_mfma_f32_32x32x16_bf16 v[16:31], v[76:79], a[52:55], v[16:31]
    ds_read_b128 v[72:75], v5 offset:17408
    v_mfma_f32_32x32x16_bf16 v[32:47], v[76:79], a[164:167], v[32:47]
    s_waitcnt lgkmcnt(3)
    v_mfma_f32_32x32x16_bf16 v[16:31], v[80:83], a[56:59], v[16:31]
    ds_read_b128 v[76:79], v5 offset:18432
    v_mfma_f32_32x32x16_bf16 v[32:47], v[80:83], a[168:171], v[32:47]
    s_waitcnt lgkmcnt(3)
    v_mfma_f32_32x32x16_bf16 v[16:31], v[64:67], a[60:63], v[16:31]
    ds_read_b128 v[80:83], v5 offset:19456
    v_mfma_f32_32x32x16_bf16 v[32:47], v[64:67], a[172:175], v[32:47]
    s_waitcnt lgkmcnt(3)
    v_mfma_f32_32x32x16_bf16 v[16:31], v[68:71], a[64:67], v[16:31]
    ds_read_b128 v[64:67], v5 offset:20480
    v_mfma_f32_32x32x16_bf16 v[32:47], v[68:71], a[176:179], v[32:47]
    s_waitcnt lgkmcnt(3)
    v_mfma_f32_32x32x16_bf16 v[16:31], v[72:75], a[68:71], v[16:31]
    ds_read_b128 v[68:71], v5 offset:21504
    v_mfma_f32_32x32x16_bf16 v[32:47], v[72:75], a[180:183], v[32:47]
    s_waitcnt lgkmcnt(3)
    v_mfma_f32_32x32x16_bf16 v[16:31], v[76:79], a[72:75], v[16:31]
    ds_read_b128 v[72:75], v5 offset:22528
    v_mfma_f32_32x32x16_bf16 v[32:47], v[76:79], a[184:187], v[32:47]
    s_waitcnt lgkmcnt(3)
    v_mfma_f32_32x32x16_bf16 v[16:31], v[80:83], a[76:79], v[16:31]
    ds_read_b128 v[76:79], v5 offset:23552
    v_mfma_f32_32x32x16_bf16 v[32:47], v[80:83], a[188:191], v[32:47]
    s_waitcnt lgkmcnt(3)
    v_mfma_f32_32x32x16_bf16 v[16:31], v[64:67], a[80:83], v[16:31]
    ds_read_b128 v[80:83], v5 offset:24576
    v_mfma_f32_32x32x16_bf16 v[32:47], v[64:67], a[192:195], v[32:47]
    s_waitcnt lgkmcnt(3)
    v_mfma_f32_32x32x16_bf16 v[16:31], v[68:71], a[84:87], v[16:31]
    ds_read_b128 v[64:67], v5 offset:25600
    v_mfma_f32_32x32x16_bf16 v[32:47], v[68:71], a[196:199], v[32:47]
    s_waitcnt lgkmcnt(3)
    v_mfma_f32_32x32x16_bf16 v[16:31], v[72:75], a[88:91], v[16:31]
    ds_read_b128 v[68:71], v5 offset:26624
    v_mfma_f32_32x32x16_bf16 v[32:47], v[72:75], a[200:203], v[32:47]
    s_waitcnt lgkmcnt(3)
    v_mfma_f32_32x32x16_bf16 v[16:31], v[76:79], a[92:95], v[16:31]
    ds_read_b128 v[72:75], v5 offset:27648
    v_mfma_f32_32x32x16_bf16 v[32:47], v[76:79], a[204:207], v[32:47]
    s_waitcnt lgkmcnt(3)
    v_mfma_f32_32x32x16_bf16 v[16:31], v[80:83], a[96:99], v[16:31]
    v_mfma_f32_32x32x16_bf16 v[32:47], v[80:83], a[208:211], v[32:47]
    s_waitcnt lgkmcnt(2)
    v_mfma_f32_32x32x16_bf16 v[16:31], v[64:67], a[100:103], v[16:31]
    v_mfma_f32_32x32x16_bf16 v[32:47], v[64:67], a[212:215], v[32:47]
    s_waitcnt lgkmcnt(1)
    v_mfma_f32_32x32x16_bf16 v[16:31], v[68:71], a[104:107], v[16:31]
    v_mfma_f32_32x32x16_bf16 v[32:47], v[68:71], a[216:219], v[32:47]
    s_waitcnt lgkmcnt(0)
    v_mfma_f32_32x32x16_bf16 v[16:31], v[72:75], a[108:111], v[16:31]
    v_mfma_f32_32x32x16_bf16 v[32:47], v[72:75], a[220:223], v[32:47]
mega_kernel_ge72:
    s_nop 15
    s_nop 1
    v_cvt_pk_bf16_f32 v96, v16, v17
    v_cvt_pk_bf16_f32 v97, v18, v19
    v_cvt_pk_bf16_f32 v98, v20, v21
    v_cvt_pk_bf16_f32 v99, v22, v23
    v_cvt_pk_bf16_f32 v100, v24, v25
    v_cvt_pk_bf16_f32 v101, v26, v27
    v_cvt_pk_bf16_f32 v102, v28, v29
    v_cvt_pk_bf16_f32 v103, v30, v31
    buffer_store_dwordx4 v[96:99], v5, s[44:47], s22 offen offset:0 sc1
    buffer_store_dwordx4 v[100:103], v5, s[44:47], s22 offen offset:1024 sc1
    v_cvt_pk_bf16_f32 v104, v32, v33
    v_cvt_pk_bf16_f32 v105, v34, v35
    v_cvt_pk_bf16_f32 v106, v36, v37
    v_cvt_pk_bf16_f32 v107, v38, v39
    v_cvt_pk_bf16_f32 v108, v40, v41
    v_cvt_pk_bf16_f32 v109, v42, v43
    v_cvt_pk_bf16_f32 v110, v44, v45
    v_cvt_pk_bf16_f32 v111, v46, v47
    buffer_store_dwordx4 v[104:107], v5, s[44:47], s22 offen offset:2048 sc1
    buffer_store_dwordx4 v[108:111], v5, s[44:47], s22 offen offset:3072 sc1
    s_add_u32 s22, s22, s23
    s_add_u32 s20, s20, 1
    s_cmp_lt_u32 s20, 64
    s_cbranch_scc1 mega_kernel_gl70
    s_sub_u32 s20, s20, 1
    s_waitcnt vmcnt(0)
    s_barrier
    s_cmp_lg_u32 s3, 0
    s_cbranch_scc1 mega_kernel_sf82
    s_lshl_b32 s37, s20, 8
    s_lshl_b32 s33, s31, 14
    s_add_u32 s37, s37, s33
    s_lshl_b32 s33, s15, 2
    s_add_u32 s37, s37, s33
    s_add_u32 s37, s37, 200937472
    s_mov_b64 s[34:35], exec
    s_mov_b64 exec, 1
    v_mov_b32 v8, 1
    v_mov_b32 v9, 0
    buffer_store_dword v8, v9, s[44:47], s37 offen sc1
    s_mov_b64 exec, s[34:35]
mega_kernel_sf82:
    s_branch mega_kernel_done
mega_kernel_g263:
    s_sub_u32 s15, s15, 60
    s_lshl_b32 s16, s15, 3
    s_lshl_b32 s17, s3, 1
    s_add_u32 s16, s16, s17
    s_mul_i32 s17, s16, 28672
    s_add_u32 s17, s17, 25690112
    s_add_u32 s18, s17, 28672
    v_mul_u32_u24 v61, 1792, v3
    v_lshl_add_u32 v61, v2, 3, v61
    v_mov_b32 v4, v5
    buffer_load_dwordx4 a[0:3], v4, s[44:47], s17 offen offset:0
    buffer_load_dwordx4 a[4:7], v4, s[44:47], s17 offen offset:1024
    buffer_load_dwordx4 a[8:11], v4, s[44:47], s17 offen offset:2048
    buffer_load_dwordx4 a[12:15], v4, s[44:47], s17 offen offset:3072
    v_add_u32 v4, 4096, v4
    buffer_load_dwordx4 a[16:19], v4, s[44:47], s17 offen offset:0
    buffer_load_dwordx4 a[20:23], v4, s[44:47], s17 offen offset:1024
    buffer_load_dwordx4 a[24:27], v4, s[44:47], s17 offen offset:2048
    buffer_load_dwordx4 a[28:31], v4, s[44:47], s17 offen offset:3072
    v_add_u32 v4, 4096, v4
    buffer_load_dwordx4 a[32:35], v4, s[44:47], s17 offen offset:0
    buffer_load_dwordx4 a[36:39], v4, s[44:47], s17 offen offset:1024
    buffer_load_dwordx4 a[40:43], v4, s[44:47], s17 offen offset:2048
    buffer_load_dwordx4 a[44:47], v4, s[44:47], s17 offen offset:3072
    v_add_u32 v4, 4096, v4
    buffer_load_dwordx4 a[48:51], v4, s[44:47], s17 offen offset:0
    buffer_load_dwordx4 a[52:55], v4, s[44:47], s17 offen offset:1024
    buffer_load_dwordx4 a[56:59], v4, s[44:47], s17 offen offset:2048
    buffer_load_dwordx4 a[60:63], v4, s[44:47], s17 offen offset:3072
    v_add_u32 v4, 4096, v4
    buffer_load_dwordx4 a[64:67], v4, s[44:47], s17 offen offset:0
    buffer_load_dwordx4 a[68:71], v4, s[44:47], s17 offen offset:1024
    buffer_load_dwordx4 a[72:75], v4, s[44:47], s17 offen offset:2048
    buffer_load_dwordx4 a[76:79], v4, s[44:47], s17 offen offset:3072
    v_add_u32 v4, 4096, v4
    buffer_load_dwordx4 a[80:83], v4, s[44:47], s17 offen offset:0
    buffer_load_dwordx4 a[84:87], v4, s[44:47], s17 offen offset:1024
    buffer_load_dwordx4 a[88:91], v4, s[44:47], s17 offen offset:2048
    buffer_load_dwordx4 a[92:95], v4, s[44:47], s17 offen offset:3072
    v_add_u32 v4, 4096, v4
    buffer_load_dwordx4 a[96:99], v4, s[44:47], s17 offen offset:0
    buffer_load_dwordx4 a[100:103], v4, s[44:47], s17 offen offset:1024
    buffer_load_dwordx4 a[104:107], v4, s[44:47], s17 offen offset:2048
    buffer_load_dwordx4 a[108:111], v4, s[44:47], s17 offen offset:3072
    v_mov_b32 v4, v5
    buffer_load_dwordx4 a[112:115], v4, s[44:47], s18 offen offset:0
    buffer_load_dwordx4 a[116:119], v4, s[44:47], s18 offen offset:1024
    buffer_load_dwordx4 a[120:123], v4, s[44:47], s18 offen offset:2048
    buffer_load_dwordx4 a[124:127], v4, s[44:47], s18 offen offset:3072
    v_add_u32 v4, 4096, v4
    buffer_load_dwordx4 a[128:131], v4, s[44:47], s18 offen offset:0
    buffer_load_dwordx4 a[132:135], v4, s[44:47], s18 offen offset:1024
    buffer_load_dwordx4 a[136:139], v4, s[44:47], s18 offen offset:2048
    buffer_load_dwordx4 a[140:143], v4, s[44:47], s18 offen offset:3072
    v_add_u32 v4, 4096, v4
    buffer_load_dwordx4 a[144:147], v4, s[44:47], s18 offen offset:0
    buffer_load_dwordx4 a[148:151], v4, s[44:47], s18 offen offset:1024
    buffer_load_dwordx4 a[152:155], v4, s[44:47], s18 offen offset:2048
    buffer_load_dwordx4 a[156:159], v4, s[44:47], s18 offen offset:3072
    v_add_u32 v4, 4096, v4
    buffer_load_dwordx4 a[160:163], v4, s[44:47], s18 offen offset:0
    buffer_load_dwordx4 a[164:167], v4, s[44:47], s18 offen offset:1024
    buffer_load_dwordx4 a[168:171], v4, s[44:47], s18 offen offset:2048
    buffer_load_dwordx4 a[172:175], v4, s[44:47], s18 offen offset:3072
    v_add_u32 v4, 4096, v4
    buffer_load_dwordx4 a[176:179], v4, s[44:47], s18 offen offset:0
    buffer_load_dwordx4 a[180:183], v4, s[44:47], s18 offen offset:1024
    buffer_load_dwordx4 a[184:187], v4, s[44:47], s18 offen offset:2048
    buffer_load_dwordx4 a[188:191], v4, s[44:47], s18 offen offset:3072
    v_add_u32 v4, 4096, v4
    buffer_load_dwordx4 a[192:195], v4, s[44:47], s18 offen offset:0
    buffer_load_dwordx4 a[196:199], v4, s[44:47], s18 offen offset:1024
    buffer_load_dwordx4 a[200:203], v4, s[44:47], s18 offen offset:2048
    buffer_load_dwordx4 a[204:207], v4, s[44:47], s18 offen offset:3072
    v_add_u32 v4, 4096, v4
    buffer_load_dwordx4 a[208:211], v4, s[44:47], s18 offen offset:0
    buffer_load_dwordx4 a[212:215], v4, s[44:47], s18 offen offset:1024
    buffer_load_dwordx4 a[216:219], v4, s[44:47], s18 offen offset:2048
    buffer_load_dwordx4 a[220:223], v4, s[44:47], s18 offen offset:3072
    s_lshl_b32 s26, s31, 1
    s_add_u32 s26, s26, 0
    s_mul_i32 s27, s26, 229376
    s_add_u32 s27, s27, 7340032
    s_mul_i32 s26, s26, 1835008
    s_add_u32 s26, s26, 0
    s_cmp_ge_u32 s16, 32
    s_cbranch_scc1 mega_kernel_vo83
    s_mul_i32 s22, s31, 4194304
    s_add_u32 s22, s22, 27525120
    s_lshl_b32 s19, s16, 11
    s_add_u32 s22, s22, s19
    s_mov_b32 s23, 65536
    s_mov_b32 s24, 0
    s_branch mega_kernel_set84
mega_kernel_vo83:
    s_mul_i32 s22, s31, 2097152
    s_add_u32 s22, s22, 35913728
    s_sub_u32 s19, s16, 32
    s_lshl_b32 s19, s19, 11
    s_add_u32 s22, s22, s19
    s_mov_b32 s23, 32768
    s_mov_b32 s24, 1
mega_kernel_set84:
    s_mov_b32 s20, 0
    s_waitcnt vmcnt(0)
mega_kernel_gl85:
    s_cmp_lg_u32 s96, 0
    s_cbranch_scc1 mega_kernel_pf89
    s_lshl_b32 s37, s20, 8
    s_lshl_b32 s33, s31, 14
    s_add_u32 s37, s37, s33
    s_add_u32 s37, s37, 200806400
    v_lshlrev_b32 v9, 2, v62
    v_cmp_gt_u32 s[38:39], 4, v62
    s_mov_b32 s12, 0
    buffer_load_dword v8, v9, s[44:47], s37 offen sc1
    s_waitcnt vmcnt(0)
    s_cmp_eq_u32 s95, 0
    s_cbranch_scc1 mega_kernel_f195
    s_barrier
    s_cmp_lg_u32 s3, 0
    s_cbranch_scc1 mega_kernel_f195
    s_sub_u32 s32, s20, 1
    s_lshl_b32 s32, s32, 8
    s_add_u32 s32, s32, s33
    s_lshl_b32 s33, s15, 2
    s_add_u32 s32, s32, s33
    s_add_u32 s32, s32, 200839168
    s_mov_b64 s[34:35], exec
    s_mov_b64 exec, 1
    v_mov_b32 v10, 1
    v_mov_b32 v11, 0
    buffer_store_dword v10, v11, s[44:47], s32 offen sc1
    s_mov_b64 exec, s[34:35]
mega_kernel_f195:
    s_mov_b32 s95, 1
    s_cmp_eq_u32 s31, 0
    s_cbranch_scc1 mega_kernel_fo94
    s_branch mega_kernel_f296
mega_kernel_fp93:
    s_sleep 1
    buffer_load_dword v8, v9, s[44:47], s37 offen sc1
    s_waitcnt vmcnt(0)
mega_kernel_f296:
    v_cmp_eq_u32 vcc, 0, v8
    s_and_b64 s[40:41], vcc, s[38:39]
    s_cbranch_scc0 mega_kernel_fo94
    s_add_u32 s12, s12, 1
    s_cmp_lt_u32 s12, 2000000
    s_cbranch_scc1 mega_kernel_fp93
mega_kernel_fo94:
    s_mul_i32 s6, s20, 28672
    s_add_u32 s6, s6, s26
    s_mul_i32 s7, s3, 7168
    s_add_u32 s6, s6, s7
    s_mul_i32 s8, s20, 3584
    s_add_u32 s8, s8, s27
    v_add_u32 v4, 4096, v5
    buffer_load_dwordx4 v[128:131], v5, s[44:47], s6 offen offset:0 sc1
    buffer_load_dwordx4 v[132:135], v5, s[44:47], s6 offen offset:1024 sc1
    buffer_load_dwordx4 v[136:139], v5, s[44:47], s6 offen offset:2048 sc1
    buffer_load_dwordx4 v[140:143], v5, s[44:47], s6 offen offset:3072 sc1
    buffer_load_dwordx4 v[144:147], v4, s[44:47], s6 offen offset:0 sc1
    buffer_load_dwordx4 v[148:151], v4, s[44:47], s6 offen offset:1024 sc1
    buffer_load_dwordx4 v[152:155], v4, s[44:47], s6 offen offset:2048 sc1
    buffer_load_dwordx2 v[160:161], v61, s[44:47], s8 offen offset:0 sc1
    buffer_load_dwordx2 v[162:163], v61, s[44:47], s8 offen offset:256 sc1
    buffer_load_dwordx2 v[164:165], v61, s[44:47], s8 offen offset:512 sc1
    buffer_load_dwordx2 v[166:167], v61, s[44:47], s8 offen offset:768 sc1
    buffer_load_dwordx2 v[168:169], v61, s[44:47], s8 offen offset:1024 sc1
    buffer_load_dwordx2 v[170:171], v61, s[44:47], s8 offen offset:1280 sc1
    buffer_load_dwordx2 v[172:173], v61, s[44:47], s8 offen offset:1536 sc1
    s_add_u32 s37, s20, 1
    s_lshl_b32 s37, s37, 8
    s_lshl_b32 s33, s31, 14
    s_add_u32 s37, s37, s33
    s_add_u32 s37, s37, 200806400
    v_lshlrev_b32 v13, 2, v62
    buffer_load_dword v12, v13, s[44:47], s37 offen sc1
    s_waitcnt vmcnt(0)
    s_branch mega_kernel_go90
mega_kernel_pf89:
    s_add_u32 s37, s20, 1
    s_lshl_b32 s37, s37, 8
    s_lshl_b32 s33, s31, 14
    s_add_u32 s37, s37, s33
    s_add_u32 s37, s37, 200806400
    v_lshlrev_b32 v13, 2, v62
    buffer_load_dword v12, v13, s[44:47], s37 offen sc1
    s_waitcnt vmcnt(0)
    s_barrier
    s_cmp_lg_u32 s3, 0
    s_cbranch_scc1 mega_kernel_sg92
    s_sub_u32 s32, s20, 1
    s_lshl_b32 s32, s32, 8
    s_lshl_b32 s33, s31, 14
    s_add_u32 s32, s32, s33
    s_lshl_b32 s33, s15, 2
    s_add_u32 s32, s32, s33
    s_add_u32 s32, s32, 200839168
    s_mov_b64 s[34:35], exec
    s_mov_b64 exec, 1
    v_mov_b32 v10, 1
    v_mov_b32 v11, 0
    buffer_store_dword v10, v11, s[44:47], s32 offen sc1
    s_mov_b64 exec, s[34:35]
mega_kernel_sg92:
mega_kernel_go90:
    v_add_f32 v160, v160, v162
    v_add_f32 v161, v161, v163
    v_add_f32 v160, v160, v164
    v_add_f32 v161, v161, v165
    v_add_f32 v160, v160, v166
    v_add_f32 v161, v161, v167
    v_add_f32 v160, v160, v168
    v_add_f32 v161, v161, v169
    v_add_f32 v160, v160, v170
    v_add_f32 v161, v161, v171
    v_add_f32 v160, v160, v172
    v_add_f32 v161, v161, v173
    v_mov_b32 v162, v160
    v_mov_b32 v163, v161
    s_nop 1
    v_permlane32_swap_b32 v160, v162
    v_permlane32_swap_b32 v161, v163
    s_nop 1
    v_add_f32 v160, v160, v162
    v_add_f32 v161, v161, v163
    v_mul_f32 v160, 0x3b124925, v160
    v_mul_f32 v161, 0x3b124925, v161
    v_fma_f32 v161, -v160, v160, v161
    v_max_f32 v161, 0, v161
    v_add_f32 v161, 0x3727c5ac, v161
    v_rsq_f32 v161, v161
    s_nop 0
    v_mul_f32 v160, v160, v161
    v_lshlrev_b32 v164, 16, v128
    v_and_b32 v165, 0xffff0000, v128
    v_fma_f32 v164, v164, v161, -v160
    v_fma_f32 v165, v165, v161, -v160
    v_cvt_pk_bf16_f32 v64, v164, v165
    v_lshlrev_b32 v164, 16, v129
    v_and_b32 v165, 0xffff0000, v129
    v_fma_f32 v164, v164, v161, -v160
    v_fma_f32 v165, v165, v161, -v160
    v_cvt_pk_bf16_f32 v65, v164, v165
    v_lshlrev_b32 v164, 16, v130
    v_and_b32 v165, 0xffff0000, v130
    v_fma_f32 v164, v164, v161, -v160
    v_fma_f32 v165, v165, v161, -v160
    v_cvt_pk_bf16_f32 v66, v164, v165
    v_lshlrev_b32 v164, 16, v131
    v_and_b32 v165, 0xffff0000, v131
    v_fma_f32 v164, v164, v161, -v160
    v_fma_f32 v165, v165, v161, -v160
    v_cvt_pk_bf16_f32 v67, v164, v165
    v_lshlrev_b32 v164, 16, v132
    v_and_b32 v165, 0xffff0000, v132
    v_fma_f32 v164, v164, v161, -v160
    v_fma_f32 v165, v165, v161, -v160
    v_cvt_pk_bf16_f32 v68, v164, v165
    v_lshlrev_b32 v164, 16, v133
    v_and_b32 v165, 0xffff0000, v133
    v_fma_f32 v164, v164, v161, -v160
    v_fma_f32 v165, v165, v161, -v160
    v_cvt_pk_bf16_f32 v69, v164, v165
    v_lshlrev_b32 v164, 16, v134
    v_and_b32 v165, 0xffff0000, v134
    v_fma_f32 v164, v164, v161, -v160
    v_fma_f32 v165, v165, v161, -v160
    v_cvt_pk_bf16_f32 v70, v164, v165
    v_lshlrev_b32 v164, 16, v135
    v_and_b32 v165, 0xffff0000, v135
    v_fma_f32 v164, v164, v161, -v160
    v_fma_f32 v165, v165, v161, -v160
    v_cvt_pk_bf16_f32 v71, v164, v165
    v_lshlrev_b32 v164, 16, v136
    v_and_b32 v165, 0xffff0000, v136
    v_fma_f32 v164, v164, v161, -v160
    v_fma_f32 v165, v165, v161, -v160
    v_cvt_pk_bf16_f32 v72, v164, v165
    v_lshlrev_b32 v164, 16, v137
    v_and_b32 v165, 0xffff0000, v137
    v_fma_f32 v164, v164, v161, -v160
    v_fma_f32 v165, v165, v161, -v160
    v_cvt_pk_bf16_f32 v73, v164, v165
    v_lshlrev_b32 v164, 16, v138
    v_and_b32 v165, 0xffff0000, v138
    v_fma_f32 v164, v164, v161, -v160
    v_fma_f32 v165, v165, v161, -v160
    v_cvt_pk_bf16_f32 v74, v164, v165
    v_lshlrev_b32 v164, 16, v139
    v_and_b32 v165, 0xffff0000, v139
    v_fma_f32 v164, v164, v161, -v160
    v_fma_f32 v165, v165, v161, -v160
    v_cvt_pk_bf16_f32 v75, v164, v165
    v_lshlrev_b32 v164, 16, v140
    v_and_b32 v165, 0xffff0000, v140
    v_fma_f32 v164, v164, v161, -v160
    v_fma_f32 v165, v165, v161, -v160
    v_cvt_pk_bf16_f32 v76, v164, v165
    v_lshlrev_b32 v164, 16, v141
    v_and_b32 v165, 0xffff0000, v141
    v_fma_f32 v164, v164, v161, -v160
    v_fma_f32 v165, v165, v161, -v160
    v_cvt_pk_bf16_f32 v77, v164, v165
    v_lshlrev_b32 v164, 16, v142
    v_and_b32 v165, 0xffff0000, v142
    v_fma_f32 v164, v164, v161, -v160
    v_fma_f32 v165, v165, v161, -v160
    v_cvt_pk_bf16_f32 v78, v164, v165
    v_lshlrev_b32 v164, 16, v143
    v_and_b32 v165, 0xffff0000, v143
    v_fma_f32 v164, v164, v161, -v160
    v_fma_f32 v165, v165, v161, -v160
    v_cvt_pk_bf16_f32 v79, v164, v165
    v_lshlrev_b32 v164, 16, v144
    v_and_b32 v165, 0xffff0000, v144
    v_fma_f32 v164, v164, v161, -v160
    v_fma_f32 v165, v165, v161, -v160
    v_cvt_pk_bf16_f32 v80, v164, v165
    v_lshlrev_b32 v164, 16, v145
    v_and_b32 v165, 0xffff0000, v145
    v_fma_f32 v164, v164, v161, -v160
    v_fma_f32 v165, v165, v161, -v160
    v_cvt_pk_bf16_f32 v81, v164, v165
    v_lshlrev_b32 v164, 16, v146
    v_and_b32 v165, 0xffff0000, v146
    v_fma_f32 v164, v164, v161, -v160
    v_fma_f32 v165, v165, v161, -v160
    v_cvt_pk_bf16_f32 v82, v164, v165
    v_lshlrev_b32 v164, 16, v147
    v_and_b32 v165, 0xffff0000, v147
    v_fma_f32 v164, v164, v161, -v160
    v_fma_f32 v165, v165, v161, -v160
    v_cvt_pk_bf16_f32 v83, v164, v165
    v_lshlrev_b32 v164, 16, v148
    v_and_b32 v165, 0xffff0000, v148
    v_fma_f32 v164, v164, v161, -v160
    v_fma_f32 v165, v165, v161, -v160
    v_cvt_pk_bf16_f32 v84, v164, v165
    v_lshlrev_b32 v164, 16, v149
    v_and_b32 v165, 0xffff0000, v149
    v_fma_f32 v164, v164, v161, -v160
    v_fma_f32 v165, v165, v161, -v160
    v_cvt_pk_bf16_f32 v85, v164, v165
    v_lshlrev_b32 v164, 16, v150
    v_and_b32 v165, 0xffff0000, v150
    v_fma_f32 v164, v164, v161, -v160
    v_fma_f32 v165, v165, v161, -v160
    v_cvt_pk_bf16_f32 v86, v164, v165
    v_lshlrev_b32 v164, 16, v151
    v_and_b32 v165, 0xffff0000, v151
    v_fma_f32 v164, v164, v161, -v160
    v_fma_f32 v165, v165, v161, -v160
    v_cvt_pk_bf16_f32 v87, v164, v165
    v_lshlrev_b32 v164, 16, v152
    v_and_b32 v165, 0xffff0000, v152
    v_fma_f32 v164, v164, v161, -v160
    v_fma_f32 v165, v165, v161, -v160
    v_cvt_pk_bf16_f32 v88, v164, v165
    v_lshlrev_b32 v164, 16, v153
    v_and_b32 v165, 0xffff0000, v153
    v_fma_f32 v164, v164, v161, -v160
    v_fma_f32 v165, v165, v161, -v160
    v_cvt_pk_bf16_f32 v89, v164, v165
    v_lshlrev_b32 v164, 16, v154
    v_and_b32 v165, 0xffff0000, v154
    v_fma_f32 v164, v164, v161, -v160
    v_fma_f32 v165, v165, v161, -v160
    v_cvt_pk_bf16_f32 v90, v164, v165
    v_lshlrev_b32 v164, 16, v155
    v_and_b32 v165, 0xffff0000, v155
    v_fma_f32 v164, v164, v161, -v160
    v_fma_f32 v165, v165, v161, -v160
    v_cvt_pk_bf16_f32 v91, v164, v165
    s_mul_i32 s7, s3, 7168
    v_add_u32 v4, s7, v5
    ds_write_b128 v4, v[64:67] offset:0
    ds_write_b128 v4, v[68:71] offset:1024
    ds_write_b128 v4, v[72:75] offset:2048
    ds_write_b128 v4, v[76:79] offset:3072
    ds_write_b128 v4, v[80:83] offset:4096
    ds_write_b128 v4, v[84:87] offset:5120
    ds_write_b128 v4, v[88:91] offset:6144
    s_mov_b32 s96, 0
    s_cmp_ge_u32 s20, 63
    s_cbranch_scc1 mega_kernel_np91
    v_cmp_gt_u32 s[38:39], 4, v62
    v_cmp_eq_u32 vcc, 0, v12
    s_and_b64 s[40:41], vcc, s[38:39]
    s_cselect_b32 s19, 1, 0
    s_and_b32 s19, s19, s31
    s_cmp_lg_u32 s19, 0
    s_cbranch_scc1 mega_kernel_np91
    s_mov_b32 s96, 1
    s_add_u32 s19, s20, 1
    s_mul_i32 s6, s19, 28672
    s_add_u32 s6, s6, s26
    s_mul_i32 s7, s3, 7168
    s_add_u32 s6, s6, s7
    s_mul_i32 s8, s19, 3584
    s_add_u32 s8, s8, s27
    v_add_u32 v4, 4096, v5
    buffer_load_dwordx4 v[128:131], v5, s[44:47], s6 offen offset:0 sc1
    buffer_load_dwordx4 v[132:135], v5, s[44:47], s6 offen offset:1024 sc1
    buffer_load_dwordx4 v[136:139], v5, s[44:47], s6 offen offset:2048 sc1
    buffer_load_dwordx4 v[140:143], v5, s[44:47], s6 offen offset:3072 sc1
    buffer_load_dwordx4 v[144:147], v4, s[44:47], s6 offen offset:0 sc1
    buffer_load_dwordx4 v[148:151], v4, s[44:47], s6 offen offset:1024 sc1
    buffer_load_dwordx4 v[152:155], v4, s[44:47], s6 offen offset:2048 sc1
    buffer_load_dwordx2 v[160:161], v61, s[44:47], s8 offen offset:0 sc1
    buffer_load_dwordx2 v[162:163], v61, s[44:47], s8 offen offset:256 sc1
    buffer_load_dwordx2 v[164:165], v61, s[44:47], s8 offen offset:512 sc1
    buffer_load_dwordx2 v[166:167], v61, s[44:47], s8 offen offset:768 sc1
    buffer_load_dwordx2 v[168:169], v61, s[44:47], s8 offen offset:1024 sc1
    buffer_load_dwordx2 v[170:171], v61, s[44:47], s8 offen offset:1280 sc1
    buffer_load_dwordx2 v[172:173], v61, s[44:47], s8 offen offset:1536 sc1
mega_kernel_np91:
    s_waitcnt lgkmcnt(0)
    s_barrier
    s_cmp_lg_u32 s24, 0
    s_cbranch_scc1 mega_kernel_f186
    ds_read_b128 v[64:67], v5 offset:0
    ds_read_b128 v[68:71], v5 offset:1024
    ds_read_b128 v[72:75], v5 offset:2048
    ds_read_b128 v[76:79], v5 offset:3072
    s_waitcnt lgkmcnt(3)
    v_mfma_f32_32x32x16_bf16 v[16:31], a[0:3], v[64:67], 0
    ds_read_b128 v[80:83], v5 offset:4096
    v_mfma_f32_32x32x16_bf16 v[32:47], a[112:115], v[64:67], 0
    s_waitcnt lgkmcnt(3)
    v_mfma_f32_32x32x16_bf16 v[16:31], a[4:7], v[68:71], v[16:31]
    ds_read_b128 v[64:67], v5 offset:5120
    v_mfma_f32_32x32x16_bf16 v[32:47], a[116:119], v[68:71], v[32:47]
    s_waitcnt lgkmcnt(3)
    v_mfma_f32_32x32x16_bf16 v[16:31], a[8:11], v[72:75], v[16:31]
    ds_read_b128 v[68:71], v5 offset:6144
    v_mfma_f32_32x32x16_bf16 v[32:47], a[120:123], v[72:75], v[32:47]
    s_waitcnt lgkmcnt(3)
    v_mfma_f32_32x32x16_bf16 v[16:31], a[12:15], v[76:79], v[16:31]
    ds_read_b128 v[72:75], v5 offset:7168
    v_mfma_f32_32x32x16_bf16 v[32:47], a[124:127], v[76:79], v[32:47]
    s_waitcnt lgkmcnt(3)
    v_mfma_f32_32x32x16_bf16 v[16:31], a[16:19], v[80:83], v[16:31]
    ds_read_b128 v[76:79], v5 offset:8192
    v_mfma_f32_32x32x16_bf16 v[32:47], a[128:131], v[80:83], v[32:47]
    s_waitcnt lgkmcnt(3)
    v_mfma_f32_32x32x16_bf16 v[16:31], a[20:23], v[64:67], v[16:31]
    ds_read_b128 v[80:83], v5 offset:9216
    v_mfma_f32_32x32x16_bf16 v[32:47], a[132:135], v[64:67], v[32:47]
    s_waitcnt lgkmcnt(3)
    v_mfma_f32_32x32x16_bf16 v[16:31], a[24:27], v[68:71], v[16:31]
    ds_read_b128 v[64:67], v5 offset:10240
    v_mfma_f32_32x32x16_bf16 v[32:47], a[136:139], v[68:71], v[32:47]
    s_waitcnt lgkmcnt(3)
    v_mfma_f32_32x32x16_bf16 v[16:31], a[28:31], v[72:75], v[16:31]
    ds_read_b128 v[68:71], v5 offset:11264
    v_mfma_f32_32x32x16_bf16 v[32:47], a[140:143], v[72:75], v[32:47]
    s_waitcnt lgkmcnt(3)
    v_mfma_f32_32x32x16_bf16 v[16:31], a[32:35], v[76:79], v[16:31]
    ds_read_b128 v[72:75], v5 offset:12288
    v_mfma_f32_32x32x16_bf16 v[32:47], a[144:147], v[76:79], v[32:47]
    s_waitcnt lgkmcnt(3)
    v_mfma_f32_32x32x16_bf16 v[16:31], a[36:39], v[80:83], v[16:31]
    ds_read_b128 v[76:79], v5 offset:13312
    v_mfma_f32_32x32x16_bf16 v[32:47], a[148:151], v[80:83], v[32:47]
    s_waitcnt lgkmcnt(3)
    v_mfma_f32_32x32x16_bf16 v[16:31], a[40:43], v[64:67], v[16:31]
    ds_read_b128 v[80:83], v5 offset:14336
    v_mfma_f32_32x32x16_bf16 v[32:47], a[152:155], v[64:67], v[32:47]
    s_waitcnt lgkmcnt(3)
    v_mfma_f32_32x32x16_bf16 v[16:31], a[44:47], v[68:71], v[16:31]
    ds_read_b128 v[64:67], v5 offset:15360
    v_mfma_f32_32x32x16_bf16 v[32:47], a[156:159], v[68:71], v[32:47]
    s_waitcnt lgkmcnt(3)
    v_mfma_f32_32x32x16_bf16 v[16:31], a[48:51], v[72:75], v[16:31]
    ds_read_b128 v[68:71], v5 offset:16384
    v_mfma_f32_32x32x16_bf16 v[32:47], a[160:163], v[72:75], v[32:47]
    s_waitcnt lgkmcnt(3)
    v_mfma_f32_32x32x16_bf16 v[16:31], a[52:55], v[76:79], v[16:31]
    ds_read_b128 v[72:75], v5 offset:17408
    v_mfma_f32_32x32x16_bf16 v[32:47], a[164:167], v[76:79], v[32:47]
    s_waitcnt lgkmcnt(3)
    v_mfma_f32_32x32x16_bf16 v[16:31], a[56:59], v[80:83], v[16:31]
    ds_read_b128 v[76:79], v5 offset:18432
    v_mfma_f32_32x32x16_bf16 v[32:47], a[168:171], v[80:83], v[32:47]
    s_waitcnt lgkmcnt(3)
    v_mfma_f32_32x32x16_bf16 v[16:31], a[60:63], v[64:67], v[16:31]
    ds_read_b128 v[80:83], v5 offset:19456
    v_mfma_f32_32x32x16_bf16 v[32:47], a[172:175], v[64:67], v[32:47]
    s_waitcnt lgkmcnt(3)
    v_mfma_f32_32x32x16_bf16 v[16:31], a[64:67], v[68:71], v[16:31]
    ds_read_b128 v[64:67], v5 offset:20480
    v_mfma_f32_32x32x16_bf16 v[32:47], a[176:179], v[68:71], v[32:47]
    s_waitcnt lgkmcnt(3)
    v_mfma_f32_32x32x16_bf16 v[16:31], a[68:71], v[72:75], v[16:31]
    ds_read_b128 v[68:71], v5 offset:21504
    v_mfma_f32_32x32x16_bf16 v[32:47], a[180:183], v[72:75], v[32:47]
    s_waitcnt lgkmcnt(3)
    v_mfma_f32_32x32x16_bf16 v[16:31], a[72:75], v[76:79], v[16:31]
    ds_read_b128 v[72:75], v5 offset:22528
    v_mfma_f32_32x32x16_bf16 v[32:47], a[184:187], v[76:79], v[32:47]
    s_waitcnt lgkmcnt(3)
    v_mfma_f32_32x32x16_bf16 v[16:31], a[76:79], v[80:83], v[16:31]
    ds_read_b128 v[76:79], v5 offset:23552
    v_mfma_f32_32x32x16_bf16 v[32:47], a[188:191], v[80:83], v[32:47]
    s_waitcnt lgkmcnt(3)
    v_mfma_f32_32x32x16_bf16 v[16:31], a[80:83], v[64:67], v[16:31]
    ds_read_b128 v[80:83], v5 offset:24576
    v_mfma_f32_32x32x16_bf16 v[32:47], a[192:195], v[64:67], v[32:47]
    s_waitcnt lgkmcnt(3)
    v_mfma_f32_32x32x16_bf16 v[16:31], a[84:87], v[68:71], v[16:31]
    ds_read_b128 v[64:67], v5 offset:25600
    v_mfma_f32_32x32x16_bf16 v[32:47], a[196:199], v[68:71], v[32:47]
    s_waitcnt lgkmcnt(3)
    v_mfma_f32_32x32x16_bf16 v[16:31], a[88:91], v[72:75], v[16:31]
    ds_read_b128 v[68:71], v5 offset:26624
    v_mfma_f32_32x32x16_bf16 v[32:47], a[200:203], v[72:75], v[32:47]
    s_waitcnt lgkmcnt(3)
    v_mfma_f32_32x32x16_bf16 v[16:31], a[92:95], v[76:79], v[16:31]
    ds_read_b128 v[72:75], v5 offset:27648
    v_mfma_f32_32x32x16_bf16 v[32:47], a[204:207], v[76:79], v[32:47]
    s_waitcnt lgkmcnt(3)
    v_mfma_f32_32x32x16_bf16 v[16:31], a[96:99], v[80:83], v[16:31]
    v_mfma_f32_32x32x16_bf16 v[32:47], a[208:211], v[80:83], v[32:47]
    s_waitcnt lgkmcnt(2)
    v_mfma_f32_32x32x16_bf16 v[16:31], a[100:103], v[64:67], v[16:31]
    v_mfma_f32_32x32x16_bf16 v[32:47], a[212:215], v[64:67], v[32:47]
    s_waitcnt lgkmcnt(1)
    v_mfma_f32_32x32x16_bf16 v[16:31], a[104:107], v[68:71], v[16:31]
    v_mfma_f32_32x32x16_bf16 v[32:47], a[216:219], v[68:71], v[32:47]
    s_waitcnt lgkmcnt(0)
    v_mfma_f32_32x32x16_bf16 v[16:31], a[108:111], v[72:75], v[16:31]
    v_mfma_f32_32x32x16_bf16 v[32:47], a[220:223], v[72:75], v[32:47]
    s_branch mega_kernel_ge87
mega_kernel_f186:
    ds_read_b128 v[64:67], v5 offset:0
    ds_read_b128 v[68:71], v5 offset:1024
    ds_read_b128 v[72:75], v5 offset:2048
    ds_read_b128 v[76:79], v5 offset:3072
    s_waitcnt lgkmcnt(3)
    v_mfma_f32_32x32x16_bf16 v[16:31], v[64:67], a[0:3], 0
    ds_read_b128 v[80:83], v5 offset:4096
    v_mfma_f32_32x32x16_bf16 v[32:47], v[64:67], a[112:115], 0
    s_waitcnt lgkmcnt(3)
    v_mfma_f32_32x32x16_bf16 v[16:31], v[68:71], a[4:7], v[16:31]
    ds_read_b128 v[64:67], v5 offset:5120
    v_mfma_f32_32x32x16_bf16 v[32:47], v[68:71], a[116:119], v[32:47]
    s_waitcnt lgkmcnt(3)
    v_mfma_f32_32x32x16_bf16 v[16:31], v[72:75], a[8:11], v[16:31]
    ds_read_b128 v[68:71], v5 offset:6144
    v_mfma_f32_32x32x16_bf16 v[32:47], v[72:75], a[120:123], v[32:47]
    s_waitcnt lgkmcnt(3)
    v_mfma_f32_32x32x16_bf16 v[16:31], v[76:79], a[12:15], v[16:31]
    ds_read_b128 v[72:75], v5 offset:7168
    v_mfma_f32_32x32x16_bf16 v[32:47], v[76:79], a[124:127], v[32:47]
    s_waitcnt lgkmcnt(3)
    v_mfma_f32_32x32x16_bf16 v[16:31], v[80:83], a[16:19], v[16:31]
    ds_read_b128 v[76:79], v5 offset:8192
    v_mfma_f32_32x32x16_bf16 v[32:47], v[80:83], a[128:131], v[32:47]
    s_waitcnt lgkmcnt(3)
    v_mfma_f32_32x32x16_bf16 v[16:31], v[64:67], a[20:23], v[16:31]
    ds_read_b128 v[80:83], v5 offset:9216
    v_mfma_f32_32x32x16_bf16 v[32:47], v[64:67], a[132:135], v[32:47]
    s_waitcnt lgkmcnt(3)
    v_mfma_f32_32x32x16_bf16 v[16:31], v[68:71], a[24:27], v[16:31]
    ds_read_b128 v[64:67], v5 offset:10240
    v_mfma_f32_32x32x16_bf16 v[32:47], v[68:71], a[136:139], v[32:47]
    s_waitcnt lgkmcnt(3)
    v_mfma_f32_32x32x16_bf16 v[16:31], v[72:75], a[28:31], v[16:31]
    ds_read_b128 v[68:71], v5 offset:11264
    v_mfma_f32_32x32x16_bf16 v[32:47], v[72:75], a[140:143], v[32:47]
    s_waitcnt lgkmcnt(3)
    v_mfma_f32_32x32x16_bf16 v[16:31], v[76:79], a[32:35], v[16:31]
    ds_read_b128 v[72:75], v5 offset:12288
    v_mfma_f32_32x32x16_bf16 v[32:47], v[76:79], a[144:147], v[32:47]
    s_waitcnt lgkmcnt(3)
    v_mfma_f32_32x32x16_bf16 v[16:31], v[80:83], a[36:39], v[16:31]
    ds_read_b128 v[76:79], v5 offset:13312
    v_mfma_f32_32x32x16_bf16 v[32:47], v[80:83], a[148:151], v[32:47]
    s_waitcnt lgkmcnt(3)
    v_mfma_f32_32x32x16_bf16 v[16:31], v[64:67], a[40:43], v[16:31]
    ds_read_b128 v[80:83], v5 offset:14336
    v_mfma_f32_32x32x16_bf16 v[32:47], v[64:67], a[152:155], v[32:47]
    s_waitcnt lgkmcnt(3)
    v_mfma_f32_32x32x16_bf16 v[16:31], v[68:71], a[44:47], v[16:31]
    ds_read_b128 v[64:67], v5 offset:15360
    v_mfma_f32_32x32x16_bf16 v[32:47], v[68:71], a[156:159], v[32:47]
    s_waitcnt lgkmcnt(3)
    v_mfma_f32_32x32x16_bf16 v[16:31], v[72:75], a[48:51], v[16:31]
    ds_read_b128 v[68:71], v5 offset:16384
    v_mfma_f32_32x32x16_bf16 v[32:47], v[72:75], a[160:163], v[32:47]
    s_waitcnt lgkmcnt(3)
    v_mfma_f32_32x32x16_bf16 v[16:31], v[76:79], a[52:55], v[16:31]
    ds_read_b128 v[72:75], v5 offset:17408
    v_mfma_f32_32x32x16_bf16 v[32:47], v[76:79], a[164:167], v[32:47]
    s_waitcnt lgkmcnt(3)
    v_mfma_f32_32x32x16_bf16 v[16:31], v[80:83], a[56:59], v[16:31]
    ds_read_b128 v[76:79], v5 offset:18432
    v_mfma_f32_32x32x16_bf16 v[32:47], v[80:83], a[168:171], v[32:47]
    s_waitcnt lgkmcnt(3)
    v_mfma_f32_32x32x16_bf16 v[16:31], v[64:67], a[60:63], v[16:31]
    ds_read_b128 v[80:83], v5 offset:19456
    v_mfma_f32_32x32x16_bf16 v[32:47], v[64:67], a[172:175], v[32:47]
    s_waitcnt lgkmcnt(3)
    v_mfma_f32_32x32x16_bf16 v[16:31], v[68:71], a[64:67], v[16:31]
    ds_read_b128 v[64:67], v5 offset:20480
    v_mfma_f32_32x32x16_bf16 v[32:47], v[68:71], a[176:179], v[32:47]
    s_waitcnt lgkmcnt(3)
    v_mfma_f32_32x32x16_bf16 v[16:31], v[72:75], a[68:71], v[16:31]
    ds_read_b128 v[68:71], v5 offset:21504
    v_mfma_f32_32x32x16_bf16 v[32:47], v[72:75], a[180:183], v[32:47]
    s_waitcnt lgkmcnt(3)
    v_mfma_f32_32x32x16_bf16 v[16:31], v[76:79], a[72:75], v[16:31]
    ds_read_b128 v[72:75], v5 offset:22528
    v_mfma_f32_32x32x16_bf16 v[32:47], v[76:79], a[184:187], v[32:47]
    s_waitcnt lgkmcnt(3)
    v_mfma_f32_32x32x16_bf16 v[16:31], v[80:83], a[76:79], v[16:31]
    ds_read_b128 v[76:79], v5 offset:23552
    v_mfma_f32_32x32x16_bf16 v[32:47], v[80:83], a[188:191], v[32:47]
    s_waitcnt lgkmcnt(3)
    v_mfma_f32_32x32x16_bf16 v[16:31], v[64:67], a[80:83], v[16:31]
    ds_read_b128 v[80:83], v5 offset:24576
    v_mfma_f32_32x32x16_bf16 v[32:47], v[64:67], a[192:195], v[32:47]
    s_waitcnt lgkmcnt(3)
    v_mfma_f32_32x32x16_bf16 v[16:31], v[68:71], a[84:87], v[16:31]
    ds_read_b128 v[64:67], v5 offset:25600
    v_mfma_f32_32x32x16_bf16 v[32:47], v[68:71], a[196:199], v[32:47]
    s_waitcnt lgkmcnt(3)
    v_mfma_f32_32x32x16_bf16 v[16:31], v[72:75], a[88:91], v[16:31]
    ds_read_b128 v[68:71], v5 offset:26624
    v_mfma_f32_32x32x16_bf16 v[32:47], v[72:75], a[200:203], v[32:47]
    s_waitcnt lgkmcnt(3)
    v_mfma_f32_32x32x16_bf16 v[16:31], v[76:79], a[92:95], v[16:31]
    ds_read_b128 v[72:75], v5 offset:27648
    v_mfma_f32_32x32x16_bf16 v[32:47], v[76:79], a[204:207], v[32:47]
    s_waitcnt lgkmcnt(3)
    v_mfma_f32_32x32x16_bf16 v[16:31], v[80:83], a[96:99], v[16:31]
    v_mfma_f32_32x32x16_bf16 v[32:47], v[80:83], a[208:211], v[32:47]
    s_waitcnt lgkmcnt(2)
    v_mfma_f32_32x32x16_bf16 v[16:31], v[64:67], a[100:103], v[16:31]
    v_mfma_f32_32x32x16_bf16 v[32:47], v[64:67], a[212:215], v[32:47]
    s_waitcnt lgkmcnt(1)
    v_mfma_f32_32x32x16_bf16 v[16:31], v[68:71], a[104:107], v[16:31]
    v_mfma_f32_32x32x16_bf16 v[32:47], v[68:71], a[216:219], v[32:47]
    s_waitcnt lgkmcnt(0)
    v_mfma_f32_32x32x16_bf16 v[16:31], v[72:75], a[108:111], v[16:31]
    v_mfma_f32_32x32x16_bf16 v[32:47], v[72:75], a[220:223], v[32:47]
mega_kernel_ge87:
    s_nop 15
    s_nop 1
    v_cvt_pk_bf16_f32 v96, v16, v17
    v_cvt_pk_bf16_f32 v97, v18, v19
    v_cvt_pk_bf16_f32 v98, v20, v21
    v_cvt_pk_bf16_f32 v99, v22, v23
    v_cvt_pk_bf16_f32 v100, v24, v25
    v_cvt_pk_bf16_f32 v101, v26, v27
    v_cvt_pk_bf16_f32 v102, v28, v29
    v_cvt_pk_bf16_f32 v103, v30, v31
    buffer_store_dwordx4 v[96:99], v5, s[44:47], s22 offen offset:0 sc1
    buffer_store_dwordx4 v[100:103], v5, s[44:47], s22 offen offset:1024 sc1
    v_cvt_pk_bf16_f32 v104, v32, v33
    v_cvt_pk_bf16_f32 v105, v34, v35
    v_cvt_pk_bf16_f32 v106, v36, v37
    v_cvt_pk_bf16_f32 v107, v38, v39
    v_cvt_pk_bf16_f32 v108, v40, v41
    v_cvt_pk_bf16_f32 v109, v42, v43
    v_cvt_pk_bf16_f32 v110, v44, v45
    v_cvt_pk_bf16_f32 v111, v46, v47
    buffer_store_dwordx4 v[104:107], v5, s[44:47], s22 offen offset:2048 sc1
    buffer_store_dwordx4 v[108:111], v5, s[44:47], s22 offen offset:3072 sc1
    s_add_u32 s22, s22, s23
    s_add_u32 s20, s20, 1
    s_cmp_lt_u32 s20, 64
    s_cbranch_scc1 mega_kernel_gl85
    s_sub_u32 s20, s20, 1
    s_waitcnt vmcnt(0)
    s_barrier
    s_cmp_lg_u32 s3, 0
    s_cbranch_scc1 mega_kernel_sf97
    s_lshl_b32 s37, s20, 8
    s_lshl_b32 s33, s31, 14
    s_add_u32 s37, s37, s33
    s_lshl_b32 s33, s15, 2
    s_add_u32 s37, s37, s33
    s_add_u32 s37, s37, 200839168
    s_mov_b64 s[34:35], exec
    s_mov_b64 exec, 1
    v_mov_b32 v8, 1
    v_mov_b32 v9, 0
    buffer_store_dword v8, v9, s[44:47], s37 offen sc1
    s_mov_b64 exec, s[34:35]
mega_kernel_sf97:
    s_branch mega_kernel_done
mega_kernel_t364:
    s_sub_u32 s15, s15, 66
    s_lshr_b32 s20, s15, 2
    s_and_b32 s15, s15, 3
    s_lshl_b32 s16, s15, 2
    s_add_u32 s16, s16, s3
    s_lshl_b32 s7, s16, 11
    s_mul_i32 s22, s31, 4194304
    s_add_u32 s22, s22, 27525120
    s_add_u32 s22, s22, s7
    s_mul_i32 s23, s31, 2097152
    s_add_u32 s24, s23, 40108032
    s_add_u32 s24, s24, s7
    s_add_u32 s23, s23, 35913728
    s_add_u32 s23, s23, s7
    v_lshlrev_b32 v6, 2, v3
    v_sub_u32 v6, v2, v6
    v_mov_b32 v7, 0xff800000
mega_kernel_tl98:
    s_lshl_b32 s6, s20, 16
    s_add_u32 s6, s6, s22
    s_add_u32 s8, s6, 32768
    s_lshl_b32 s9, s20, 15
    s_add_u32 s9, s9, s23
    s_cmp_eq_u32 s20, 0
    s_cbranch_scc1 mega_kernel_no99
    s_sub_u32 s19, s20, 1
    s_lshl_b32 s37, s19, 8
    s_lshl_b32 s33, s31, 14
    s_add_u32 s37, s37, s33
    s_add_u32 s37, s37, 200839168
    v_lshlrev_b32 v9, 2, v62
    v_cmp_gt_u32 s[38:39], 6, v62
    s_mov_b32 s12, 0
mega_kernel_fp100:
    buffer_load_dword v8, v9, s[44:47], s37 offen sc1
    s_waitcnt vmcnt(0)
    v_cmp_eq_u32 vcc, 0, v8
    s_and_b64 s[40:41], vcc, s[38:39]
    s_cbranch_scc0 mega_kernel_fo101
    s_sleep 1
    s_add_u32 s12, s12, 1
    s_cmp_lt_u32 s12, 2000000
    s_cbranch_scc1 mega_kernel_fp100
mega_kernel_fo101:
    s_cmp_lt_u32 s20, 8
    s_cbranch_scc1 mega_kernel_sk102
    s_sub_u32 s10, s8, 524288
    s_sub_u32 s11, s9, 262144
    buffer_load_dwordx4 a[0:3], v5, s[44:47], s10 offen sc1
    buffer_load_dwordx4 a[4:7], v5, s[44:47], s10 offen offset:1024 sc1
    buffer_load_dwordx4 a[72:75], v5, s[44:47], s11 offen sc1
    buffer_load_dwordx4 a[76:79], v5, s[44:47], s11 offen offset:1024 sc1
mega_kernel_sk102:
    s_cmp_lt_u32 s20, 7
    s_cbranch_scc1 mega_kernel_sk103
    s_sub_u32 s10, s8, 458752
    s_sub_u32 s11, s9, 229376
    buffer_load_dwordx4 a[8:11], v5, s[44:47], s10 offen sc1
    buffer_load_dwordx4 a[12:15], v5, s[44:47], s10 offen offset:1024 sc1
    buffer_load_dwordx4 a[80:83], v5, s[44:47], s11 offen sc1
    buffer_load_dwordx4 a[84:87], v5, s[44:47], s11 offen offset:1024 sc1
mega_kernel_sk103:
    s_cmp_lt_u32 s20, 6
    s_cbranch_scc1 mega_kernel_sk104
    s_sub_u32 s10, s8, 393216
    s_sub_u32 s11, s9, 196608
    buffer_load_dwordx4 a[16:19], v5, s[44:47], s10 offen sc1
    buffer_load_dwordx4 a[20:23], v5, s[44:47], s10 offen offset:1024 sc1
    buffer_load_dwordx4 a[88:91], v5, s[44:47], s11 offen sc1
    buffer_load_dwordx4 a[92:95], v5, s[44:47], s11 offen offset:1024 sc1
mega_kernel_sk104:
    s_cmp_lt_u32 s20, 5
    s_cbranch_scc1 mega_kernel_sk105
    s_sub_u32 s10, s8, 327680
    s_sub_u32 s11, s9, 163840
    buffer_load_dwordx4 a[24:27], v5, s[44:47], s10 offen sc1
    buffer_load_dwordx4 a[28:31], v5, s[44:47], s10 offen offset:1024 sc1
    buffer_load_dwordx4 a[96:99], v5, s[44:47], s11 offen sc1
    buffer_load_dwordx4 a[100:103], v5, s[44:47], s11 offen offset:1024 sc1
mega_kernel_sk105:
    s_cmp_lt_u32 s20, 4
    s_cbranch_scc1 mega_kernel_sk106
    s_sub_u32 s10, s8, 262144
    s_sub_u32 s11, s9, 131072
    buffer_load_dwordx4 a[32:35], v5, s[44:47], s10 offen sc1
    buffer_load_dwordx4 a[36:39], v5, s[44:47], s10 offen offset:1024 sc1
    buffer_load_dwordx4 a[104:107], v5, s[44:47], s11 offen sc1
    buffer_load_dwordx4 a[108:111], v5, s[44:47], s11 offen offset:1024 sc1
mega_kernel_sk106:
    s_cmp_lt_u32 s20, 3
    s_cbranch_scc1 mega_kernel_sk107
    s_sub_u32 s10, s8, 196608
    s_sub_u32 s11, s9, 98304
    buffer_load_dwordx4 a[40:43], v5, s[44:47], s10 offen sc1
    buffer_load_dwordx4 a[44:47], v5, s[44:47], s10 offen offset:1024 sc1
    buffer_load_dwordx4 a[112:115], v5, s[44:47], s11 offen sc1
    buffer_load_dwordx4 a[116:119], v5, s[44:47], s11 offen offset:1024 sc1
mega_kernel_sk107:
    s_cmp_lt_u32 s20, 2
    s_cbranch_scc1 mega_kernel_sk108
    s_sub_u32 s10, s8, 131072
    s_sub_u32 s11, s9, 65536
    buffer_load_dwordx4 a[48:51], v5, s[44:47], s10 offen sc1
    buffer_load_dwordx4 a[52:55], v5, s[44:47], s10 offen offset:1024 sc1
    buffer_load_dwordx4 a[120:123], v5, s[44:47], s11 offen sc1
    buffer_load_dwordx4 a[124:127], v5, s[44:47], s11 offen offset:1024 sc1
mega_kernel_sk108:
    s_cmp_lt_u32 s20, 1
    s_cbranch_scc1 mega_kernel_sk109
    s_sub_u32 s10, s8, 65536
    s_sub_u32 s11, s9, 32768
    buffer_load_dwordx4 a[56:59], v5, s[44:47], s10 offen sc1
    buffer_load_dwordx4 a[60:63], v5, s[44:47], s10 offen offset:1024 sc1
    buffer_load_dwordx4 a[128:131], v5, s[44:47], s11 offen sc1
    buffer_load_dwordx4 a[132:135], v5, s[44:47], s11 offen offset:1024 sc1
mega_kernel_sk109:
mega_kernel_no99:
    s_lshl_b32 s37, s20, 8
    s_lshl_b32 s33, s31, 14
    s_add_u32 s37, s37, s33
    s_add_u32 s37, s37, 200839168
    v_lshlrev_b32 v9, 2, v62
    v_cmp_gt_u32 s[38:39], 6, v62
    s_mov_b32 s12, 0
mega_kernel_fp110:
    buffer_load_dword v8, v9, s[44:47], s37 offen sc1
    s_waitcnt vmcnt(0)
    v_cmp_eq_u32 vcc, 0, v8
    s_and_b64 s[40:41], vcc, s[38:39]
    s_cbranch_scc0 mega_kernel_fo111
    s_sleep 1
    s_add_u32 s12, s12, 1
    s_cmp_lt_u32 s12, 2000000
    s_cbranch_scc1 mega_kernel_fp110
mega_kernel_fo111:
    buffer_load_dwordx4 v[8:11], v5, s[44:47], s6 offen sc1
    buffer_load_dwordx4 v[12:15], v5, s[44:47], s6 offen offset:1024 sc1
    s_cmp_lt_u32 s20, 0
    s_cbranch_scc1 mega_kernel_sk112
    s_sub_u32 s10, s8, 0
    s_sub_u32 s11, s9, 0
    buffer_load_dwordx4 a[64:67], v5, s[44:47], s10 offen sc1
    buffer_load_dwordx4 a[68:71], v5, s[44:47], s10 offen offset:1024 sc1
    buffer_load_dwordx4 a[136:139], v5, s[44:47], s11 offen sc1
    buffer_load_dwordx4 a[140:143], v5, s[44:47], s11 offen offset:1024 sc1
mega_kernel_sk112:
    v_mov_b32 v16, 0
    v_mov_b32 v17, 0
    v_mov_b32 v18, 0
    v_mov_b32 v19, 0
    v_mov_b32 v20, 0
    v_mov_b32 v21, 0
    v_mov_b32 v22, 0
    v_mov_b32 v23, 0
    v_mov_b32 v24, 0
    v_mov_b32 v25, 0
    v_mov_b32 v26, 0
    v_mov_b32 v27, 0
    v_mov_b32 v28, 0
    v_mov_b32 v29, 0
    v_mov_b32 v30, 0
    v_mov_b32 v31, 0
    s_waitcnt vmcnt(0)
    s_cmp_lt_u32 s20, 8
    s_cbranch_scc1 mega_kernel_s113
    v_mfma_f32_32x32x16_bf16 v[64:79], a[0:3], v[8:11], 0
    v_mfma_f32_32x32x16_bf16 v[64:79], a[4:7], v[12:15], v[64:79]
    s_branch mega_kernel_s2114
mega_kernel_s113:
    v_mov_b32 v64, v7
    v_mov_b32 v65, v7
    v_mov_b32 v66, v7
    v_mov_b32 v67, v7
    v_mov_b32 v68, v7
    v_mov_b32 v69, v7
    v_mov_b32 v70, v7
    v_mov_b32 v71, v7
    v_mov_b32 v72, v7
    v_mov_b32 v73, v7
    v_mov_b32 v74, v7
    v_mov_b32 v75, v7
    v_mov_b32 v76, v7
    v_mov_b32 v77, v7
    v_mov_b32 v78, v7
    v_mov_b32 v79, v7
mega_kernel_s2114:
    s_cmp_lt_u32 s20, 7
    s_cbranch_scc1 mega_kernel_s115
    v_mfma_f32_32x32x16_bf16 v[80:95], a[8:11], v[8:11], 0
    v_mfma_f32_32x32x16_bf16 v[80:95], a[12:15], v[12:15], v[80:95]
    s_branch mega_kernel_s2116
mega_kernel_s115:
    v_mov_b32 v80, v7
    v_mov_b32 v81, v7
    v_mov_b32 v82, v7
    v_mov_b32 v83, v7
    v_mov_b32 v84, v7
    v_mov_b32 v85, v7
    v_mov_b32 v86, v7
    v_mov_b32 v87, v7
    v_mov_b32 v88, v7
    v_mov_b32 v89, v7
    v_mov_b32 v90, v7
    v_mov_b32 v91, v7
    v_mov_b32 v92, v7
    v_mov_b32 v93, v7
    v_mov_b32 v94, v7
    v_mov_b32 v95, v7
mega_kernel_s2116:
    s_cmp_lt_u32 s20, 6
    s_cbranch_scc1 mega_kernel_s117
    v_mfma_f32_32x32x16_bf16 v[96:111], a[16:19], v[8:11], 0
    v_mfma_f32_32x32x16_bf16 v[96:111], a[20:23], v[12:15], v[96:111]
    s_branch mega_kernel_s2118
mega_kernel_s117:
    v_mov_b32 v96, v7
    v_mov_b32 v97, v7
    v_mov_b32 v98, v7
    v_mov_b32 v99, v7
    v_mov_b32 v100, v7
    v_mov_b32 v101, v7
    v_mov_b32 v102, v7
    v_mov_b32 v103, v7
    v_mov_b32 v104, v7
    v_mov_b32 v105, v7
    v_mov_b32 v106, v7
    v_mov_b32 v107, v7
    v_mov_b32 v108, v7
    v_mov_b32 v109, v7
    v_mov_b32 v110, v7
    v_mov_b32 v111, v7
mega_kernel_s2118:
    s_cmp_lt_u32 s20, 5
    s_cbranch_scc1 mega_kernel_s119
    v_mfma_f32_32x32x16_bf16 v[112:127], a[24:27], v[8:11], 0
    v_mfma_f32_32x32x16_bf16 v[112:127], a[28:31], v[12:15], v[112:127]
    s_branch mega_kernel_s2120
mega_kernel_s119:
    v_mov_b32 v112, v7
    v_mov_b32 v113, v7
    v_mov_b32 v114, v7
    v_mov_b32 v115, v7
    v_mov_b32 v116, v7
    v_mov_b32 v117, v7
    v_mov_b32 v118, v7
    v_mov_b32 v119, v7
    v_mov_b32 v120, v7
    v_mov_b32 v121, v7
    v_mov_b32 v122, v7
    v_mov_b32 v123, v7
    v_mov_b32 v124, v7
    v_mov_b32 v125, v7
    v_mov_b32 v126, v7
    v_mov_b32 v127, v7
mega_kernel_s2120:
    s_cmp_lt_u32 s20, 4
    s_cbranch_scc1 mega_kernel_s121
    v_mfma_f32_32x32x16_bf16 v[128:143], a[32:35], v[8:11], 0
    v_mfma_f32_32x32x16_bf16 v[128:143], a[36:39], v[12:15], v[128:143]
    s_branch mega_kernel_s2122
mega_kernel_s121:
    v_mov_b32 v128, v7
    v_mov_b32 v129, v7
    v_mov_b32 v130, v7
    v_mov_b32 v131, v7
    v_mov_b32 v132, v7
    v_mov_b32 v133, v7
    v_mov_b32 v134, v7
    v_mov_b32 v135, v7
    v_mov_b32 v136, v7
    v_mov_b32 v137, v7
    v_mov_b32 v138, v7
    v_mov_b32 v139, v7
    v_mov_b32 v140, v7
    v_mov_b32 v141, v7
    v_mov_b32 v142, v7
    v_mov_b32 v143, v7
mega_kernel_s2122:
    s_cmp_lt_u32 s20, 3
    s_cbranch_scc1 mega_kernel_s123
    v_mfma_f32_32x32x16_bf16 v[144:159], a[40:43], v[8:11], 0
    v_mfma_f32_32x32x16_bf16 v[144:159], a[44:47], v[12:15], v[144:159]
    s_branch mega_kernel_s2124
mega_kernel_s123:
    v_mov_b32 v144, v7
    v_mov_b32 v145, v7
    v_mov_b32 v146, v7
    v_mov_b32 v147, v7
    v_mov_b32 v148, v7
    v_mov_b32 v149, v7
    v_mov_b32 v150, v7
    v_mov_b32 v151, v7
    v_mov_b32 v152, v7
    v_mov_b32 v153, v7
    v_mov_b32 v154, v7
    v_mov_b32 v155, v7
    v_mov_b32 v156, v7
    v_mov_b32 v157, v7
    v_mov_b32 v158, v7
    v_mov_b32 v159, v7
mega_kernel_s2124:
    s_cmp_lt_u32 s20, 2
    s_cbranch_scc1 mega_kernel_s125
    v_mfma_f32_32x32x16_bf16 v[160:175], a[48:51], v[8:11], 0
    v_mfma_f32_32x32x16_bf16 v[160:175], a[52:55], v[12:15], v[160:175]
    s_branch mega_kernel_s2126
mega_kernel_s125:
    v_mov_b32 v160, v7
    v_mov_b32 v161, v7
    v_mov_b32 v162, v7
    v_mov_b32 v163, v7
    v_mov_b32 v164, v7
    v_mov_b32 v165, v7
    v_mov_b32 v166, v7
    v_mov_b32 v167, v7
    v_mov_b32 v168, v7
    v_mov_b32 v169, v7
    v_mov_b32 v170, v7
    v_mov_b32 v171, v7
    v_mov_b32 v172, v7
    v_mov_b32 v173, v7
    v_mov_b32 v174, v7
    v_mov_b32 v175, v7
mega_kernel_s2126:
    s_cmp_lt_u32 s20, 1
    s_cbranch_scc1 mega_kernel_s127
    v_mfma_f32_32x32x16_bf16 v[176:191], a[56:59], v[8:11], 0
    v_mfma_f32_32x32x16_bf16 v[176:191], a[60:63], v[12:15], v[176:191]
    s_branch mega_kernel_s2128
mega_kernel_s127:
    v_mov_b32 v176, v7
    v_mov_b32 v177, v7
    v_mov_b32 v178, v7
    v_mov_b32 v179, v7
    v_mov_b32 v180, v7
    v_mov_b32 v181, v7
    v_mov_b32 v182, v7
    v_mov_b32 v183, v7
    v_mov_b32 v184, v7
    v_mov_b32 v185, v7
    v_mov_b32 v186, v7
    v_mov_b32 v187, v7
    v_mov_b32 v188, v7
    v_mov_b32 v189, v7
    v_mov_b32 v190, v7
    v_mov_b32 v191, v7
mega_kernel_s2128:
    s_cmp_lt_u32 s20, 0
    s_cbranch_scc1 mega_kernel_s129
    v_mfma_f32_32x32x16_bf16 v[192:207], a[64:67], v[8:11], 0
    v_mfma_f32_32x32x16_bf16 v[192:207], a[68:71], v[12:15], v[192:207]
    s_branch mega_kernel_s2130
mega_kernel_s129:
    v_mov_b32 v192, v7
    v_mov_b32 v193, v7
    v_mov_b32 v194, v7
    v_mov_b32 v195, v7
    v_mov_b32 v196, v7
    v_mov_b32 v197, v7
    v_mov_b32 v198, v7
    v_mov_b32 v199, v7
    v_mov_b32 v200, v7
    v_mov_b32 v201, v7
    v_mov_b32 v202, v7
    v_mov_b32 v203, v7
    v_mov_b32 v204, v7
    v_mov_b32 v205, v7
    v_mov_b32 v206, v7
    v_mov_b32 v207, v7
mega_kernel_s2130:
    s_nop 15
    s_nop 3
    v_cmp_le_i32 vcc, 0, v6
    s_nop 1
    v_cndmask_b32 v192, v7, v192, vcc
    v_cndmask_b32 v64, v64, v7, vcc
    v_cmp_le_i32 vcc, 1, v6
    s_nop 1
    v_cndmask_b32 v193, v7, v193, vcc
    v_cndmask_b32 v65, v65, v7, vcc
    v_cmp_le_i32 vcc, 2, v6
    s_nop 1
    v_cndmask_b32 v194, v7, v194, vcc
    v_cndmask_b32 v66, v66, v7, vcc
    v_cmp_le_i32 vcc, 3, v6
    s_nop 1
    v_cndmask_b32 v195, v7, v195, vcc
    v_cndmask_b32 v67, v67, v7, vcc
    v_cmp_le_i32 vcc, 8, v6
    s_nop 1
    v_cndmask_b32 v196, v7, v196, vcc
    v_cndmask_b32 v68, v68, v7, vcc
    v_cmp_le_i32 vcc, 9, v6
    s_nop 1
    v_cndmask_b32 v197, v7, v197, vcc
    v_cndmask_b32 v69, v69, v7, vcc
    v_cmp_le_i32 vcc, 10, v6
    s_nop 1
    v_cndmask_b32 v198, v7, v198, vcc
    v_cndmask_b32 v70, v70, v7, vcc
    v_cmp_le_i32 vcc, 11, v6
    s_nop 1
    v_cndmask_b32 v199, v7, v199, vcc
    v_cndmask_b32 v71, v71, v7, vcc
    v_cmp_le_i32 vcc, 16, v6
    s_nop 1
    v_cndmask_b32 v200, v7, v200, vcc
    v_cndmask_b32 v72, v72, v7, vcc
    v_cmp_le_i32 vcc, 17, v6
    s_nop 1
    v_cndmask_b32 v201, v7, v201, vcc
    v_cndmask_b32 v73, v73, v7, vcc
    v_cmp_le_i32 vcc, 18, v6
    s_nop 1
    v_cndmask_b32 v202, v7, v202, vcc
    v_cndmask_b32 v74, v74, v7, vcc
    v_cmp_le_i32 vcc, 19, v6
    s_nop 1
    v_cndmask_b32 v203, v7, v203, vcc
    v_cndmask_b32 v75, v75, v7, vcc
    v_cmp_le_i32 vcc, 24, v6
    s_nop 1
    v_cndmask_b32 v204, v7, v204, vcc
    v_cndmask_b32 v76, v76, v7, vcc
    v_cmp_le_i32 vcc, 25, v6
    s_nop 1
    v_cndmask_b32 v205, v7, v205, vcc
    v_cndmask_b32 v77, v77, v7, vcc
    v_cmp_le_i32 vcc, 26, v6
    s_nop 1
    v_cndmask_b32 v206, v7, v206, vcc
    v_cndmask_b32 v78, v78, v7, vcc
    v_cmp_le_i32 vcc, 27, v6
    s_nop 1
    v_cndmask_b32 v207, v7, v207, vcc
    v_cndmask_b32 v79, v79, v7, vcc
    v_max_f32 v32, v64, v65
    v_max_f32 v33, v66, v67
    v_max_f32 v34, v68, v69
    v_max_f32 v35, v70, v71
    v_max3_f32 v32, v32, v72, v73
    v_max3_f32 v33, v33, v74, v75
    v_max3_f32 v34, v34, v76, v77
    v_max3_f32 v35, v35, v78, v79
    v_max3_f32 v32, v32, v80, v81
    v_max3_f32 v33, v33, v82, v83
    v_max3_f32 v34, v34, v84, v85
    v_max3_f32 v35, v35, v86, v87
    v_max3_f32 v32, v32, v88, v89
    v_max3_f32 v33, v33, v90, v91
    v_max3_f32 v34, v34, v92, v93
    v_max3_f32 v35, v35, v94, v95
    v_max3_f32 v32, v32, v96, v97
    v_max3_f32 v33, v33, v98, v99
    v_max3_f32 v34, v34, v100, v101
    v_max3_f32 v35, v35, v102, v103
    v_max3_f32 v32, v32, v104, v105
    v_max3_f32 v33, v33, v106, v107
    v_max3_f32 v34, v34, v108, v109
    v_max3_f32 v35, v35, v110, v111
    v_max3_f32 v32, v32, v112, v113
    v_max3_f32 v33, v33, v114, v115
    v_max3_f32 v34, v34, v116, v117
    v_max3_f32 v35, v35, v118, v119
    v_max3_f32 v32, v32, v120, v121
    v_max3_f32 v33, v33, v122, v123
    v_max3_f32 v34, v34, v124, v125
    v_max3_f32 v35, v35, v126, v127
    v_max3_f32 v32, v32, v128, v129
    v_max3_f32 v33, v33, v130, v131
    v_max3_f32 v34, v34, v132, v133
    v_max3_f32 v35, v35, v134, v135
    v_max3_f32 v32, v32, v136, v137
    v_max3_f32 v33, v33, v138, v139
    v_max3_f32 v34, v34, v140, v141
    v_max3_f32 v35, v35, v142, v143
    v_max3_f32 v32, v32, v144, v145
    v_max3_f32 v33, v33, v146, v147
    v_max3_f32 v34, v34, v148, v149
    v_max3_f32 v35, v35, v150, v151
    v_max3_f32 v32, v32, v152, v153
    v_max3_f32 v33, v33, v154, v155
    v_max3_f32 v34, v34, v156, v157
    v_max3_f32 v35, v35, v158, v159
    v_max3_f32 v32, v32, v160, v161
    v_max3_f32 v33, v33, v162, v163
    v_max3_f32 v34, v34, v164, v165
    v_max3_f32 v35, v35, v166, v167
    v_max3_f32 v32, v32, v168, v169
    v_max3_f32 v33, v33, v170, v171
    v_max3_f32 v34, v34, v172, v173
    v_max3_f32 v35, v35, v174, v175
    v_max3_f32 v32, v32, v176, v177
    v_max3_f32 v33, v33, v178, v179
    v_max3_f32 v34, v34, v180, v181
    v_max3_f32 v35, v35, v182, v183
    v_max3_f32 v32, v32, v184, v185
    v_max3_f32 v33, v33, v186, v187
    v_max3_f32 v34, v34, v188, v189
    v_max3_f32 v35, v35, v190, v191
    v_max3_f32 v32, v32, v192, v193
    v_max3_f32 v33, v33, v194, v195
    v_max3_f32 v34, v34, v196, v197
    v_max3_f32 v35, v35, v198, v199
    v_max3_f32 v32, v32, v200, v201
    v_max3_f32 v33, v33, v202, v203
    v_max3_f32 v34, v34, v204, v205
    v_max3_f32 v35, v35, v206, v207
    v_max_f32 v32, v32, v33
    v_max_f32 v34, v34, v35
    v_max_f32 v32, v32, v34
    v_mov_b32 v33, v32
    s_nop 1
    v_permlane32_swap_b32 v32, v33
    s_nop 1
    v_max_f32 v32, v32, v33
    s_mov_b32 s12, 0x3e8b97f6
    v_mul_f32 v33, s12, v32
    v_mov_b32 v34, 0
    v_mov_b32 v35, 0
    v_mov_b32 v36, 0
    v_mov_b32 v37, 0
    v_fma_f32 v64, v64, s12, -v33
    v_fma_f32 v65, v65, s12, -v33
    v_fma_f32 v66, v66, s12, -v33
    v_fma_f32 v67, v67, s12, -v33
    v_fma_f32 v68, v68, s12, -v33
    v_fma_f32 v69, v69, s12, -v33
    v_fma_f32 v70, v70, s12, -v33
    v_fma_f32 v71, v71, s12, -v33
    v_fma_f32 v72, v72, s12, -v33
    v_fma_f32 v73, v73, s12, -v33
    v_fma_f32 v74, v74, s12, -v33
    v_fma_f32 v75, v75, s12, -v33
    v_fma_f32 v76, v76, s12, -v33
    v_fma_f32 v77, v77, s12, -v33
    v_fma_f32 v78, v78, s12, -v33
    v_fma_f32 v79, v79, s12, -v33
    v_fma_f32 v80, v80, s12, -v33
    v_fma_f32 v81, v81, s12, -v33
    v_fma_f32 v82, v82, s12, -v33
    v_fma_f32 v83, v83, s12, -v33
    v_fma_f32 v84, v84, s12, -v33
    v_fma_f32 v85, v85, s12, -v33
    v_fma_f32 v86, v86, s12, -v33
    v_fma_f32 v87, v87, s12, -v33
    v_fma_f32 v88, v88, s12, -v33
    v_fma_f32 v89, v89, s12, -v33
    v_fma_f32 v90, v90, s12, -v33
    v_fma_f32 v91, v91, s12, -v33
    v_fma_f32 v92, v92, s12, -v33
    v_fma_f32 v93, v93, s12, -v33
    v_fma_f32 v94, v94, s12, -v33
    v_fma_f32 v95, v95, s12, -v33
    v_fma_f32 v96, v96, s12, -v33
    v_fma_f32 v97, v97, s12, -v33
    v_fma_f32 v98, v98, s12, -v33
    v_fma_f32 v99, v99, s12, -v33
    v_fma_f32 v100, v100, s12, -v33
    v_fma_f32 v101, v101, s12, -v33
    v_fma_f32 v102, v102, s12, -v33
    v_fma_f32 v103, v103, s12, -v33
    v_fma_f32 v104, v104, s12, -v33
    v_fma_f32 v105, v105, s12, -v33
    v_fma_f32 v106, v106, s12, -v33
    v_fma_f32 v107, v107, s12, -v33
    v_fma_f32 v108, v108, s12, -v33
    v_fma_f32 v109, v109, s12, -v33
    v_fma_f32 v110, v110, s12, -v33
    v_fma_f32 v111, v111, s12, -v33
    v_fma_f32 v112, v112, s12, -v33
    v_fma_f32 v113, v113, s12, -v33
    v_fma_f32 v114, v114, s12, -v33
    v_fma_f32 v115, v115, s12, -v33
    v_fma_f32 v116, v116, s12, -v33
    v_fma_f32 v117, v117, s12, -v33
    v_fma_f32 v118, v118, s12, -v33
    v_fma_f32 v119, v119, s12, -v33
    v_fma_f32 v120, v120, s12, -v33
    v_fma_f32 v121, v121, s12, -v33
    v_fma_f32 v122, v122, s12, -v33
    v_fma_f32 v123, v123, s12, -v33
    v_fma_f32 v124, v124, s12, -v33
    v_fma_f32 v125, v125, s12, -v33
    v_fma_f32 v126, v126, s12, -v33
    v_fma_f32 v127, v127, s12, -v33
    v_fma_f32 v128, v128, s12, -v33
    v_fma_f32 v129, v129, s12, -v33
    v_fma_f32 v130, v130, s12, -v33
    v_fma_f32 v131, v131, s12, -v33
    v_fma_f32 v132, v132, s12, -v33
    v_fma_f32 v133, v133, s12, -v33
    v_fma_f32 v134, v134, s12, -v33
    v_fma_f32 v135, v135, s12, -v33
    v_fma_f32 v136, v136, s12, -v33
    v_fma_f32 v137, v137, s12, -v33
    v_fma_f32 v138, v138, s12, -v33
    v_fma_f32 v139, v139, s12, -v33
    v_fma_f32 v140, v140, s12, -v33
    v_fma_f32 v141, v141, s12, -v33
    v_fma_f32 v142, v142, s12, -v33
    v_fma_f32 v143, v143, s12, -v33
    v_fma_f32 v144, v144, s12, -v33
    v_fma_f32 v145, v145, s12, -v33
    v_fma_f32 v146, v146, s12, -v33
    v_fma_f32 v147, v147, s12, -v33
    v_fma_f32 v148, v148, s12, -v33
    v_fma_f32 v149, v149, s12, -v33
    v_fma_f32 v150, v150, s12, -v33
    v_fma_f32 v151, v151, s12, -v33
    v_fma_f32 v152, v152, s12, -v33
    v_fma_f32 v153, v153, s12, -v33
    v_fma_f32 v154, v154, s12, -v33
    v_fma_f32 v155, v155, s12, -v33
    v_fma_f32 v156, v156, s12, -v33
    v_fma_f32 v157, v157, s12, -v33
    v_fma_f32 v158, v158, s12, -v33
    v_fma_f32 v159, v159, s12, -v33
    v_fma_f32 v160, v160, s12, -v33
    v_fma_f32 v161, v161, s12, -v33
    v_fma_f32 v162, v162, s12, -v33
    v_fma_f32 v163, v163, s12, -v33
    v_fma_f32 v164, v164, s12, -v33
    v_fma_f32 v165, v165, s12, -v33
    v_fma_f32 v166, v166, s12, -v33
    v_fma_f32 v167, v167, s12, -v33
    v_fma_f32 v168, v168, s12, -v33
    v_fma_f32 v169, v169, s12, -v33
    v_fma_f32 v170, v170, s12, -v33
    v_fma_f32 v171, v171, s12, -v33
    v_fma_f32 v172, v172, s12, -v33
    v_fma_f32 v173, v173, s12, -v33
    v_fma_f32 v174, v174, s12, -v33
    v_fma_f32 v175, v175, s12, -v33
    v_fma_f32 v176, v176, s12, -v33
    v_fma_f32 v177, v177, s12, -v33
    v_fma_f32 v178, v178, s12, -v33
    v_fma_f32 v179, v179, s12, -v33
    v_fma_f32 v180, v180, s12, -v33
    v_fma_f32 v181, v181, s12, -v33
    v_fma_f32 v182, v182, s12, -v33
    v_fma_f32 v183, v183, s12, -v33
    v_fma_f32 v184, v184, s12, -v33
    v_fma_f32 v185, v185, s12, -v33
    v_fma_f32 v186, v186, s12, -v33
    v_fma_f32 v187, v187, s12, -v33
    v_fma_f32 v188, v188, s12, -v33
    v_fma_f32 v189, v189, s12, -v33
    v_fma_f32 v190, v190, s12, -v33
    v_fma_f32 v191, v191, s12, -v33
    v_fma_f32 v192, v192, s12, -v33
    v_fma_f32 v193, v193, s12, -v33
    v_fma_f32 v194, v194, s12, -v33
    v_fma_f32 v195, v195, s12, -v33
    v_fma_f32 v196, v196, s12, -v33
    v_fma_f32 v197, v197, s12, -v33
    v_fma_f32 v198, v198, s12, -v33
    v_fma_f32 v199, v199, s12, -v33
    v_fma_f32 v200, v200, s12, -v33
    v_fma_f32 v201, v201, s12, -v33
    v_fma_f32 v202, v202, s12, -v33
    v_fma_f32 v203, v203, s12, -v33
    v_fma_f32 v204, v204, s12, -v33
    v_fma_f32 v205, v205, s12, -v33
    v_fma_f32 v206, v206, s12, -v33
    v_fma_f32 v207, v207, s12, -v33
    v_exp_f32 v64, v64
    v_exp_f32 v65, v65
    v_exp_f32 v66, v66
    v_exp_f32 v67, v67
    v_exp_f32 v68, v68
    v_exp_f32 v69, v69
    v_exp_f32 v70, v70
    v_exp_f32 v71, v71
    v_exp_f32 v72, v72
    v_exp_f32 v73, v73
    v_exp_f32 v74, v74
    v_exp_f32 v75, v75
    v_exp_f32 v76, v76
    v_exp_f32 v77, v77
    v_exp_f32 v78, v78
    v_exp_f32 v79, v79
    v_exp_f32 v80, v80
    v_exp_f32 v81, v81
    v_exp_f32 v82, v82
    v_exp_f32 v83, v83
    v_exp_f32 v84, v84
    v_exp_f32 v85, v85
    v_exp_f32 v86, v86
    v_exp_f32 v87, v87
    v_exp_f32 v88, v88
    v_exp_f32 v89, v89
    v_exp_f32 v90, v90
    v_exp_f32 v91, v91
    v_exp_f32 v92, v92
    v_exp_f32 v93, v93
    v_exp_f32 v94, v94
    v_exp_f32 v95, v95
    v_exp_f32 v96, v96
    v_exp_f32 v97, v97
    v_exp_f32 v98, v98
    v_exp_f32 v99, v99
    v_exp_f32 v100, v100
    v_exp_f32 v101, v101
    v_exp_f32 v102, v102
    v_exp_f32 v103, v103
    v_exp_f32 v104, v104
    v_exp_f32 v105, v105
    v_exp_f32 v106, v106
    v_exp_f32 v107, v107
    v_exp_f32 v108, v108
    v_exp_f32 v109, v109
    v_exp_f32 v110, v110
    v_exp_f32 v111, v111
    v_exp_f32 v112, v112
    v_exp_f32 v113, v113
    v_exp_f32 v114, v114
    v_exp_f32 v115, v115
    v_exp_f32 v116, v116
    v_exp_f32 v117, v117
    v_exp_f32 v118, v118
    v_exp_f32 v119, v119
    v_exp_f32 v120, v120
    v_exp_f32 v121, v121
    v_exp_f32 v122, v122
    v_exp_f32 v123, v123
    v_exp_f32 v124, v124
    v_exp_f32 v125, v125
    v_exp_f32 v126, v126
    v_exp_f32 v127, v127
    v_exp_f32 v128, v128
    v_exp_f32 v129, v129
    v_exp_f32 v130, v130
    v_exp_f32 v131, v131
    v_exp_f32 v132, v132
    v_exp_f32 v133, v133
    v_exp_f32 v134, v134
    v_exp_f32 v135, v135
    v_exp_f32 v136, v136
    v_exp_f32 v137, v137
    v_exp_f32 v138, v138
    v_exp_f32 v139, v139
    v_exp_f32 v140, v140
    v_exp_f32 v141, v141
    v_exp_f32 v142, v142
    v_exp_f32 v143, v143
    v_exp_f32 v144, v144
    v_exp_f32 v145, v145
    v_exp_f32 v146, v146
    v_exp_f32 v147, v147
    v_exp_f32 v148, v148
    v_exp_f32 v149, v149
    v_exp_f32 v150, v150
    v_exp_f32 v151, v151
    v_exp_f32 v152, v152
    v_exp_f32 v153, v153
    v_exp_f32 v154, v154
    v_exp_f32 v155, v155
    v_exp_f32 v156, v156
    v_exp_f32 v157, v157
    v_exp_f32 v158, v158
    v_exp_f32 v159, v159
    v_exp_f32 v160, v160
    v_exp_f32 v161, v161
    v_exp_f32 v162, v162
    v_exp_f32 v163, v163
    v_exp_f32 v164, v164
    v_exp_f32 v165, v165
    v_exp_f32 v166, v166
    v_exp_f32 v167, v167
    v_exp_f32 v168, v168
    v_exp_f32 v169, v169
    v_exp_f32 v170, v170
    v_exp_f32 v171, v171
    v_exp_f32 v172, v172
    v_exp_f32 v173, v173
    v_exp_f32 v174, v174
    v_exp_f32 v175, v175
    v_exp_f32 v176, v176
    v_exp_f32 v177, v177
    v_exp_f32 v178, v178
    v_exp_f32 v179, v179
    v_exp_f32 v180, v180
    v_exp_f32 v181, v181
    v_exp_f32 v182, v182
    v_exp_f32 v183, v183
    v_exp_f32 v184, v184
    v_exp_f32 v185, v185
    v_exp_f32 v186, v186
    v_exp_f32 v187, v187
    v_exp_f32 v188, v188
    v_exp_f32 v189, v189
    v_exp_f32 v190, v190
    v_exp_f32 v191, v191
    v_exp_f32 v192, v192
    v_exp_f32 v193, v193
    v_exp_f32 v194, v194
    v_exp_f32 v195, v195
    v_exp_f32 v196, v196
    v_exp_f32 v197, v197
    v_exp_f32 v198, v198
    v_exp_f32 v199, v199
    v_exp_f32 v200, v200
    v_exp_f32 v201, v201
    v_exp_f32 v202, v202
    v_exp_f32 v203, v203
    v_exp_f32 v204, v204
    v_exp_f32 v205, v205
    v_exp_f32 v206, v206
    v_exp_f32 v207, v207
    s_nop 0
    v_add_f32 v34, v34, v64
    v_add_f32 v35, v35, v65
    v_add_f32 v36, v36, v66
    v_add_f32 v37, v37, v67
    v_add_f32 v34, v34, v68
    v_add_f32 v35, v35, v69
    v_add_f32 v36, v36, v70
    v_add_f32 v37, v37, v71
    v_add_f32 v34, v34, v72
    v_add_f32 v35, v35, v73
    v_add_f32 v36, v36, v74
    v_add_f32 v37, v37, v75
    v_add_f32 v34, v34, v76
    v_add_f32 v35, v35, v77
    v_add_f32 v36, v36, v78
    v_add_f32 v37, v37, v79
    v_add_f32 v34, v34, v80
    v_add_f32 v35, v35, v81
    v_add_f32 v36, v36, v82
    v_add_f32 v37, v37, v83
    v_add_f32 v34, v34, v84
    v_add_f32 v35, v35, v85
    v_add_f32 v36, v36, v86
    v_add_f32 v37, v37, v87
    v_add_f32 v34, v34, v88
    v_add_f32 v35, v35, v89
    v_add_f32 v36, v36, v90
    v_add_f32 v37, v37, v91
    v_add_f32 v34, v34, v92
    v_add_f32 v35, v35, v93
    v_add_f32 v36, v36, v94
    v_add_f32 v37, v37, v95
    v_add_f32 v34, v34, v96
    v_add_f32 v35, v35, v97
    v_add_f32 v36, v36, v98
    v_add_f32 v37, v37, v99
    v_add_f32 v34, v34, v100
    v_add_f32 v35, v35, v101
    v_add_f32 v36, v36, v102
    v_add_f32 v37, v37, v103
    v_add_f32 v34, v34, v104
    v_add_f32 v35, v35, v105
    v_add_f32 v36, v36, v106
    v_add_f32 v37, v37, v107
    v_add_f32 v34, v34, v108
    v_add_f32 v35, v35, v109
    v_add_f32 v36, v36, v110
    v_add_f32 v37, v37, v111
    v_add_f32 v34, v34, v112
    v_add_f32 v35, v35, v113
    v_add_f32 v36, v36, v114
    v_add_f32 v37, v37, v115
    v_add_f32 v34, v34, v116
    v_add_f32 v35, v35, v117
    v_add_f32 v36, v36, v118
    v_add_f32 v37, v37, v119
    v_add_f32 v34, v34, v120
    v_add_f32 v35, v35, v121
    v_add_f32 v36, v36, v122
    v_add_f32 v37, v37, v123
    v_add_f32 v34, v34, v124
    v_add_f32 v35, v35, v125
    v_add_f32 v36, v36, v126
    v_add_f32 v37, v37, v127
    v_add_f32 v34, v34, v128
    v_add_f32 v35, v35, v129
    v_add_f32 v36, v36, v130
    v_add_f32 v37, v37, v131
    v_add_f32 v34, v34, v132
    v_add_f32 v35, v35, v133
    v_add_f32 v36, v36, v134
    v_add_f32 v37, v37, v135
    v_add_f32 v34, v34, v136
    v_add_f32 v35, v35, v137
    v_add_f32 v36, v36, v138
    v_add_f32 v37, v37, v139
    v_add_f32 v34, v34, v140
    v_add_f32 v35, v35, v141
    v_add_f32 v36, v36, v142
    v_add_f32 v37, v37, v143
    v_add_f32 v34, v34, v144
    v_add_f32 v35, v35, v145
    v_add_f32 v36, v36, v146
    v_add_f32 v37, v37, v147
    v_add_f32 v34, v34, v148
    v_add_f32 v35, v35, v149
    v_add_f32 v36, v36, v150
    v_add_f32 v37, v37, v151
    v_add_f32 v34, v34, v152
    v_add_f32 v35, v35, v153
    v_add_f32 v36, v36, v154
    v_add_f32 v37, v37, v155
    v_add_f32 v34, v34, v156
    v_add_f32 v35, v35, v157
    v_add_f32 v36, v36, v158
    v_add_f32 v37, v37, v159
    v_add_f32 v34, v34, v160
    v_add_f32 v35, v35, v161
    v_add_f32 v36, v36, v162
    v_add_f32 v37, v37, v163
    v_add_f32 v34, v34, v164
    v_add_f32 v35, v35, v165
    v_add_f32 v36, v36, v166
    v_add_f32 v37, v37, v167
    v_add_f32 v34, v34, v168
    v_add_f32 v35, v35, v169
    v_add_f32 v36, v36, v170
    v_add_f32 v37, v37, v171
    v_add_f32 v34, v34, v172
    v_add_f32 v35, v35, v173
    v_add_f32 v36, v36, v174
    v_add_f32 v37, v37, v175
    v_add_f32 v34, v34, v176
    v_add_f32 v35, v35, v177
    v_add_f32 v36, v36, v178
    v_add_f32 v37, v37, v179
    v_add_f32 v34, v34, v180
    v_add_f32 v35, v35, v181
    v_add_f32 v36, v36, v182
    v_add_f32 v37, v37, v183
    v_add_f32 v34, v34, v184
    v_add_f32 v35, v35, v185
    v_add_f32 v36, v36, v186
    v_add_f32 v37, v37, v187
    v_add_f32 v34, v34, v188
    v_add_f32 v35, v35, v189
    v_add_f32 v36, v36, v190
    v_add_f32 v37, v37, v191
    v_add_f32 v34, v34, v192
    v_add_f32 v35, v35, v193
    v_add_f32 v36, v36, v194
    v_add_f32 v37, v37, v195
    v_add_f32 v34, v34, v196
    v_add_f32 v35, v35, v197
    v_add_f32 v36, v36, v198
    v_add_f32 v37, v37, v199
    v_add_f32 v34, v34, v200
    v_add_f32 v35, v35, v201
    v_add_f32 v36, v36, v202
    v_add_f32 v37, v37, v203
    v_add_f32 v34, v34, v204
    v_add_f32 v35, v35, v205
    v_add_f32 v36, v36, v206
    v_add_f32 v37, v37, v207
    v_cvt_pk_bf16_f32 v64, v64, v65
    v_cvt_pk_bf16_f32 v65, v66, v67
    v_cvt_pk_bf16_f32 v66, v68, v69
    v_cvt_pk_bf16_f32 v67, v70, v71
    v_cvt_pk_bf16_f32 v68, v72, v73
    v_cvt_pk_bf16_f32 v69, v74, v75
    v_cvt_pk_bf16_f32 v70, v76, v77
    v_cvt_pk_bf16_f32 v71, v78, v79
    v_cvt_pk_bf16_f32 v72, v80, v81
    v_cvt_pk_bf16_f32 v73, v82, v83
    v_cvt_pk_bf16_f32 v74, v84, v85
    v_cvt_pk_bf16_f32 v75, v86, v87
    v_cvt_pk_bf16_f32 v76, v88, v89
    v_cvt_pk_bf16_f32 v77, v90, v91
    v_cvt_pk_bf16_f32 v78, v92, v93
    v_cvt_pk_bf16_f32 v79, v94, v95
    v_cvt_pk_bf16_f32 v80, v96, v97
    v_cvt_pk_bf16_f32 v81, v98, v99
    v_cvt_pk_bf16_f32 v82, v100, v101
    v_cvt_pk_bf16_f32 v83, v102, v103
    v_cvt_pk_bf16_f32 v84, v104, v105
    v_cvt_pk_bf16_f32 v85, v106, v107
    v_cvt_pk_bf16_f32 v86, v108, v109
    v_cvt_pk_bf16_f32 v87, v110, v111
    v_cvt_pk_bf16_f32 v88, v112, v113
    v_cvt_pk_bf16_f32 v89, v114, v115
    v_cvt_pk_bf16_f32 v90, v116, v117
    v_cvt_pk_bf16_f32 v91, v118, v119
    v_cvt_pk_bf16_f32 v92, v120, v121
    v_cvt_pk_bf16_f32 v93, v122, v123
    v_cvt_pk_bf16_f32 v94, v124, v125
    v_cvt_pk_bf16_f32 v95, v126, v127
    v_cvt_pk_bf16_f32 v96, v128, v129
    v_cvt_pk_bf16_f32 v97, v130, v131
    v_cvt_pk_bf16_f32 v98, v132, v133
    v_cvt_pk_bf16_f32 v99, v134, v135
    v_cvt_pk_bf16_f32 v100, v136, v137
    v_cvt_pk_bf16_f32 v101, v138, v139
    v_cvt_pk_bf16_f32 v102, v140, v141
    v_cvt_pk_bf16_f32 v103, v142, v143
    v_cvt_pk_bf16_f32 v104, v144, v145
    v_cvt_pk_bf16_f32 v105, v146, v147
    v_cvt_pk_bf16_f32 v106, v148, v149
    v_cvt_pk_bf16_f32 v107, v150, v151
    v_cvt_pk_bf16_f32 v108, v152, v153
    v_cvt_pk_bf16_f32 v109, v154, v155
    v_cvt_pk_bf16_f32 v110, v156, v157
    v_cvt_pk_bf16_f32 v111, v158, v159
    v_cvt_pk_bf16_f32 v112, v160, v161
    v_cvt_pk_bf16_f32 v113, v162, v163
    v_cvt_pk_bf16_f32 v114, v164, v165
    v_cvt_pk_bf16_f32 v115, v166, v167
    v_cvt_pk_bf16_f32 v116, v168, v169
    v_cvt_pk_bf16_f32 v117, v170, v171
    v_cvt_pk_bf16_f32 v118, v172, v173
    v_cvt_pk_bf16_f32 v119, v174, v175
    v_cvt_pk_bf16_f32 v120, v176, v177
    v_cvt_pk_bf16_f32 v121, v178, v179
    v_cvt_pk_bf16_f32 v122, v180, v181
    v_cvt_pk_bf16_f32 v123, v182, v183
    v_cvt_pk_bf16_f32 v124, v184, v185
    v_cvt_pk_bf16_f32 v125, v186, v187
    v_cvt_pk_bf16_f32 v126, v188, v189
    v_cvt_pk_bf16_f32 v127, v190, v191
    v_cvt_pk_bf16_f32 v128, v192, v193
    v_cvt_pk_bf16_f32 v129, v194, v195
    v_cvt_pk_bf16_f32 v130, v196, v197
    v_cvt_pk_bf16_f32 v131, v198, v199
    v_cvt_pk_bf16_f32 v132, v200, v201
    v_cvt_pk_bf16_f32 v133, v202, v203
    v_cvt_pk_bf16_f32 v134, v204, v205
    v_cvt_pk_bf16_f32 v135, v206, v207
    v_add_f32 v34, v34, v35
    v_add_f32 v36, v36, v37
    v_add_f32 v34, v34, v36
    v_mov_b32 v35, v34
    s_nop 1
    v_permlane32_swap_b32 v34, v35
    s_nop 1
    v_add_f32 v34, v34, v35
    v_rcp_f32 v34, v34
    s_cmp_lt_u32 s20, 8
    s_cbranch_scc1 mega_kernel_p131
    v_mfma_f32_32x32x16_bf16 v[16:31], a[72:75], v[64:67], v[16:31]
    v_mfma_f32_32x32x16_bf16 v[16:31], a[76:79], v[68:71], v[16:31]
mega_kernel_p131:
    s_cmp_lt_u32 s20, 7
    s_cbranch_scc1 mega_kernel_p132
    v_mfma_f32_32x32x16_bf16 v[16:31], a[80:83], v[72:75], v[16:31]
    v_mfma_f32_32x32x16_bf16 v[16:31], a[84:87], v[76:79], v[16:31]
mega_kernel_p132:
    s_cmp_lt_u32 s20, 6
    s_cbranch_scc1 mega_kernel_p133
    v_mfma_f32_32x32x16_bf16 v[16:31], a[88:91], v[80:83], v[16:31]
    v_mfma_f32_32x32x16_bf16 v[16:31], a[92:95], v[84:87], v[16:31]
mega_kernel_p133:
    s_cmp_lt_u32 s20, 5
    s_cbranch_scc1 mega_kernel_p134
    v_mfma_f32_32x32x16_bf16 v[16:31], a[96:99], v[88:91], v[16:31]
    v_mfma_f32_32x32x16_bf16 v[16:31], a[100:103], v[92:95], v[16:31]
mega_kernel_p134:
    s_cmp_lt_u32 s20, 4
    s_cbranch_scc1 mega_kernel_p135
    v_mfma_f32_32x32x16_bf16 v[16:31], a[104:107], v[96:99], v[16:31]
    v_mfma_f32_32x32x16_bf16 v[16:31], a[108:111], v[100:103], v[16:31]
mega_kernel_p135:
    s_cmp_lt_u32 s20, 3
    s_cbranch_scc1 mega_kernel_p136
    v_mfma_f32_32x32x16_bf16 v[16:31], a[112:115], v[104:107], v[16:31]
    v_mfma_f32_32x32x16_bf16 v[16:31], a[116:119], v[108:111], v[16:31]
mega_kernel_p136:
    s_cmp_lt_u32 s20, 2
    s_cbranch_scc1 mega_kernel_p137
    v_mfma_f32_32x32x16_bf16 v[16:31], a[120:123], v[112:115], v[16:31]
    v_mfma_f32_32x32x16_bf16 v[16:31], a[124:127], v[116:119], v[16:31]
mega_kernel_p137:
    s_cmp_lt_u32 s20, 1
    s_cbranch_scc1 mega_kernel_p138
    v_mfma_f32_32x32x16_bf16 v[16:31], a[128:131], v[120:123], v[16:31]
    v_mfma_f32_32x32x16_bf16 v[16:31], a[132:135], v[124:127], v[16:31]
mega_kernel_p138:
    s_cmp_lt_u32 s20, 0
    s_cbranch_scc1 mega_kernel_p139
    v_mfma_f32_32x32x16_bf16 v[16:31], a[136:139], v[128:131], v[16:31]
    v_mfma_f32_32x32x16_bf16 v[16:31], a[140:143], v[132:135], v[16:31]
mega_kernel_p139:
    s_nop 15
    s_nop 3
    v_mul_f32 v16, v16, v34
    v_mul_f32 v17, v17, v34
    v_mul_f32 v18, v18, v34
    v_mul_f32 v19, v19, v34
    v_mul_f32 v20, v20, v34
    v_mul_f32 v21, v21, v34
    v_mul_f32 v22, v22, v34
    v_mul_f32 v23, v23, v34
    v_mul_f32 v24, v24, v34
    v_mul_f32 v25, v25, v34
    v_mul_f32 v26, v26, v34
    v_mul_f32 v27, v27, v34
    v_mul_f32 v28, v28, v34
    v_mul_f32 v29, v29, v34
    v_mul_f32 v30, v30, v34
    v_mul_f32 v31, v31, v34
    v_cvt_pk_bf16_f32 v40, v16, v17
    v_cvt_pk_bf16_f32 v41, v18, v19
    v_cvt_pk_bf16_f32 v42, v20, v21
    v_cvt_pk_bf16_f32 v43, v22, v23
    v_cvt_pk_bf16_f32 v44, v24, v25
    v_cvt_pk_bf16_f32 v45, v26, v27
    v_cvt_pk_bf16_f32 v46, v28, v29
    v_cvt_pk_bf16_f32 v47, v30, v31
    s_lshl_b32 s9, s20, 15
    s_add_u32 s9, s9, s24
    buffer_store_dwordx4 v[40:43], v5, s[44:47], s9 offen sc1
    buffer_store_dwordx4 v[44:47], v5, s[44:47], s9 offen offset:1024 sc1
    s_waitcnt vmcnt(0)
    s_barrier
    s_cmp_lg_u32 s3, 0
    s_cbranch_scc1 mega_kernel_sf140
    s_lshl_b32 s37, s20, 8
    s_lshl_b32 s33, s31, 14
    s_add_u32 s37, s37, s33
    s_lshl_b32 s33, s15, 2
    s_add_u32 s37, s37, s33
    s_add_u32 s37, s37, 200871936
    s_mov_b64 s[34:35], exec
    s_mov_b64 exec, 1
    v_mov_b32 v8, 1
    v_mov_b32 v9, 0
    buffer_store_dword v8, v9, s[44:47], s37 offen sc1
    s_mov_b64 exec, s[34:35]
mega_kernel_sf140:
    s_add_u32 s20, s20, 2
    s_cmp_lt_u32 s20, 64
    s_cbranch_scc1 mega_kernel_tl98
    s_branch mega_kernel_done
mega_kernel_g365:
    s_sub_u32 s15, s15, 74
    s_lshl_b32 s16, s15, 2
    s_add_u32 s16, s16, s3
    s_lshl_b32 s26, s31, 1
    s_add_u32 s26, s26, 0
    s_add_u32 s28, s26, 1
    s_mul_i32 s29, s28, 229376
    s_add_u32 s29, s29, 7340032
    s_mul_i32 s28, s28, 1835008
    s_add_u32 s28, s28, 0
    s_mul_i32 s26, s26, 1835008
    s_add_u32 s26, s26, 0
    v_lshlrev_b32 v60, 4, v2
    v_lshl_add_u32 v60, v3, 3, v60
    v_lshlrev_b32 v59, 3, v2
    v_mov_b32 v8, 2147483392
    v_cmp_eq_u32 vcc, 0, v3
    s_nop 1
    v_cndmask_b32 v59, v8, v59, vcc
    s_min_u32 s17, s16, 13
    s_lshl_b32 s7, s17, 15
    s_add_u32 s7, s7, 27066368
    v_mov_b32 v6, v5
    buffer_load_dwordx4 a[0:3], v6, s[44:47], s7 offen offset:0
    buffer_load_dwordx4 a[4:7], v6, s[44:47], s7 offen offset:1024
    buffer_load_dwordx4 a[8:11], v6, s[44:47], s7 offen offset:2048
    buffer_load_dwordx4 a[12:15], v6, s[44:47], s7 offen offset:3072
    v_add_u32 v6, 4096, v6
    buffer_load_dwordx4 a[16:19], v6, s[44:47], s7 offen offset:0
    buffer_load_dwordx4 a[20:23], v6, s[44:47], s7 offen offset:1024
    buffer_load_dwordx4 a[24:27], v6, s[44:47], s7 offen offset:2048
    buffer_load_dwordx4 a[28:31], v6, s[44:47], s7 offen offset:3072
    v_add_u32 v6, 4096, v6
    buffer_load_dwordx4 a[32:35], v6, s[44:47], s7 offen offset:0
    buffer_load_dwordx4 a[36:39], v6, s[44:47], s7 offen offset:1024
    buffer_load_dwordx4 a[40:43], v6, s[44:47], s7 offen offset:2048
    buffer_load_dwordx4 a[44:47], v6, s[44:47], s7 offen offset:3072
    v_add_u32 v6, 4096, v6
    buffer_load_dwordx4 a[48:51], v6, s[44:47], s7 offen offset:0
    buffer_load_dwordx4 a[52:55], v6, s[44:47], s7 offen offset:1024
    buffer_load_dwordx4 a[56:59], v6, s[44:47], s7 offen offset:2048
    buffer_load_dwordx4 a[60:63], v6, s[44:47], s7 offen offset:3072
    v_add_u32 v6, 4096, v6
    buffer_load_dwordx4 a[64:67], v6, s[44:47], s7 offen offset:0
    buffer_load_dwordx4 a[68:71], v6, s[44:47], s7 offen offset:1024
    buffer_load_dwordx4 a[72:75], v6, s[44:47], s7 offen offset:2048
    buffer_load_dwordx4 a[76:79], v6, s[44:47], s7 offen offset:3072
    v_add_u32 v6, 4096, v6
    buffer_load_dwordx4 a[80:83], v6, s[44:47], s7 offen offset:0
    buffer_load_dwordx4 a[84:87], v6, s[44:47], s7 offen offset:1024
    buffer_load_dwordx4 a[88:91], v6, s[44:47], s7 offen offset:2048
    buffer_load_dwordx4 a[92:95], v6, s[44:47], s7 offen offset:3072
    v_add_u32 v6, 4096, v6
    buffer_load_dwordx4 a[96:99], v6, s[44:47], s7 offen offset:0
    buffer_load_dwordx4 a[100:103], v6, s[44:47], s7 offen offset:1024
    buffer_load_dwordx4 a[104:107], v6, s[44:47], s7 offen offset:2048
    buffer_load_dwordx4 a[108:111], v6, s[44:47], s7 offen offset:3072
    v_add_u32 v6, 4096, v6
    buffer_load_dwordx4 a[112:115], v6, s[44:47], s7 offen offset:0
    buffer_load_dwordx4 a[116:119], v6, s[44:47], s7 offen offset:1024
    buffer_load_dwordx4 a[120:123], v6, s[44:47], s7 offen offset:2048
    buffer_load_dwordx4 a[124:127], v6, s[44:47], s7 offen offset:3072
    s_mul_i32 s22, s31, 2097152
    s_add_u32 s22, s22, 40108032
    s_lshl_b32 s7, s3, 13
    s_add_u32 s22, s22, s7
    s_mov_b32 s20, 0
    s_waitcnt vmcnt(0)
mega_kernel_gl141:
    s_lshl_b32 s37, s20, 8
    s_lshl_b32 s33, s31, 14
    s_add_u32 s37, s37, s33
    s_add_u32 s37, s37, 200871936
    v_lshlrev_b32 v9, 2, v62
    v_cmp_gt_u32 s[38:39], 4, v62
    s_mov_b32 s12, 0
    buffer_load_dword v8, v9, s[44:47], s37 offen sc1
    s_waitcnt vmcnt(0)
    s_cmp_eq_u32 s95, 0
    s_cbranch_scc1 mega_kernel_f1145
    s_barrier
    s_cmp_lg_u32 s3, 0
    s_cbranch_scc1 mega_kernel_f1145
    s_sub_u32 s32, s20, 1
    s_lshl_b32 s32, s32, 8
    s_add_u32 s32, s32, s33
    s_lshl_b32 s33, s15, 2
    s_add_u32 s32, s32, s33
    s_add_u32 s32, s32, 200904704
    s_mov_b64 s[34:35], exec
    s_mov_b64 exec, 1
    v_mov_b32 v10, 1
    v_mov_b32 v11, 0
    buffer_store_dword v10, v11, s[44:47], s32 offen sc1
    s_mov_b64 exec, s[34:35]
mega_kernel_f1145:
    s_mov_b32 s95, 1
    s_branch mega_kernel_f2146
mega_kernel_fp143:
    s_sleep 1
    buffer_load_dword v8, v9, s[44:47], s37 offen sc1
    s_waitcnt vmcnt(0)
mega_kernel_f2146:
    v_cmp_eq_u32 vcc, 0, v8
    s_and_b64 s[40:41], vcc, s[38:39]
    s_cbranch_scc0 mega_kernel_fo144
    s_add_u32 s12, s12, 1
    s_cmp_lt_u32 s12, 2000000
    s_cbranch_scc1 mega_kernel_fp143
mega_kernel_fo144:
    v_add_u32 v4, 4096, v5
    buffer_load_dwordx4 v[64:67], v5, s[44:47], s22 offen offset:0 sc1
    buffer_load_dwordx4 v[68:71], v5, s[44:47], s22 offen offset:1024 sc1
    buffer_load_dwordx4 v[72:75], v5, s[44:47], s22 offen offset:2048 sc1
    buffer_load_dwordx4 v[76:79], v5, s[44:47], s22 offen offset:3072 sc1
    buffer_load_dwordx4 v[80:83], v4, s[44:47], s22 offen offset:0 sc1
    buffer_load_dwordx4 v[84:87], v4, s[44:47], s22 offen offset:1024 sc1
    buffer_load_dwordx4 v[88:91], v4, s[44:47], s22 offen offset:2048 sc1
    buffer_load_dwordx4 v[92:95], v4, s[44:47], s22 offen offset:3072 sc1
    s_mov_b32 s18, s16
    s_mov_b32 s16, s17
    s_mul_i32 s6, s20, 28672
    s_add_u32 s6, s6, s26
    s_lshl_b32 s7, s16, 11
    s_add_u32 s6, s6, s7
    buffer_load_dwordx2 v[40:41], v60, s[44:47], s6 offen offset:0 sc1
    buffer_load_dwordx2 v[42:43], v60, s[44:47], s6 offen offset:512 sc1
    buffer_load_dwordx2 v[44:45], v60, s[44:47], s6 offen offset:1024 sc1
    buffer_load_dwordx2 v[46:47], v60, s[44:47], s6 offen offset:1536 sc1
    s_mov_b32 s16, s18
    s_add_u32 s22, s22, 32768
    s_lshl_b32 s7, s3, 13
    v_add_u32 v4, s7, v5
    s_waitcnt vmcnt(4)
    ds_write_b128 v4, v[64:67] offset:0
    ds_write_b128 v4, v[68:71] offset:1024
    ds_write_b128 v4, v[72:75] offset:2048
    ds_write_b128 v4, v[76:79] offset:3072
    ds_write_b128 v4, v[80:83] offset:4096
    ds_write_b128 v4, v[84:87] offset:5120
    ds_write_b128 v4, v[88:91] offset:6144
    ds_write_b128 v4, v[92:95] offset:7168
    s_waitcnt lgkmcnt(0)
    s_barrier
    ds_read_b128 v[64:67], v5 offset:0
    ds_read_b128 v[68:71], v5 offset:1024
    ds_read_b128 v[72:75], v5 offset:2048
    ds_read_b128 v[76:79], v5 offset:3072
    s_waitcnt lgkmcnt(3)
    v_mfma_f32_32x32x16_bf16 v[16:31], a[0:3], v[64:67], 0
    ds_read_b128 v[80:83], v5 offset:4096
    s_waitcnt lgkmcnt(3)
    v_mfma_f32_32x32x16_bf16 v[16:31], a[4:7], v[68:71], v[16:31]
    ds_read_b128 v[64:67], v5 offset:5120
    s_waitcnt lgkmcnt(3)
    v_mfma_f32_32x32x16_bf16 v[16:31], a[8:11], v[72:75], v[16:31]
    ds_read_b128 v[68:71], v5 offset:6144
    s_waitcnt lgkmcnt(3)
    v_mfma_f32_32x32x16_bf16 v[16:31], a[12:15], v[76:79], v[16:31]
    ds_read_b128 v[72:75], v5 offset:7168
    s_waitcnt lgkmcnt(3)
    v_mfma_f32_32x32x16_bf16 v[16:31], a[16:19], v[80:83], v[16:31]
    ds_read_b128 v[76:79], v5 offset:8192
    s_waitcnt lgkmcnt(3)
    v_mfma_f32_32x32x16_bf16 v[16:31], a[20:23], v[64:67], v[16:31]
    ds_read_b128 v[80:83], v5 offset:9216
    s_waitcnt lgkmcnt(3)
    v_mfma_f32_32x32x16_bf16 v[16:31], a[24:27], v[68:71], v[16:31]
    ds_read_b128 v[64:67], v5 offset:10240
    s_waitcnt lgkmcnt(3)
    v_mfma_f32_32x32x16_bf16 v[16:31], a[28:31], v[72:75], v[16:31]
    ds_read_b128 v[68:71], v5 offset:11264
    s_waitcnt lgkmcnt(3)
    v_mfma_f32_32x32x16_bf16 v[16:31], a[32:35], v[76:79], v[16:31]
    ds_read_b128 v[72:75], v5 offset:12288
    s_waitcnt lgkmcnt(3)
    v_mfma_f32_32x32x16_bf16 v[16:31], a[36:39], v[80:83], v[16:31]
    ds_read_b128 v[76:79], v5 offset:13312
    s_waitcnt lgkmcnt(3)
    v_mfma_f32_32x32x16_bf16 v[16:31], a[40:43], v[64:67], v[16:31]
    ds_read_b128 v[80:83], v5 offset:14336
    s_waitcnt lgkmcnt(3)
    v_mfma_f32_32x32x16_bf16 v[16:31], a[44:47], v[68:71], v[16:31]
    ds_read_b128 v[64:67], v5 offset:15360
    s_waitcnt lgkmcnt(3)
    v_mfma_f32_32x32x16_bf16 v[16:31], a[48:51], v[72:75], v[16:31]
    ds_read_b128 v[68:71], v5 offset:16384
    s_waitcnt lgkmcnt(3)
    v_mfma_f32_32x32x16_bf16 v[16:31], a[52:55], v[76:79], v[16:31]
    ds_read_b128 v[72:75], v5 offset:17408
    s_waitcnt lgkmcnt(3)
    v_mfma_f32_32x32x16_bf16 v[16:31], a[56:59], v[80:83], v[16:31]
    ds_read_b128 v[76:79], v5 offset:18432
    s_waitcnt lgkmcnt(3)
    v_mfma_f32_32x32x16_bf16 v[16:31], a[60:63], v[64:67], v[16:31]
    ds_read_b128 v[80:83], v5 offset:19456
    s_waitcnt lgkmcnt(3)
    v_mfma_f32_32x32x16_bf16 v[16:31], a[64:67], v[68:71], v[16:31]
    ds_read_b128 v[64:67], v5 offset:20480
    s_waitcnt lgkmcnt(3)
    v_mfma_f32_32x32x16_bf16 v[16:31], a[68:71], v[72:75], v[16:31]
    ds_read_b128 v[68:71], v5 offset:21504
    s_waitcnt lgkmcnt(3)
    v_mfma_f32_32x32x16_bf16 v[16:31], a[72:75], v[76:79], v[16:31]
    ds_read_b128 v[72:75], v5 offset:22528
    s_waitcnt lgkmcnt(3)
    v_mfma_f32_32x32x16_bf16 v[16:31], a[76:79], v[80:83], v[16:31]
    ds_read_b128 v[76:79], v5 offset:23552
    s_waitcnt lgkmcnt(3)
    v_mfma_f32_32x32x16_bf16 v[16:31], a[80:83], v[64:67], v[16:31]
    ds_read_b128 v[80:83], v5 offset:24576
    s_waitcnt lgkmcnt(3)
    v_mfma_f32_32x32x16_bf16 v[16:31], a[84:87], v[68:71], v[16:31]
    ds_read_b128 v[64:67], v5 offset:25600
    s_waitcnt lgkmcnt(3)
    v_mfma_f32_32x32x16_bf16 v[16:31], a[88:91], v[72:75], v[16:31]
    ds_read_b128 v[68:71], v5 offset:26624
    s_waitcnt lgkmcnt(3)
    v_mfma_f32_32x32x16_bf16 v[16:31], a[92:95], v[76:79], v[16:31]
    ds_read_b128 v[72:75], v5 offset:27648
    s_waitcnt lgkmcnt(3)
    v_mfma_f32_32x32x16_bf16 v[16:31], a[96:99], v[80:83], v[16:31]
    ds_read_b128 v[76:79], v5 offset:28672
    s_waitcnt lgkmcnt(3)
    v_mfma_f32_32x32x16_bf16 v[16:31], a[100:103], v[64:67], v[16:31]
    ds_read_b128 v[80:83], v5 offset:29696
    s_waitcnt lgkmcnt(3)
    v_mfma_f32_32x32x16_bf16 v[16:31], a[104:107], v[68:71], v[16:31]
    ds_read_b128 v[64:67], v5 offset:30720
    s_waitcnt lgkmcnt(3)
    v_mfma_f32_32x32x16_bf16 v[16:31], a[108:111], v[72:75], v[16:31]
    ds_read_b128 v[68:71], v5 offset:31744
    s_waitcnt lgkmcnt(3)
    v_mfma_f32_32x32x16_bf16 v[16:31], a[112:115], v[76:79], v[16:31]
    s_waitcnt lgkmcnt(2)
    v_mfma_f32_32x32x16_bf16 v[16:31], a[116:119], v[80:83], v[16:31]
    s_waitcnt lgkmcnt(1)
    v_mfma_f32_32x32x16_bf16 v[16:31], a[120:123], v[64:67], v[16:31]
    s_waitcnt lgkmcnt(0)
    v_mfma_f32_32x32x16_bf16 v[16:31], a[124:127], v[68:71], v[16:31]
    s_nop 15
    s_nop 1
    s_waitcnt vmcnt(0)
    s_cmp_ge_u32 s16, 14
    s_cbranch_scc1 mega_kernel_sk142
    v_mov_b32 v50, 0
    v_mov_b32 v51, 0
    v_cvt_pk_bf16_f32 v49, v16, v17
    v_lshlrev_b32 v52, 16, v40
    v_and_b32 v53, 0xffff0000, v40
    v_lshlrev_b32 v16, 16, v49
    v_and_b32 v17, 0xffff0000, v49
    v_add_f32 v16, v16, v52
    v_add_f32 v17, v17, v53
    v_cvt_pk_bf16_f32 v40, v16, v17
    v_lshlrev_b32 v16, 16, v40
    v_and_b32 v17, 0xffff0000, v40
    v_add_f32 v50, v50, v16
    v_add_f32 v50, v50, v17
    v_fmac_f32 v51, v16, v16
    v_fmac_f32 v51, v17, v17
    v_cvt_pk_bf16_f32 v49, v18, v19
    v_lshlrev_b32 v52, 16, v41
    v_and_b32 v53, 0xffff0000, v41
    v_lshlrev_b32 v18, 16, v49
    v_and_b32 v19, 0xffff0000, v49
    v_add_f32 v18, v18, v52
    v_add_f32 v19, v19, v53
    v_cvt_pk_bf16_f32 v41, v18, v19
    v_lshlrev_b32 v18, 16, v41
    v_and_b32 v19, 0xffff0000, v41
    v_add_f32 v50, v50, v18
    v_add_f32 v50, v50, v19
    v_fmac_f32 v51, v18, v18
    v_fmac_f32 v51, v19, v19
    v_cvt_pk_bf16_f32 v49, v20, v21
    v_lshlrev_b32 v52, 16, v42
    v_and_b32 v53, 0xffff0000, v42
    v_lshlrev_b32 v20, 16, v49
    v_and_b32 v21, 0xffff0000, v49
    v_add_f32 v20, v20, v52
    v_add_f32 v21, v21, v53
    v_cvt_pk_bf16_f32 v42, v20, v21
    v_lshlrev_b32 v20, 16, v42
    v_and_b32 v21, 0xffff0000, v42
    v_add_f32 v50, v50, v20
    v_add_f32 v50, v50, v21
    v_fmac_f32 v51, v20, v20
    v_fmac_f32 v51, v21, v21
    v_cvt_pk_bf16_f32 v49, v22, v23
    v_lshlrev_b32 v52, 16, v43
    v_and_b32 v53, 0xffff0000, v43
    v_lshlrev_b32 v22, 16, v49
    v_and_b32 v23, 0xffff0000, v49
    v_add_f32 v22, v22, v52
    v_add_f32 v23, v23, v53
    v_cvt_pk_bf16_f32 v43, v22, v23
    v_lshlrev_b32 v22, 16, v43
    v_and_b32 v23, 0xffff0000, v43
    v_add_f32 v50, v50, v22
    v_add_f32 v50, v50, v23
    v_fmac_f32 v51, v22, v22
    v_fmac_f32 v51, v23, v23
    v_cvt_pk_bf16_f32 v49, v24, v25
    v_lshlrev_b32 v52, 16, v44
    v_and_b32 v53, 0xffff0000, v44
    v_lshlrev_b32 v24, 16, v49
    v_and_b32 v25, 0xffff0000, v49
    v_add_f32 v24, v24, v52
    v_add_f32 v25, v25, v53
    v_cvt_pk_bf16_f32 v44, v24, v25
    v_lshlrev_b32 v24, 16, v44
    v_and_b32 v25, 0xffff0000, v44
    v_add_f32 v50, v50, v24
    v_add_f32 v50, v50, v25
    v_fmac_f32 v51, v24, v24
    v_fmac_f32 v51, v25, v25
    v_cvt_pk_bf16_f32 v49, v26, v27
    v_lshlrev_b32 v52, 16, v45
    v_and_b32 v53, 0xffff0000, v45
    v_lshlrev_b32 v26, 16, v49
    v_and_b32 v27, 0xffff0000, v49
    v_add_f32 v26, v26, v52
    v_add_f32 v27, v27, v53
    v_cvt_pk_bf16_f32 v45, v26, v27
    v_lshlrev_b32 v26, 16, v45
    v_and_b32 v27, 0xffff0000, v45
    v_add_f32 v50, v50, v26
    v_add_f32 v50, v50, v27
    v_fmac_f32 v51, v26, v26
    v_fmac_f32 v51, v27, v27
    v_cvt_pk_bf16_f32 v49, v28, v29
    v_lshlrev_b32 v52, 16, v46
    v_and_b32 v53, 0xffff0000, v46
    v_lshlrev_b32 v28, 16, v49
    v_and_b32 v29, 0xffff0000, v49
    v_add_f32 v28, v28, v52
    v_add_f32 v29, v29, v53
    v_cvt_pk_bf16_f32 v46, v28, v29
    v_lshlrev_b32 v28, 16, v46
    v_and_b32 v29, 0xffff0000, v46
    v_add_f32 v50, v50, v28
    v_add_f32 v50, v50, v29
    v_fmac_f32 v51, v28, v28
    v_fmac_f32 v51, v29, v29
    v_cvt_pk_bf16_f32 v49, v30, v31
    v_lshlrev_b32 v52, 16, v47
    v_and_b32 v53, 0xffff0000, v47
    v_lshlrev_b32 v30, 16, v49
    v_and_b32 v31, 0xffff0000, v49
    v_add_f32 v30, v30, v52
    v_add_f32 v31, v31, v53
    v_cvt_pk_bf16_f32 v47, v30, v31
    v_lshlrev_b32 v30, 16, v47
    v_and_b32 v31, 0xffff0000, v47
    v_add_f32 v50, v50, v30
    v_add_f32 v50, v50, v31
    v_fmac_f32 v51, v30, v30
    v_fmac_f32 v51, v31, v31
    s_mul_i32 s6, s20, 28672
    s_add_u32 s6, s6, s28
    s_lshl_b32 s7, s16, 11
    s_add_u32 s6, s6, s7
    buffer_store_dwordx2 v[40:41], v60, s[44:47], s6 offen offset:0 sc1
    buffer_store_dwordx2 v[42:43], v60, s[44:47], s6 offen offset:512 sc1
    buffer_store_dwordx2 v[44:45], v60, s[44:47], s6 offen offset:1024 sc1
    buffer_store_dwordx2 v[46:47], v60, s[44:47], s6 offen offset:1536 sc1
    v_mov_b32 v52, v50
    v_mov_b32 v53, v51
    s_nop 1
    v_permlane32_swap_b32 v50, v52
    v_permlane32_swap_b32 v51, v53
    s_nop 1
    v_add_f32 v50, v50, v52
    v_add_f32 v51, v51, v53
    s_mul_i32 s6, s20, 3584
    s_add_u32 s6, s6, s29
    s_lshl_b32 s7, s16, 8
    s_add_u32 s6, s6, s7
    buffer_store_dwordx2 v[50:51], v59, s[44:47], s6 offen sc1
mega_kernel_sk142:
    s_add_u32 s20, s20, 1
    s_cmp_lt_u32 s20, 64
    s_cbranch_scc1 mega_kernel_gl141
    s_sub_u32 s20, s20, 1
    s_waitcnt vmcnt(0)
    s_barrier
    s_cmp_lg_u32 s3, 0
    s_cbranch_scc1 mega_kernel_sf147
    s_lshl_b32 s37, s20, 8
    s_lshl_b32 s33, s31, 14
    s_add_u32 s37, s37, s33
    s_lshl_b32 s33, s15, 2
    s_add_u32 s37, s37, s33
    s_add_u32 s37, s37, 200904704
    s_mov_b64 s[34:35], exec
    s_mov_b64 exec, 1
    v_mov_b32 v8, 1
    v_mov_b32 v9, 0
    buffer_store_dword v8, v9, s[44:47], s37 offen sc1
    s_mov_b64 exec, s[34:35]
mega_kernel_sf147:
    s_branch mega_kernel_done
mega_kernel_s66:
    s_sub_u32 s15, s15, 78
    s_lshr_b32 s20, s15, 2
    s_and_b32 s15, s15, 3
    s_lshl_b32 s16, s15, 2
    s_add_u32 s16, s16, s3
    s_mul_i32 s22, s31, 33554432
    s_add_u32 s22, s22, 44302336
    s_lshl_b32 s7, s16, 14
    s_add_u32 s22, s22, s7
    s_mul_i32 s23, s31, 4194304
    s_add_u32 s23, s23, 170135552
    s_lshl_b32 s7, s16, 12
    s_add_u32 s23, s23, s7
    s_mul_i32 s24, s31, 2621440
    s_add_u32 s24, s24, 193204224
    s_lshl_b32 s7, s16, 11
    s_add_u32 s25, s24, s7
    s_lshr_b32 s7, s16, 1
    s_lshl_b32 s7, s7, 10
    s_add_u32 s24, s24, s7
    s_and_b32 s7, s16, 1
    s_lshl_b32 s7, s7, 3
    s_add_u32 s24, s24, s7
    s_add_u32 s24, s24, 32768
    v_lshlrev_b32 v6, 7, v3
    v_lshl_add_u32 v6, v2, 4, v6
    v_mov_b32 v8, 2147483392
    v_cmp_gt_u32 vcc, 8, v2
    s_nop 1
    v_cndmask_b32 v6, v8, v6, vcc
    v_lshlrev_b32 v7, 2, v3
    v_sub_u32 v7, v2, v7
    s_mov_b32 s19, 0x3db8aa3b
mega_kernel_sl148:
    s_lshl_b32 s37, s20, 8
    s_lshl_b32 s33, s31, 14
    s_add_u32 s37, s37, s33
    s_add_u32 s37, s37, 200937472
    v_lshlrev_b32 v9, 2, v62
    v_cmp_gt_u32 s[38:39], 60, v62
    s_mov_b32 s12, 0
mega_kernel_fp149:
    buffer_load_dword v8, v9, s[44:47], s37 offen sc1
    s_waitcnt vmcnt(0)
    v_cmp_eq_u32 vcc, 0, v8
    s_and_b64 s[40:41], vcc, s[38:39]
    s_cbranch_scc0 mega_kernel_fo150
    s_sleep 1
    s_add_u32 s12, s12, 1
    s_cmp_lt_u32 s12, 2000000
    s_cbranch_scc1 mega_kernel_fp149
mega_kernel_fo150:
    s_lshl_b32 s9, s20, 19
    s_add_u32 s9, s9, s22
    s_add_u32 s10, s9, 262144
    v_mov_b32 v4, v5
    buffer_load_dwordx4 a[0:3], v4, s[44:47], s9 offen offset:0 sc1
    buffer_load_dwordx4 a[64:67], v4, s[44:47], s10 offen offset:0 sc1
    buffer_load_dwordx4 a[4:7], v4, s[44:47], s9 offen offset:1024 sc1
    buffer_load_dwordx4 a[68:71], v4, s[44:47], s10 offen offset:1024 sc1
    buffer_load_dwordx4 a[8:11], v4, s[44:47], s9 offen offset:2048 sc1
    buffer_load_dwordx4 a[72:75], v4, s[44:47], s10 offen offset:2048 sc1
    buffer_load_dwordx4 a[12:15], v4, s[44:47], s9 offen offset:3072 sc1
    buffer_load_dwordx4 a[76:79], v4, s[44:47], s10 offen offset:3072 sc1
    v_add_u32 v4, 4096, v4
    buffer_load_dwordx4 a[16:19], v4, s[44:47], s9 offen offset:0 sc1
    buffer_load_dwordx4 a[80:83], v4, s[44:47], s10 offen offset:0 sc1
    buffer_load_dwordx4 a[20:23], v4, s[44:47], s9 offen offset:1024 sc1
    buffer_load_dwordx4 a[84:87], v4, s[44:47], s10 offen offset:1024 sc1
    buffer_load_dwordx4 a[24:27], v4, s[44:47], s9 offen offset:2048 sc1
    buffer_load_dwordx4 a[88:91], v4, s[44:47], s10 offen offset:2048 sc1
    buffer_load_dwordx4 a[28:31], v4, s[44:47], s9 offen offset:3072 sc1
    buffer_load_dwordx4 a[92:95], v4, s[44:47], s10 offen offset:3072 sc1
    v_add_u32 v4, 4096, v4
    buffer_load_dwordx4 a[32:35], v4, s[44:47], s9 offen offset:0 sc1
    buffer_load_dwordx4 a[96:99], v4, s[44:47], s10 offen offset:0 sc1
    buffer_load_dwordx4 a[36:39], v4, s[44:47], s9 offen offset:1024 sc1
    buffer_load_dwordx4 a[100:103], v4, s[44:47], s10 offen offset:1024 sc1
    buffer_load_dwordx4 a[40:43], v4, s[44:47], s9 offen offset:2048 sc1
    buffer_load_dwordx4 a[104:107], v4, s[44:47], s10 offen offset:2048 sc1
    buffer_load_dwordx4 a[44:47], v4, s[44:47], s9 offen offset:3072 sc1
    buffer_load_dwordx4 a[108:111], v4, s[44:47], s10 offen offset:3072 sc1
    v_add_u32 v4, 4096, v4
    buffer_load_dwordx4 a[48:51], v4, s[44:47], s9 offen offset:0 sc1
    buffer_load_dwordx4 a[112:115], v4, s[44:47], s10 offen offset:0 sc1
    buffer_load_dwordx4 a[52:55], v4, s[44:47], s9 offen offset:1024 sc1
    buffer_load_dwordx4 a[116:119], v4, s[44:47], s10 offen offset:1024 sc1
    buffer_load_dwordx4 a[56:59], v4, s[44:47], s9 offen offset:2048 sc1
    buffer_load_dwordx4 a[120:123], v4, s[44:47], s10 offen offset:2048 sc1
    buffer_load_dwordx4 a[60:63], v4, s[44:47], s9 offen offset:3072 sc1
    buffer_load_dwordx4 a[124:127], v4, s[44:47], s10 offen offset:3072 sc1
    s_waitcnt vmcnt(0)
    v_mfma_f32_32x32x16_bf16 v[16:31], a[64:67], a[0:3], 0
    v_mfma_f32_32x32x16_bf16 v[16:31], a[68:71], a[4:7], v[16:31]
    v_mfma_f32_32x32x16_bf16 v[16:31], a[72:75], a[8:11], v[16:31]
    v_mfma_f32_32x32x16_bf16 v[16:31], a[76:79], a[12:15], v[16:31]
    v_mfma_f32_32x32x16_bf16 v[16:31], a[80:83], a[16:19], v[16:31]
    v_mfma_f32_32x32x16_bf16 v[16:31], a[84:87], a[20:23], v[16:31]
    v_mfma_f32_32x32x16_bf16 v[16:31], a[88:91], a[24:27], v[16:31]
    v_mfma_f32_32x32x16_bf16 v[16:31], a[92:95], a[28:31], v[16:31]
    v_mfma_f32_32x32x16_bf16 v[16:31], a[96:99], a[32:35], v[16:31]
    v_mfma_f32_32x32x16_bf16 v[16:31], a[100:103], a[36:39], v[16:31]
    v_mfma_f32_32x32x16_bf16 v[16:31], a[104:107], a[40:43], v[16:31]
    v_mfma_f32_32x32x16_bf16 v[16:31], a[108:111], a[44:47], v[16:31]
    v_mfma_f32_32x32x16_bf16 v[16:31], a[112:115], a[48:51], v[16:31]
    v_mfma_f32_32x32x16_bf16 v[16:31], a[116:119], a[52:55], v[16:31]
    v_mfma_f32_32x32x16_bf16 v[16:31], a[120:123], a[56:59], v[16:31]
    v_mfma_f32_32x32x16_bf16 v[16:31], a[124:127], a[60:63], v[16:31]
    s_lshl_b32 s37, s20, 8
    s_lshl_b32 s33, s31, 14
    s_add_u32 s37, s37, s33
    s_add_u32 s37, s37, 200970240
    v_lshlrev_b32 v9, 2, v62
    v_cmp_gt_u32 s[38:39], 16, v62
    s_mov_b32 s12, 0
mega_kernel_fp151:
    buffer_load_dword v8, v9, s[44:47], s37 offen sc1
    s_waitcnt vmcnt(0)
    v_cmp_eq_u32 vcc, 0, v8
    s_and_b64 s[40:41], vcc, s[38:39]
    s_cbranch_scc0 mega_kernel_fo152
    s_sleep 1
    s_add_u32 s12, s12, 1
    s_cmp_lt_u32 s12, 2000000
    s_cbranch_scc1 mega_kernel_fp151
mega_kernel_fo152:
    s_lshl_b32 s11, s20, 16
    s_add_u32 s11, s11, s23
    buffer_load_dwordx4 v[64:67], v6, s[44:47], s11 offen offset:0 sc1
    buffer_load_dwordx4 v[68:71], v6, s[44:47], s11 offen offset:256 sc1
    buffer_load_dwordx4 v[72:75], v6, s[44:47], s11 offen offset:512 sc1
    buffer_load_dwordx4 v[76:79], v6, s[44:47], s11 offen offset:768 sc1
    buffer_load_dwordx4 v[80:83], v6, s[44:47], s11 offen offset:1024 sc1
    buffer_load_dwordx4 v[84:87], v6, s[44:47], s11 offen offset:1280 sc1
    buffer_load_dwordx4 v[88:91], v6, s[44:47], s11 offen offset:1536 sc1
    buffer_load_dwordx4 v[92:95], v6, s[44:47], s11 offen offset:1792 sc1
    buffer_load_dwordx4 v[96:99], v6, s[44:47], s11 offen offset:2048 sc1
    buffer_load_dwordx4 v[100:103], v6, s[44:47], s11 offen offset:2304 sc1
    buffer_load_dwordx4 v[104:107], v6, s[44:47], s11 offen offset:2560 sc1
    buffer_load_dwordx4 v[108:111], v6, s[44:47], s11 offen offset:2816 sc1
    buffer_load_dwordx4 v[112:115], v6, s[44:47], s11 offen offset:3072 sc1
    buffer_load_dwordx4 v[116:119], v6, s[44:47], s11 offen offset:3328 sc1
    buffer_load_dwordx4 v[120:123], v6, s[44:47], s11 offen offset:3584 sc1
    buffer_load_dwordx4 v[124:127], v6, s[44:47], s11 offen offset:3840 sc1
    v_mov_b32 v8, 0xff800000
    v_cmp_le_i32 vcc, 0, v7
    s_nop 1
    v_cndmask_b32 v16, v8, v16, vcc
    v_cmp_le_i32 vcc, 1, v7
    s_nop 1
    v_cndmask_b32 v17, v8, v17, vcc
    v_cmp_le_i32 vcc, 2, v7
    s_nop 1
    v_cndmask_b32 v18, v8, v18, vcc
    v_cmp_le_i32 vcc, 3, v7
    s_nop 1
    v_cndmask_b32 v19, v8, v19, vcc
    v_cmp_le_i32 vcc, 8, v7
    s_nop 1
    v_cndmask_b32 v20, v8, v20, vcc
    v_cmp_le_i32 vcc, 9, v7
    s_nop 1
    v_cndmask_b32 v21, v8, v21, vcc
    v_cmp_le_i32 vcc, 10, v7
    s_nop 1
    v_cndmask_b32 v22, v8, v22, vcc
    v_cmp_le_i32 vcc, 11, v7
    s_nop 1
    v_cndmask_b32 v23, v8, v23, vcc
    v_cmp_le_i32 vcc, 16, v7
    s_nop 1
    v_cndmask_b32 v24, v8, v24, vcc
    v_cmp_le_i32 vcc, 17, v7
    s_nop 1
    v_cndmask_b32 v25, v8, v25, vcc
    v_cmp_le_i32 vcc, 18, v7
    s_nop 1
    v_cndmask_b32 v26, v8, v26, vcc
    v_cmp_le_i32 vcc, 19, v7
    s_nop 1
    v_cndmask_b32 v27, v8, v27, vcc
    v_cmp_le_i32 vcc, 24, v7
    s_nop 1
    v_cndmask_b32 v28, v8, v28, vcc
    v_cmp_le_i32 vcc, 25, v7
    s_nop 1
    v_cndmask_b32 v29, v8, v29, vcc
    v_cmp_le_i32 vcc, 26, v7
    s_nop 1
    v_cndmask_b32 v30, v8, v30, vcc
    v_cmp_le_i32 vcc, 27, v7
    s_nop 1
    v_cndmask_b32 v31, v8, v31, vcc
    v_max_f32 v10, v16, v17
    v_max3_f32 v10, v10, v18, v19
    v_max3_f32 v10, v10, v20, v21
    v_max3_f32 v10, v10, v22, v23
    v_max3_f32 v10, v10, v24, v25
    v_max3_f32 v10, v10, v26, v27
    v_max3_f32 v10, v10, v28, v29
    v_max3_f32 v10, v10, v30, v31
    s_waitcnt vmcnt(0)
    v_mfma_f32_32x32x16_bf16 v[32:47], v[64:67], a[0:3], 0
    v_mfma_f32_32x32x16_bf16 v[32:47], v[68:71], a[4:7], v[32:47]
    v_mfma_f32_32x32x16_bf16 v[32:47], v[72:75], a[8:11], v[32:47]
    v_mfma_f32_32x32x16_bf16 v[32:47], v[76:79], a[12:15], v[32:47]
    v_mfma_f32_32x32x16_bf16 v[32:47], v[80:83], a[16:19], v[32:47]
    v_mfma_f32_32x32x16_bf16 v[32:47], v[84:87], a[20:23], v[32:47]
    v_mfma_f32_32x32x16_bf16 v[32:47], v[88:91], a[24:27], v[32:47]
    v_mfma_f32_32x32x16_bf16 v[32:47], v[92:95], a[28:31], v[32:47]
    v_mfma_f32_32x32x16_bf16 v[32:47], v[96:99], a[32:35], v[32:47]
    v_mfma_f32_32x32x16_bf16 v[32:47], v[100:103], a[36:39], v[32:47]
    v_mfma_f32_32x32x16_bf16 v[32:47], v[104:107], a[40:43], v[32:47]
    v_mfma_f32_32x32x16_bf16 v[32:47], v[108:111], a[44:47], v[32:47]
    v_mfma_f32_32x32x16_bf16 v[32:47], v[112:115], a[48:51], v[32:47]
    v_mfma_f32_32x32x16_bf16 v[32:47], v[116:119], a[52:55], v[32:47]
    v_mfma_f32_32x32x16_bf16 v[32:47], v[120:123], a[56:59], v[32:47]
    v_mfma_f32_32x32x16_bf16 v[32:47], v[124:127], a[60:63], v[32:47]
    s_nop 15
    s_nop 3
    v_max3_f32 v10, v10, v32, v33
    v_max3_f32 v10, v10, v34, v35
    v_mov_b32 v11, v10
    s_nop 1
    v_permlane32_swap_b32 v10, v11
    s_nop 1
    v_max_f32 v10, v10, v11
    v_mul_f32 v10, s19, v10
    v_fma_f32 v16, v16, s19, -v10
    v_fma_f32 v17, v17, s19, -v10
    v_fma_f32 v18, v18, s19, -v10
    v_fma_f32 v19, v19, s19, -v10
    v_fma_f32 v20, v20, s19, -v10
    v_fma_f32 v21, v21, s19, -v10
    v_fma_f32 v22, v22, s19, -v10
    v_fma_f32 v23, v23, s19, -v10
    v_fma_f32 v24, v24, s19, -v10
    v_fma_f32 v25, v25, s19, -v10
    v_fma_f32 v26, v26, s19, -v10
    v_fma_f32 v27, v27, s19, -v10
    v_fma_f32 v28, v28, s19, -v10
    v_fma_f32 v29, v29, s19, -v10
    v_fma_f32 v30, v30, s19, -v10
    v_fma_f32 v31, v31, s19, -v10
    v_fma_f32 v32, v32, s19, -v10
    v_fma_f32 v33, v33, s19, -v10
    v_fma_f32 v34, v34, s19, -v10
    v_fma_f32 v35, v35, s19, -v10
    v_exp_f32 v16, v16
    v_exp_f32 v17, v17
    v_exp_f32 v18, v18
    v_exp_f32 v19, v19
    v_exp_f32 v20, v20
    v_exp_f32 v21, v21
    v_exp_f32 v22, v22
    v_exp_f32 v23, v23
    v_exp_f32 v24, v24
    v_exp_f32 v25, v25
    v_exp_f32 v26, v26
    v_exp_f32 v27, v27
    v_exp_f32 v28, v28
    v_exp_f32 v29, v29
    v_exp_f32 v30, v30
    v_exp_f32 v31, v31
    v_exp_f32 v32, v32
    v_exp_f32 v33, v33
    v_exp_f32 v34, v34
    v_exp_f32 v35, v35
    s_nop 0
    v_add_f32 v10, v16, v17
    v_add_f32 v11, v18, v19
    v_add_f32 v10, v10, v20
    v_add_f32 v11, v11, v21
    v_add_f32 v10, v10, v22
    v_add_f32 v11, v11, v23
    v_add_f32 v10, v10, v24
    v_add_f32 v11, v11, v25
    v_add_f32 v10, v10, v26
    v_add_f32 v11, v11, v27
    v_add_f32 v10, v10, v28
    v_add_f32 v11, v11, v29
    v_add_f32 v10, v10, v30
    v_add_f32 v11, v11, v31
    v_add_f32 v10, v10, v32
    v_add_f32 v11, v11, v33
    v_add_f32 v10, v10, v34
    v_add_f32 v11, v11, v35
    v_add_f32 v10, v10, v11
    v_mov_b32 v11, v10
    s_nop 1
    v_permlane32_swap_b32 v10, v11
    s_nop 1
    v_add_f32 v10, v10, v11
    v_rcp_f32 v10, v10
    s_nop 0
    v_mul_f32 v16, v16, v10
    v_mul_f32 v17, v17, v10
    v_mul_f32 v18, v18, v10
    v_mul_f32 v19, v19, v10
    v_mul_f32 v20, v20, v10
    v_mul_f32 v21, v21, v10
    v_mul_f32 v22, v22, v10
    v_mul_f32 v23, v23, v10
    v_mul_f32 v24, v24, v10
    v_mul_f32 v25, v25, v10
    v_mul_f32 v26, v26, v10
    v_mul_f32 v27, v27, v10
    v_mul_f32 v28, v28, v10
    v_mul_f32 v29, v29, v10
    v_mul_f32 v30, v30, v10
    v_mul_f32 v31, v31, v10
    v_mul_f32 v32, v32, v10
    v_mul_f32 v33, v33, v10
    v_mul_f32 v34, v34, v10
    v_mul_f32 v35, v35, v10
    v_cvt_pk_bf16_f32 v48, v16, v17
    v_cvt_pk_bf16_f32 v49, v18, v19
    v_cvt_pk_bf16_f32 v50, v20, v21
    v_cvt_pk_bf16_f32 v51, v22, v23
    v_cvt_pk_bf16_f32 v52, v24, v25
    v_cvt_pk_bf16_f32 v53, v26, v27
    v_cvt_pk_bf16_f32 v54, v28, v29
    v_cvt_pk_bf16_f32 v55, v30, v31
    v_cvt_pk_bf16_f32 v56, v32, v33
    v_cvt_pk_bf16_f32 v57, v34, v35
    s_mul_i32 s9, s20, 40960
    s_add_u32 s10, s9, s24
    s_add_u32 s9, s9, s25
    buffer_store_dwordx4 v[48:51], v5, s[44:47], s9 offen sc1
    buffer_store_dwordx4 v[52:55], v5, s[44:47], s9 offen offset:1024 sc1
    buffer_store_dwordx2 v[56:57], v5, s[44:47], s10 offen sc1
    s_waitcnt vmcnt(0)
    s_barrier
    s_cmp_lg_u32 s3, 0
    s_cbranch_scc1 mega_kernel_sf153
    s_lshl_b32 s37, s20, 8
    s_lshl_b32 s33, s31, 14
    s_add_u32 s37, s37, s33
    s_lshl_b32 s33, s15, 2
    s_add_u32 s37, s37, s33
    s_add_u32 s37, s37, 201003008
    s_mov_b64 s[34:35], exec
    s_mov_b64 exec, 1
    v_mov_b32 v8, 1
    v_mov_b32 v9, 0
    buffer_store_dword v8, v9, s[44:47], s37 offen sc1
    s_mov_b64 exec, s[34:35]
mega_kernel_sf153:
    s_add_u32 s20, s20, 2
    s_cmp_lt_u32 s20, 64
    s_cbranch_scc1 mega_kernel_sl148
    s_branch mega_kernel_done
mega_kernel_z67:
    s_sub_u32 s15, s15, 86
    s_lshr_b32 s20, s15, 2
    s_and_b32 s15, s15, 3
    s_lshl_b32 s16, s15, 2
    s_add_u32 s16, s16, s3
    s_lshl_b32 s26, s31, 1
    s_add_u32 s26, s26, 1
    s_add_u32 s28, s26, 1
    s_mul_i32 s29, s28, 229376
    s_add_u32 s29, s29, 7340032
    s_mul_i32 s28, s28, 1835008
    s_add_u32 s28, s28, 0
    s_mul_i32 s26, s26, 1835008
    s_add_u32 s26, s26, 0
    v_lshlrev_b32 v60, 4, v2
    v_lshl_add_u32 v60, v3, 3, v60
    v_lshlrev_b32 v59, 3, v2
    v_mov_b32 v8, 2147483392
    v_cmp_eq_u32 vcc, 0, v3
    s_nop 1
    v_cndmask_b32 v59, v8, v59, vcc
    s_min_u32 s17, s16, 13
    s_mul_i32 s22, s31, 29360128
    s_add_u32 s22, s22, 111411200
    s_lshl_b32 s7, s17, 11
    s_add_u32 s22, s22, s7
    s_mul_i32 s23, s31, 7340032
    s_add_u32 s23, s23, 178524160
    s_lshl_b32 s7, s17, 5
    v_add_u32 v8, s7, v2
    v_mul_u32_u24 v9, 2341, v8
    v_lshrrev_b32 v9, 16, v9
    v_mul_u32_u24 v10, 28, v9
    v_sub_u32 v10, v8, v10
    v_mul_u32_u24 v58, 7168, v9
    v_lshl_add_u32 v58, v10, 4, v58
    v_lshl_add_u32 v58, v3, 3, v58
    s_mul_i32 s24, s31, 2621440
    s_add_u32 s24, s24, 193204224
    s_mul_i32 s7, s3, 10240
    s_add_u32 s24, s24, s7
mega_kernel_zl154:
    s_lshl_b32 s37, s20, 8
    s_lshl_b32 s33, s31, 14
    s_add_u32 s37, s37, s33
    s_add_u32 s37, s37, 200937472
    v_lshlrev_b32 v9, 2, v62
    v_cmp_gt_u32 s[38:39], 60, v62
    s_mov_b32 s12, 0
mega_kernel_fp158:
    buffer_load_dword v8, v9, s[44:47], s37 offen sc1
    s_waitcnt vmcnt(0)
    v_cmp_eq_u32 vcc, 0, v8
    s_and_b64 s[40:41], vcc, s[38:39]
    s_cbranch_scc0 mega_kernel_fo159
    s_sleep 1
    s_add_u32 s12, s12, 1
    s_cmp_lt_u32 s12, 2000000
    s_cbranch_scc1 mega_kernel_fp158
mega_kernel_fo159:
    s_mul_i32 s8, s20, 458752
    s_add_u32 s8, s8, s22
    s_add_u32 s10, s8, 0
    buffer_load_dwordx4 a[0:3], v5, s[44:47], s10 offen offset:0 sc1
    s_add_u32 s10, s8, 0
    buffer_load_dwordx4 a[4:7], v5, s[44:47], s10 offen offset:1024 sc1
    s_add_u32 s10, s8, 28672
    buffer_load_dwordx4 a[8:11], v5, s[44:47], s10 offen offset:0 sc1
    s_add_u32 s10, s8, 28672
    buffer_load_dwordx4 a[12:15], v5, s[44:47], s10 offen offset:1024 sc1
    s_add_u32 s10, s8, 57344
    buffer_load_dwordx4 a[16:19], v5, s[44:47], s10 offen offset:0 sc1
    s_add_u32 s10, s8, 57344
    buffer_load_dwordx4 a[20:23], v5, s[44:47], s10 offen offset:1024 sc1
    s_add_u32 s10, s8, 86016
    buffer_load_dwordx4 a[24:27], v5, s[44:47], s10 offen offset:0 sc1
    s_add_u32 s10, s8, 86016
    buffer_load_dwordx4 a[28:31], v5, s[44:47], s10 offen offset:1024 sc1
    s_add_u32 s10, s8, 114688
    buffer_load_dwordx4 a[32:35], v5, s[44:47], s10 offen offset:0 sc1
    s_add_u32 s10, s8, 114688
    buffer_load_dwordx4 a[36:39], v5, s[44:47], s10 offen offset:1024 sc1
    s_add_u32 s10, s8, 143360
    buffer_load_dwordx4 a[40:43], v5, s[44:47], s10 offen offset:0 sc1
    s_add_u32 s10, s8, 143360
    buffer_load_dwordx4 a[44:47], v5, s[44:47], s10 offen offset:1024 sc1
    s_add_u32 s10, s8, 172032
    buffer_load_dwordx4 a[48:51], v5, s[44:47], s10 offen offset:0 sc1
    s_add_u32 s10, s8, 172032
    buffer_load_dwordx4 a[52:55], v5, s[44:47], s10 offen offset:1024 sc1
    s_add_u32 s10, s8, 200704
    buffer_load_dwordx4 a[56:59], v5, s[44:47], s10 offen offset:0 sc1
    s_add_u32 s10, s8, 200704
    buffer_load_dwordx4 a[60:63], v5, s[44:47], s10 offen offset:1024 sc1
    s_add_u32 s10, s8, 229376
    buffer_load_dwordx4 a[64:67], v5, s[44:47], s10 offen offset:0 sc1
    s_add_u32 s10, s8, 229376
    buffer_load_dwordx4 a[68:71], v5, s[44:47], s10 offen offset:1024 sc1
    s_add_u32 s10, s8, 258048
    buffer_load_dwordx4 a[72:75], v5, s[44:47], s10 offen offset:0 sc1
    s_add_u32 s10, s8, 258048
    buffer_load_dwordx4 a[76:79], v5, s[44:47], s10 offen offset:1024 sc1
    s_add_u32 s10, s8, 286720
    buffer_load_dwordx4 a[80:83], v5, s[44:47], s10 offen offset:0 sc1
    s_add_u32 s10, s8, 286720
    buffer_load_dwordx4 a[84:87], v5, s[44:47], s10 offen offset:1024 sc1
    s_add_u32 s10, s8, 315392
    buffer_load_dwordx4 a[88:91], v5, s[44:47], s10 offen offset:0 sc1
    s_add_u32 s10, s8, 315392
    buffer_load_dwordx4 a[92:95], v5, s[44:47], s10 offen offset:1024 sc1
    s_add_u32 s10, s8, 344064
    buffer_load_dwordx4 a[96:99], v5, s[44:47], s10 offen offset:0 sc1
    s_add_u32 s10, s8, 344064
    buffer_load_dwordx4 a[100:103], v5, s[44:47], s10 offen offset:1024 sc1
    s_add_u32 s10, s8, 372736
    buffer_load_dwordx4 a[104:107], v5, s[44:47], s10 offen offset:0 sc1
    s_add_u32 s10, s8, 372736
    buffer_load_dwordx4 a[108:111], v5, s[44:47], s10 offen offset:1024 sc1
    s_add_u32 s10, s8, 401408
    buffer_load_dwordx4 a[112:115], v5, s[44:47], s10 offen offset:0 sc1
    s_add_u32 s10, s8, 401408
    buffer_load_dwordx4 a[116:119], v5, s[44:47], s10 offen offset:1024 sc1
    s_add_u32 s10, s8, 430080
    buffer_load_dwordx4 a[120:123], v5, s[44:47], s10 offen offset:0 sc1
    s_add_u32 s10, s8, 430080
    buffer_load_dwordx4 a[124:127], v5, s[44:47], s10 offen offset:1024 sc1
    s_mov_b32 s18, s16
    s_mov_b32 s16, s17
    s_mul_i32 s6, s20, 28672
    s_add_u32 s6, s6, s26
    s_lshl_b32 s7, s16, 11
    s_add_u32 s6, s6, s7
    buffer_load_dwordx2 v[40:41], v60, s[44:47], s6 offen offset:0 sc1
    buffer_load_dwordx2 v[42:43], v60, s[44:47], s6 offen offset:512 sc1
    buffer_load_dwordx2 v[44:45], v60, s[44:47], s6 offen offset:1024 sc1
    buffer_load_dwordx2 v[46:47], v60, s[44:47], s6 offen offset:1536 sc1
    s_mov_b32 s16, s18
    s_lshl_b32 s37, s20, 8
    s_lshl_b32 s33, s31, 14
    s_add_u32 s37, s37, s33
    s_add_u32 s37, s37, 201003008
    v_lshlrev_b32 v9, 2, v62
    v_cmp_gt_u32 s[38:39], 4, v62
    s_mov_b32 s12, 0
mega_kernel_fp160:
    buffer_load_dword v8, v9, s[44:47], s37 offen sc1
    s_waitcnt vmcnt(0)
    v_cmp_eq_u32 vcc, 0, v8
    s_and_b64 s[40:41], vcc, s[38:39]
    s_cbranch_scc0 mega_kernel_fo161
    s_sleep 1
    s_add_u32 s12, s12, 1
    s_cmp_lt_u32 s12, 2000000
    s_cbranch_scc1 mega_kernel_fp160
mega_kernel_fo161:
    s_mul_i32 s9, s20, 40960
    s_add_u32 s9, s9, s24
    v_add_u32 v4, 4096, v5
    v_add_u32 v6, 8192, v5
    buffer_load_dwordx4 v[64:67], v5, s[44:47], s9 offen offset:0 sc1
    buffer_load_dwordx4 v[68:71], v5, s[44:47], s9 offen offset:1024 sc1
    buffer_load_dwordx4 v[72:75], v5, s[44:47], s9 offen offset:2048 sc1
    buffer_load_dwordx4 v[76:79], v5, s[44:47], s9 offen offset:3072 sc1
    buffer_load_dwordx4 v[80:83], v4, s[44:47], s9 offen offset:0 sc1
    buffer_load_dwordx4 v[84:87], v4, s[44:47], s9 offen offset:1024 sc1
    buffer_load_dwordx4 v[88:91], v4, s[44:47], s9 offen offset:2048 sc1
    buffer_load_dwordx4 v[92:95], v4, s[44:47], s9 offen offset:3072 sc1
    buffer_load_dwordx4 v[96:99], v6, s[44:47], s9 offen offset:0 sc1
    buffer_load_dwordx4 v[100:103], v6, s[44:47], s9 offen offset:1024 sc1
    s_lshl_b32 s37, s20, 8
    s_lshl_b32 s33, s31, 14
    s_add_u32 s37, s37, s33
    s_add_u32 s37, s37, 200970304
    v_lshlrev_b32 v9, 2, v62
    v_cmp_gt_u32 s[38:39], 16, v62
    s_mov_b32 s12, 0
mega_kernel_fp162:
    buffer_load_dword v8, v9, s[44:47], s37 offen sc1
    s_waitcnt vmcnt(0)
    v_cmp_eq_u32 vcc, 0, v8
    s_and_b64 s[40:41], vcc, s[38:39]
    s_cbranch_scc0 mega_kernel_fo163
    s_sleep 1
    s_add_u32 s12, s12, 1
    s_cmp_lt_u32 s12, 2000000
    s_cbranch_scc1 mega_kernel_fp162
mega_kernel_fo163:
    s_mul_i32 s9, s20, 114688
    s_add_u32 s9, s9, s23
    s_add_u32 s10, s9, 0
    buffer_load_dwordx2 a[128:129], v58, s[44:47], s10 offen offset:0 sc1
    buffer_load_dwordx2 a[130:131], v58, s[44:47], s10 offen offset:448 sc1
    buffer_load_dwordx2 a[132:133], v58, s[44:47], s10 offen offset:896 sc1
    buffer_load_dwordx2 a[134:135], v58, s[44:47], s10 offen offset:1344 sc1
    s_add_u32 s10, s9, 1792
    buffer_load_dwordx2 a[136:137], v58, s[44:47], s10 offen offset:0 sc1
    buffer_load_dwordx2 a[138:139], v58, s[44:47], s10 offen offset:448 sc1
    buffer_load_dwordx2 a[140:141], v58, s[44:47], s10 offen offset:896 sc1
    buffer_load_dwordx2 a[142:143], v58, s[44:47], s10 offen offset:1344 sc1
    s_add_u32 s10, s9, 3584
    buffer_load_dwordx2 a[144:145], v58, s[44:47], s10 offen offset:0 sc1
    buffer_load_dwordx2 a[146:147], v58, s[44:47], s10 offen offset:448 sc1
    buffer_load_dwordx2 a[148:149], v58, s[44:47], s10 offen offset:896 sc1
    buffer_load_dwordx2 a[150:151], v58, s[44:47], s10 offen offset:1344 sc1
    s_add_u32 s10, s9, 5376
    buffer_load_dwordx2 a[152:153], v58, s[44:47], s10 offen offset:0 sc1
    buffer_load_dwordx2 a[154:155], v58, s[44:47], s10 offen offset:448 sc1
    buffer_load_dwordx2 a[156:157], v58, s[44:47], s10 offen offset:896 sc1
    buffer_load_dwordx2 a[158:159], v58, s[44:47], s10 offen offset:1344 sc1
    s_mul_i32 s7, s3, 10240
    v_add_u32 v4, s7, v5
    ds_write_b128 v4, v[64:67] offset:0
    ds_write_b128 v4, v[68:71] offset:1024
    ds_write_b128 v4, v[72:75] offset:2048
    ds_write_b128 v4, v[76:79] offset:3072
    ds_write_b128 v4, v[80:83] offset:4096
    ds_write_b128 v4, v[84:87] offset:5120
    ds_write_b128 v4, v[88:91] offset:6144
    ds_write_b128 v4, v[92:95] offset:7168
    ds_write_b128 v4, v[96:99] offset:8192
    ds_write_b128 v4, v[100:103] offset:9216
    s_waitcnt lgkmcnt(0)
    s_barrier
    ds_read_b128 v[64:67], v5 offset:0
    ds_read_b128 v[68:71], v5 offset:1024
    ds_read_b128 v[72:75], v5 offset:2048
    ds_read_b128 v[76:79], v5 offset:3072
    s_waitcnt lgkmcnt(3)
    v_mfma_f32_32x32x16_bf16 v[16:31], a[0:3], v[64:67], 0
    ds_read_b128 v[80:83], v5 offset:4096
    s_waitcnt lgkmcnt(3)
    v_mfma_f32_32x32x16_bf16 v[16:31], a[4:7], v[68:71], v[16:31]
    ds_read_b128 v[64:67], v5 offset:5120
    s_waitcnt lgkmcnt(3)
    v_mfma_f32_32x32x16_bf16 v[16:31], a[8:11], v[72:75], v[16:31]
    ds_read_b128 v[68:71], v5 offset:6144
    s_waitcnt lgkmcnt(3)
    v_mfma_f32_32x32x16_bf16 v[16:31], a[12:15], v[76:79], v[16:31]
    ds_read_b128 v[72:75], v5 offset:7168
    s_waitcnt lgkmcnt(3)
    v_mfma_f32_32x32x16_bf16 v[16:31], a[16:19], v[80:83], v[16:31]
    ds_read_b128 v[76:79], v5 offset:8192
    s_waitcnt lgkmcnt(3)
    v_mfma_f32_32x32x16_bf16 v[16:31], a[20:23], v[64:67], v[16:31]
    ds_read_b128 v[80:83], v5 offset:9216
    s_waitcnt lgkmcnt(3)
    v_mfma_f32_32x32x16_bf16 v[16:31], a[24:27], v[68:71], v[16:31]
    ds_read_b128 v[64:67], v5 offset:10240
    s_waitcnt lgkmcnt(3)
    v_mfma_f32_32x32x16_bf16 v[16:31], a[28:31], v[72:75], v[16:31]
    ds_read_b128 v[68:71], v5 offset:11264
    s_waitcnt lgkmcnt(3)
    v_mfma_f32_32x32x16_bf16 v[16:31], a[32:35], v[76:79], v[16:31]
    ds_read_b128 v[72:75], v5 offset:12288
    s_waitcnt lgkmcnt(3)
    v_mfma_f32_32x32x16_bf16 v[16:31], a[36:39], v[80:83], v[16:31]
    ds_read_b128 v[76:79], v5 offset:13312
    s_waitcnt lgkmcnt(3)
    v_mfma_f32_32x32x16_bf16 v[16:31], a[40:43], v[64:67], v[16:31]
    ds_read_b128 v[80:83], v5 offset:14336
    s_waitcnt lgkmcnt(3)
    v_mfma_f32_32x32x16_bf16 v[16:31], a[44:47], v[68:71], v[16:31]
    ds_read_b128 v[64:67], v5 offset:15360
    s_waitcnt lgkmcnt(3)
    v_mfma_f32_32x32x16_bf16 v[16:31], a[48:51], v[72:75], v[16:31]
    ds_read_b128 v[68:71], v5 offset:16384
    s_waitcnt lgkmcnt(3)
    v_mfma_f32_32x32x16_bf16 v[16:31], a[52:55], v[76:79], v[16:31]
    ds_read_b128 v[72:75], v5 offset:17408
    s_waitcnt lgkmcnt(3)
    v_mfma_f32_32x32x16_bf16 v[16:31], a[56:59], v[80:83], v[16:31]
    ds_read_b128 v[76:79], v5 offset:18432
    s_waitcnt lgkmcnt(3)
    v_mfma_f32_32x32x16_bf16 v[16:31], a[60:63], v[64:67], v[16:31]
    ds_read_b128 v[80:83], v5 offset:19456
    s_waitcnt lgkmcnt(3)
    v_mfma_f32_32x32x16_bf16 v[16:31], a[64:67], v[68:71], v[16:31]
    ds_read_b128 v[64:67], v5 offset:20480
    s_waitcnt lgkmcnt(3)
    v_mfma_f32_32x32x16_bf16 v[16:31], a[68:71], v[72:75], v[16:31]
    ds_read_b128 v[68:71], v5 offset:21504
    s_waitcnt lgkmcnt(3)
    v_mfma_f32_32x32x16_bf16 v[16:31], a[72:75], v[76:79], v[16:31]
    ds_read_b128 v[72:75], v5 offset:22528
    s_waitcnt lgkmcnt(3)
    v_mfma_f32_32x32x16_bf16 v[16:31], a[76:79], v[80:83], v[16:31]
    ds_read_b128 v[76:79], v5 offset:23552
    s_waitcnt lgkmcnt(3)
    v_mfma_f32_32x32x16_bf16 v[16:31], a[80:83], v[64:67], v[16:31]
    ds_read_b128 v[80:83], v5 offset:24576
    s_waitcnt lgkmcnt(3)
    v_mfma_f32_32x32x16_bf16 v[16:31], a[84:87], v[68:71], v[16:31]
    ds_read_b128 v[64:67], v5 offset:25600
    s_waitcnt lgkmcnt(3)
    v_mfma_f32_32x32x16_bf16 v[16:31], a[88:91], v[72:75], v[16:31]
    ds_read_b128 v[68:71], v5 offset:26624
    s_waitcnt lgkmcnt(3)
    v_mfma_f32_32x32x16_bf16 v[16:31], a[92:95], v[76:79], v[16:31]
    ds_read_b128 v[72:75], v5 offset:27648
    s_waitcnt lgkmcnt(3)
    v_mfma_f32_32x32x16_bf16 v[16:31], a[96:99], v[80:83], v[16:31]
    ds_read_b128 v[76:79], v5 offset:28672
    s_waitcnt lgkmcnt(3)
    v_mfma_f32_32x32x16_bf16 v[16:31], a[100:103], v[64:67], v[16:31]
    ds_read_b128 v[80:83], v5 offset:29696
    s_waitcnt lgkmcnt(3)
    v_mfma_f32_32x32x16_bf16 v[16:31], a[104:107], v[68:71], v[16:31]
    ds_read_b128 v[64:67], v5 offset:30720
    s_waitcnt lgkmcnt(3)
    v_mfma_f32_32x32x16_bf16 v[16:31], a[108:111], v[72:75], v[16:31]
    ds_read_b128 v[68:71], v5 offset:31744
    s_waitcnt lgkmcnt(3)
    v_mfma_f32_32x32x16_bf16 v[16:31], a[112:115], v[76:79], v[16:31]
    ds_read_b128 v[72:75], v5 offset:32768
    s_waitcnt lgkmcnt(3)
    v_mfma_f32_32x32x16_bf16 v[16:31], a[116:119], v[80:83], v[16:31]
    ds_read_b128 v[76:79], v5 offset:33792
    s_waitcnt lgkmcnt(3)
    v_mfma_f32_32x32x16_bf16 v[16:31], a[120:123], v[64:67], v[16:31]
    ds_read_b128 v[80:83], v5 offset:34816
    s_waitcnt lgkmcnt(3)
    v_mfma_f32_32x32x16_bf16 v[16:31], a[124:127], v[68:71], v[16:31]
    ds_read_b128 v[64:67], v5 offset:35840
    s_waitcnt vmcnt(0)
    s_waitcnt lgkmcnt(3)
    v_mfma_f32_32x32x16_bf16 v[16:31], a[128:131], v[72:75], v[16:31]
    ds_read_b128 v[68:71], v5 offset:36864
    s_waitcnt lgkmcnt(3)
    v_mfma_f32_32x32x16_bf16 v[16:31], a[132:135], v[76:79], v[16:31]
    ds_read_b128 v[72:75], v5 offset:37888
    s_waitcnt lgkmcnt(3)
    v_mfma_f32_32x32x16_bf16 v[16:31], a[136:139], v[80:83], v[16:31]
    ds_read_b128 v[76:79], v5 offset:38912
    s_waitcnt lgkmcnt(3)
    v_mfma_f32_32x32x16_bf16 v[16:31], a[140:143], v[64:67], v[16:31]
    ds_read_b128 v[80:83], v5 offset:39936
    s_waitcnt lgkmcnt(3)
    v_mfma_f32_32x32x16_bf16 v[16:31], a[144:147], v[68:71], v[16:31]
    s_waitcnt lgkmcnt(2)
    v_mfma_f32_32x32x16_bf16 v[16:31], a[148:151], v[72:75], v[16:31]
    s_waitcnt lgkmcnt(1)
    v_mfma_f32_32x32x16_bf16 v[16:31], a[152:155], v[76:79], v[16:31]
    s_waitcnt lgkmcnt(0)
    v_mfma_f32_32x32x16_bf16 v[16:31], a[156:159], v[80:83], v[16:31]
    s_nop 15
    s_nop 1
    s_cmp_ge_u32 s16, 14
    s_cbranch_scc1 mega_kernel_sk155
    s_cmp_lg_u32 s31, 0
    s_cbranch_scc1 mega_kernel_fin156
    v_mov_b32 v50, 0
    v_mov_b32 v51, 0
    v_cvt_pk_bf16_f32 v49, v16, v17
    v_lshlrev_b32 v52, 16, v40
    v_and_b32 v53, 0xffff0000, v40
    v_lshlrev_b32 v16, 16, v49
    v_and_b32 v17, 0xffff0000, v49
    v_add_f32 v16, v16, v52
    v_add_f32 v17, v17, v53
    v_cvt_pk_bf16_f32 v40, v16, v17
    v_lshlrev_b32 v16, 16, v40
    v_and_b32 v17, 0xffff0000, v40
    v_add_f32 v50, v50, v16
    v_add_f32 v50, v50, v17
    v_fmac_f32 v51, v16, v16
    v_fmac_f32 v51, v17, v17
    v_cvt_pk_bf16_f32 v49, v18, v19
    v_lshlrev_b32 v52, 16, v41
    v_and_b32 v53, 0xffff0000, v41
    v_lshlrev_b32 v18, 16, v49
    v_and_b32 v19, 0xffff0000, v49
    v_add_f32 v18, v18, v52
    v_add_f32 v19, v19, v53
    v_cvt_pk_bf16_f32 v41, v18, v19
    v_lshlrev_b32 v18, 16, v41
    v_and_b32 v19, 0xffff0000, v41
    v_add_f32 v50, v50, v18
    v_add_f32 v50, v50, v19
    v_fmac_f32 v51, v18, v18
    v_fmac_f32 v51, v19, v19
    v_cvt_pk_bf16_f32 v49, v20, v21
    v_lshlrev_b32 v52, 16, v42
    v_and_b32 v53, 0xffff0000, v42
    v_lshlrev_b32 v20, 16, v49
    v_and_b32 v21, 0xffff0000, v49
    v_add_f32 v20, v20, v52
    v_add_f32 v21, v21, v53
    v_cvt_pk_bf16_f32 v42, v20, v21
    v_lshlrev_b32 v20, 16, v42
    v_and_b32 v21, 0xffff0000, v42
    v_add_f32 v50, v50, v20
    v_add_f32 v50, v50, v21
    v_fmac_f32 v51, v20, v20
    v_fmac_f32 v51, v21, v21
    v_cvt_pk_bf16_f32 v49, v22, v23
    v_lshlrev_b32 v52, 16, v43
    v_and_b32 v53, 0xffff0000, v43
    v_lshlrev_b32 v22, 16, v49
    v_and_b32 v23, 0xffff0000, v49
    v_add_f32 v22, v22, v52
    v_add_f32 v23, v23, v53
    v_cvt_pk_bf16_f32 v43, v22, v23
    v_lshlrev_b32 v22, 16, v43
    v_and_b32 v23, 0xffff0000, v43
    v_add_f32 v50, v50, v22
    v_add_f32 v50, v50, v23
    v_fmac_f32 v51, v22, v22
    v_fmac_f32 v51, v23, v23
    v_cvt_pk_bf16_f32 v49, v24, v25
    v_lshlrev_b32 v52, 16, v44
    v_and_b32 v53, 0xffff0000, v44
    v_lshlrev_b32 v24, 16, v49
    v_and_b32 v25, 0xffff0000, v49
    v_add_f32 v24, v24, v52
    v_add_f32 v25, v25, v53
    v_cvt_pk_bf16_f32 v44, v24, v25
    v_lshlrev_b32 v24, 16, v44
    v_and_b32 v25, 0xffff0000, v44
    v_add_f32 v50, v50, v24
    v_add_f32 v50, v50, v25
    v_fmac_f32 v51, v24, v24
    v_fmac_f32 v51, v25, v25
    v_cvt_pk_bf16_f32 v49, v26, v27
    v_lshlrev_b32 v52, 16, v45
    v_and_b32 v53, 0xffff0000, v45
    v_lshlrev_b32 v26, 16, v49
    v_and_b32 v27, 0xffff0000, v49
    v_add_f32 v26, v26, v52
    v_add_f32 v27, v27, v53
    v_cvt_pk_bf16_f32 v45, v26, v27
    v_lshlrev_b32 v26, 16, v45
    v_and_b32 v27, 0xffff0000, v45
    v_add_f32 v50, v50, v26
    v_add_f32 v50, v50, v27
    v_fmac_f32 v51, v26, v26
    v_fmac_f32 v51, v27, v27
    v_cvt_pk_bf16_f32 v49, v28, v29
    v_lshlrev_b32 v52, 16, v46
    v_and_b32 v53, 0xffff0000, v46
    v_lshlrev_b32 v28, 16, v49
    v_and_b32 v29, 0xffff0000, v49
    v_add_f32 v28, v28, v52
    v_add_f32 v29, v29, v53
    v_cvt_pk_bf16_f32 v46, v28, v29
    v_lshlrev_b32 v28, 16, v46
    v_and_b32 v29, 0xffff0000, v46
    v_add_f32 v50, v50, v28
    v_add_f32 v50, v50, v29
    v_fmac_f32 v51, v28, v28
    v_fmac_f32 v51, v29, v29
    v_cvt_pk_bf16_f32 v49, v30, v31
    v_lshlrev_b32 v52, 16, v47
    v_and_b32 v53, 0xffff0000, v47
    v_lshlrev_b32 v30, 16, v49
    v_and_b32 v31, 0xffff0000, v49
    v_add_f32 v30, v30, v52
    v_add_f32 v31, v31, v53
    v_cvt_pk_bf16_f32 v47, v30, v31
    v_lshlrev_b32 v30, 16, v47
    v_and_b32 v31, 0xffff0000, v47
    v_add_f32 v50, v50, v30
    v_add_f32 v50, v50, v31
    v_fmac_f32 v51, v30, v30
    v_fmac_f32 v51, v31, v31
    s_mul_i32 s6, s20, 28672
    s_add_u32 s6, s6, s28
    s_lshl_b32 s7, s16, 11
    s_add_u32 s6, s6, s7
    buffer_store_dwordx2 v[40:41], v60, s[44:47], s6 offen offset:0 sc1
    buffer_store_dwordx2 v[42:43], v60, s[44:47], s6 offen offset:512 sc1
    buffer_store_dwordx2 v[44:45], v60, s[44:47], s6 offen offset:1024 sc1
    buffer_store_dwordx2 v[46:47], v60, s[44:47], s6 offen offset:1536 sc1
    v_mov_b32 v52, v50
    v_mov_b32 v53, v51
    s_nop 1
    v_permlane32_swap_b32 v50, v52
    v_permlane32_swap_b32 v51, v53
    s_nop 1
    v_add_f32 v50, v50, v52
    v_add_f32 v51, v51, v53
    s_mul_i32 s6, s20, 3584
    s_add_u32 s6, s6, s29
    s_lshl_b32 s7, s16, 8
    s_add_u32 s6, s6, s7
    buffer_store_dwordx2 v[50:51], v59, s[44:47], s6 offen sc1
    s_branch mega_kernel_sk155
mega_kernel_fin156:
    v_mov_b32 v50, 0
    v_mov_b32 v51, 0
    v_cvt_pk_bf16_f32 v49, v16, v17
    v_lshlrev_b32 v52, 16, v40
    v_and_b32 v53, 0xffff0000, v40
    v_lshlrev_b32 v16, 16, v49
    v_and_b32 v17, 0xffff0000, v49
    v_add_f32 v16, v16, v52
    v_add_f32 v17, v17, v53
    v_cvt_pk_bf16_f32 v40, v16, v17
    v_cvt_pk_bf16_f32 v49, v18, v19
    v_lshlrev_b32 v52, 16, v41
    v_and_b32 v53, 0xffff0000, v41
    v_lshlrev_b32 v18, 16, v49
    v_and_b32 v19, 0xffff0000, v49
    v_add_f32 v18, v18, v52
    v_add_f32 v19, v19, v53
    v_cvt_pk_bf16_f32 v41, v18, v19
    v_cvt_pk_bf16_f32 v49, v20, v21
    v_lshlrev_b32 v52, 16, v42
    v_and_b32 v53, 0xffff0000, v42
    v_lshlrev_b32 v20, 16, v49
    v_and_b32 v21, 0xffff0000, v49
    v_add_f32 v20, v20, v52
    v_add_f32 v21, v21, v53
    v_cvt_pk_bf16_f32 v42, v20, v21
    v_cvt_pk_bf16_f32 v49, v22, v23
    v_lshlrev_b32 v52, 16, v43
    v_and_b32 v53, 0xffff0000, v43
    v_lshlrev_b32 v22, 16, v49
    v_and_b32 v23, 0xffff0000, v49
    v_add_f32 v22, v22, v52
    v_add_f32 v23, v23, v53
    v_cvt_pk_bf16_f32 v43, v22, v23
    v_cvt_pk_bf16_f32 v49, v24, v25
    v_lshlrev_b32 v52, 16, v44
    v_and_b32 v53, 0xffff0000, v44
    v_lshlrev_b32 v24, 16, v49
    v_and_b32 v25, 0xffff0000, v49
    v_add_f32 v24, v24, v52
    v_add_f32 v25, v25, v53
    v_cvt_pk_bf16_f32 v44, v24, v25
    v_cvt_pk_bf16_f32 v49, v26, v27
    v_lshlrev_b32 v52, 16, v45
    v_and_b32 v53, 0xffff0000, v45
    v_lshlrev_b32 v26, 16, v49
    v_and_b32 v27, 0xffff0000, v49
    v_add_f32 v26, v26, v52
    v_add_f32 v27, v27, v53
    v_cvt_pk_bf16_f32 v45, v26, v27
    v_cvt_pk_bf16_f32 v49, v28, v29
    v_lshlrev_b32 v52, 16, v46
    v_and_b32 v53, 0xffff0000, v46
    v_lshlrev_b32 v28, 16, v49
    v_and_b32 v29, 0xffff0000, v49
    v_add_f32 v28, v28, v52
    v_add_f32 v29, v29, v53
    v_cvt_pk_bf16_f32 v46, v28, v29
    v_cvt_pk_bf16_f32 v49, v30, v31
    v_lshlrev_b32 v52, 16, v47
    v_and_b32 v53, 0xffff0000, v47
    v_lshlrev_b32 v30, 16, v49
    v_and_b32 v31, 0xffff0000, v49
    v_add_f32 v30, v30, v52
    v_add_f32 v31, v31, v53
    v_cvt_pk_bf16_f32 v47, v30, v31
    s_mul_i32 s6, s20, 28672
    s_lshl_b32 s7, s16, 6
    s_add_u32 s6, s6, s7
    v_mul_u32_u24 v48, 896, v2
    v_lshl_add_u32 v48, v3, 3, v48
    buffer_store_dwordx2 v[40:41], v48, s[52:55], s6 offen offset:0
    buffer_store_dwordx2 v[42:43], v48, s[52:55], s6 offen offset:16
    buffer_store_dwordx2 v[44:45], v48, s[52:55], s6 offen offset:32
    buffer_store_dwordx2 v[46:47], v48, s[52:55], s6 offen offset:48
mega_kernel_sk155:
    s_cmp_lg_u32 s31, 0
    s_cbranch_scc1 mega_kernel_sf157
    s_waitcnt vmcnt(0)
    s_barrier
    s_cmp_lg_u32 s3, 0
    s_cbranch_scc1 mega_kernel_sf164
    s_lshl_b32 s37, s20, 8
    s_lshl_b32 s33, s31, 14
    s_add_u32 s37, s37, s33
    s_lshl_b32 s33, s15, 2
    s_add_u32 s37, s37, s33
    s_add_u32 s37, s37, 200822784
    s_mov_b64 s[34:35], exec
    s_mov_b64 exec, 1
    v_mov_b32 v8, 1
    v_mov_b32 v9, 0
    buffer_store_dword v8, v9, s[44:47], s37 offen sc1
    s_mov_b64 exec, s[34:35]
mega_kernel_sf164:
    s_branch mega_kernel_sf157_e
mega_kernel_sf157:
    s_barrier
mega_kernel_sf157_e:
    s_add_u32 s20, s20, 2
    s_cmp_lt_u32 s20, 64
    s_cbranch_scc1 mega_kernel_zl154
    s_branch mega_kernel_done
mega_kernel_done:
    s_endpgm
.section .rodata,"a"
.p2align 6
.amdhsa_kernel prep_kernel
  .amdhsa_next_free_vgpr 256
  .amdhsa_next_free_sgpr 102
  .amdhsa_accum_offset 256
  .amdhsa_group_segment_fixed_size 0
  .amdhsa_kernarg_size 104
  .amdhsa_user_sgpr_count 2
  .amdhsa_user_sgpr_kernarg_segment_ptr 1
  .amdhsa_system_sgpr_workgroup_id_x 1
.end_amdhsa_kernel

.section .rodata,"a"
.p2align 6
.amdhsa_kernel mega_kernel
  .amdhsa_next_free_vgpr 512
  .amdhsa_next_free_sgpr 102
  .amdhsa_accum_offset 256
  .amdhsa_group_segment_fixed_size 0
  .amdhsa_kernarg_size 104
  .amdhsa_user_sgpr_count 2
  .amdhsa_user_sgpr_kernarg_segment_ptr 1
  .amdhsa_system_sgpr_workgroup_id_x 1
.end_amdhsa_kernel
```
